```python
import torch

def _softmax(x, axis=-1):
    return torch.softmax(x, dim=axis)
def _gelu(x):
    return torch.nn.functional.gelu(x, approximate="tanh")
def _silu(x):
    return torch.nn.functional.silu(x)
def _sigmoid(x):
    return torch.sigmoid(x)
def _layernorm(x, axis=-1, eps=1e-5):
    m = x.mean(dim=axis, keepdim=True)
    v = x.var(dim=axis, keepdim=True, unbiased=False)
    return (x - m) / torch.sqrt(v + eps)
def _scatter_add(tgt, idx, src, axis=0):
    return tgt.clone().index_add_(axis, idx, src)
def _segment_sum(src, seg, n):
    out = torch.zeros((n,) + src.shape[1:], dtype=src.dtype)
    return out.index_add_(0, seg, src)
def _pad(x, pw):
    flat = tuple(v for pair in reversed(pw) for v in pair)
    return torch.nn.functional.pad(x, flat)

kernel_name = 'gated_mix__linear_attn_block__linear_attn_block__prompt'

def setup_inputs():

    _w = (lambda a: (lambda t: t.to(torch.bfloat16) if t.is_floating_point() else t)(torch.as_tensor(a)))
    def _A_setup():
        B, S, D = 1, 2048, 1024
        return {
            "x": _w((lambda *s: torch.randn(*s, dtype=torch.bfloat16) * 0.05)(B, S, D)),
            "wqkv": _w((lambda *s: torch.randn(*s, dtype=torch.bfloat16) * 0.8)(D, 3 * D)),
            "wo": _w((lambda *s: torch.randn(*s, dtype=torch.bfloat16) * 0.05)(D, D)),
        }
    _A_in = _A_setup()

    def _B_setup():
        B, S, D = 1, 2048, 1024
        return {
            "x": _w((lambda *s: torch.randn(*s, dtype=torch.bfloat16) * 0.05)(B, S, D)),
            "wqkv": _w((lambda *s: torch.randn(*s, dtype=torch.bfloat16) * 0.8)(D, 3 * D)),
            "wo": _w((lambda *s: torch.randn(*s, dtype=torch.bfloat16) * 0.05)(D, D)),
        }
    _B_in = _B_setup()

    return {
        "A_x": _A_in["x"],
        "A_wqkv": _A_in["wqkv"],
        "A_wo": _A_in["wo"],
        "B_x": _B_in["x"],
        "B_wqkv": _B_in["wqkv"],
        "B_wo": _B_in["wo"],
        "gate_w": _w((lambda *s: torch.randn(*s, dtype=torch.bfloat16) * 0.05)(1024) * 16.0),
    }

def reference(A_x, A_wqkv, A_wo, B_x, B_wqkv, B_wo, gate_w):
    def _A_ref(x, wqkv, wo):
        B, S, D = x.shape
        H = 32; Dh = D // H
        qkv = (lambda x, *d: x.permute(*d))((x @ wqkv).reshape(B, S, 3, H, Dh), 2, 0, 3, 1, 4)
        q, k, v = qkv[0], qkv[1], qkv[2]
        phi = lambda t: torch.where(t > 0, t + 1, torch.exp(t)) + 1e-6
        pq, pk = phi(q), phi(k)
        kv = torch.einsum("bhsd,bhse->bhde", pk, v)
        z = torch.einsum("bhsd->bhd", pk)
        num = torch.einsum("bhqd,bhde->bhqe", pq, kv)
        den = torch.einsum("bhqd,bhd->bhq", pq, z)[..., None] + 1e-6
        o = num / den
        return (lambda x, *d: x.permute(*d))(o, 0, 2, 1, 3).reshape(B, S, D) @ wo

    def _B_ref(x, wqkv, wo):
        B, S, D = x.shape
        H = 32; Dh = D // H
        qkv = (lambda x, *d: x.permute(*d))((x @ wqkv).reshape(B, S, 3, H, Dh), 2, 0, 3, 1, 4)
        q, k, v = qkv[0], qkv[1], qkv[2]
        phi = lambda t: torch.where(t > 0, t + 1, torch.exp(t)) + 1e-6
        pq, pk = phi(q), phi(k)
        kv = torch.einsum("bhsd,bhse->bhde", pk, v)
        z = torch.einsum("bhsd->bhd", pk)
        num = torch.einsum("bhqd,bhde->bhqe", pq, kv)
        den = torch.einsum("bhqd,bhd->bhq", pq, z)[..., None] + 1e-6
        o = num / den
        return (lambda x, *d: x.permute(*d))(o, 0, 2, 1, 3).reshape(B, S, D) @ wo

    x = A_x
    g = _sigmoid((x * gate_w).sum(-1, keepdims=True))
    a = _A_ref(x, A_wqkv, A_wo)
    b = _B_ref(x, B_wqkv, B_wo)
    return g * a + (1 - g) * b
```

```asm
; @launch grid=(256,1,1) block=(256,1,1) lds=163840
.amdgcn_target "amdgcn-amd-amdhsa--gfx950"
.text
.globl gated_mix__linear_attn_block__linear_attn_block__prompt_kernel
.p2align 8
.type gated_mix__linear_attn_block__linear_attn_block__prompt_kernel,@function
gated_mix__linear_attn_block__linear_attn_block__prompt_kernel:
    s_cmp_ge_u32 s2, 256
    s_cbranch_scc1 K_END
    s_load_dwordx4 s[4:7], s[0:1], 0
    s_load_dwordx2 s[8:9], s[0:1], 32
    s_load_dwordx4 s[68:71], s[0:1], 48
    s_load_dwordx4 s[12:15], s[0:1], 64
    s_load_dwordx2 s[74:75], s[0:1], 16
    s_load_dwordx2 s[76:77], s[0:1], 40
    v_lshrrev_b32 v21, 6, v0
    v_and_b32 v1, 63, v0
    v_readfirstlane_b32 s38, v21
    s_and_b32 s56, s2, 7
    s_lshr_b32 s57, s2, 3
    s_and_b32 s36, s57, 7
    s_lshr_b32 s58, s57, 3
    s_lshl_b32 s37, s56, 2
    s_add_u32 s37, s37, s58
    s_and_b32 s39, s38, 1
    s_lshr_b32 s40, s38, 1
    s_and_b32 s41, s37, 15
    s_lshr_b32 s42, s37, 4
    v_lshrrev_b32 v21, 3, v1
    v_and_b32 v22, 7, v1
    v_lshrrev_b32 v23, 4, v1
    v_and_b32 v24, 1, v23
    v_lshlrev_b32 v24, 2, v24
    v_xor_b32 v24, v22, v24
    v_lshlrev_b32 v24, 4, v24
    v_mul_u32_u24 v25, 6144, v21
    v_add_u32 v24, v24, v25
    v_xor_b32 v25, 32, v24
    s_mul_i32 s56, s38, 6
    s_lshl_b32 s59, s41, 7
    s_add_u32 s57, s56, 0
    s_lshr_b32 s58, s57, 3
    s_and_b32 s57, s57, 7
    s_mul_i32 s57, s57, 49152
    s_lshl_b32 s58, s58, 11
    s_add_u32 s57, s57, s58
    s_add_u32 s57, s57, s59
    v_add_u32 v10, s57, v24
    s_add_u32 s57, s56, 1
    s_lshr_b32 s58, s57, 3
    s_and_b32 s57, s57, 7
    s_mul_i32 s57, s57, 49152
    s_lshl_b32 s58, s58, 11
    s_add_u32 s57, s57, s58
    s_add_u32 s57, s57, s59
    s_sub_u32 s57, s57, 1024
    v_add_u32 v11, s57, v25
    s_add_u32 s57, s56, 2
    s_lshr_b32 s58, s57, 3
    s_and_b32 s57, s57, 7
    s_mul_i32 s57, s57, 49152
    s_lshl_b32 s58, s58, 11
    s_add_u32 s57, s57, s58
    s_add_u32 s57, s57, s59
    s_sub_u32 s57, s57, 2048
    v_add_u32 v12, s57, v24
    s_add_u32 s57, s56, 3
    s_lshr_b32 s58, s57, 3
    s_and_b32 s57, s57, 7
    s_mul_i32 s57, s57, 49152
    s_lshl_b32 s58, s58, 11
    s_add_u32 s57, s57, s58
    s_add_u32 s57, s57, s59
    s_sub_u32 s57, s57, 3072
    v_add_u32 v13, s57, v25
    s_add_u32 s57, s56, 4
    s_lshr_b32 s58, s57, 3
    s_and_b32 s57, s57, 7
    s_mul_i32 s57, s57, 49152
    s_lshl_b32 s58, s58, 11
    s_add_u32 s57, s57, s58
    s_add_u32 s57, s57, s59
    v_add_u32 v14, s57, v24
    s_add_u32 s57, s56, 5
    s_lshr_b32 s58, s57, 3
    s_and_b32 s57, s57, 7
    s_mul_i32 s57, s57, 49152
    s_lshl_b32 s58, s58, 11
    s_add_u32 s57, s57, s58
    s_add_u32 s57, s57, s59
    s_sub_u32 s57, s57, 1024
    v_add_u32 v15, s57, v25
    v_xor_b32 v24, v22, v23
    v_lshlrev_b32 v24, 4, v24
    v_lshl_add_u32 v24, v21, 11, v24
    s_lshl_b32 s56, s36, 19
    s_lshl_b32 s57, s40, 18
    s_add_u32 s56, s56, s57
    s_lshl_b32 s57, s39, 16
    s_add_u32 s56, s56, s57
    v_add_u32 v2, s56, v24
    v_xor_b32 v25, 64, v2
    v_add_u32 v3, 15360, v25
    v_add_u32 v4, 30720, v2
    v_add_u32 v5, 46080, v25
    v_add_u32 v6, 131072, v2
    v_add_u32 v7, 146432, v25
    v_add_u32 v8, 161792, v2
    v_add_u32 v9, 177152, v25
    s_lshl_b32 s48, s38, 13
    s_lshl_b32 s45, s40, 14
    s_lshl_b32 s57, s39, 12
    s_add_u32 s45, s45, s57
    s_mov_b32 s72, 0
    s_mul_i32 s49, s38, 6144
    s_mov_b32 s43, 0
    s_mov_b32 s44, 0
    s_waitcnt lgkmcnt(0)
    s_mov_b32 s16, s4
    s_and_b32 s17, s5, 0xffff
    s_mov_b32 s18, 4194304
    s_mov_b32 s19, 0x00020000
    s_cmp_eq_u32 s42, 0
    s_cselect_b32 s56, s6, s8
    s_cselect_b32 s57, s7, s9
    s_mov_b32 s20, s56
    s_and_b32 s21, s57, 0xffff
    s_mov_b32 s22, 6291456
    s_mov_b32 s23, 0x00020000
    v_lshlrev_b32 v38, 7, v1
    s_lshl_b32 s58, s2, 2
    s_add_u32 s58, s58, s38
    s_lshl_b32 s58, s58, 12
    s_mov_b32 exec_lo, 0xf000f
    s_mov_b32 exec_hi, 0
    buffer_load_dword v39, v38, s[16:19], s58 offen
    s_mov_b64 exec, -1
    s_add_u32 m0, s49, 65536
    s_nop 0
    buffer_load_dwordx4 v10, s[20:23], s44 offen lds
    buffer_load_dwordx4 v11, s[20:23], s44 offen offset:1024 lds
    buffer_load_dwordx4 v12, s[20:23], s44 offen offset:2048 lds
    buffer_load_dwordx4 v13, s[20:23], s44 offen offset:3072 lds
    s_add_u32 m0, s49, 69632
    s_nop 0
    buffer_load_dwordx4 v14, s[20:23], s44 offen lds
    buffer_load_dwordx4 v15, s[20:23], s44 offen offset:1024 lds
    s_add_u32 s44, s44, 393216
    s_add_u32 m0, s45, 0
    s_nop 0
    buffer_load_dwordx4 v2, s[16:19], s43 offen lds
    buffer_load_dwordx4 v3, s[16:19], s43 offen offset:1024 lds
    buffer_load_dwordx4 v4, s[16:19], s43 offen offset:2048 lds
    buffer_load_dwordx4 v5, s[16:19], s43 offen offset:3072 lds
    s_add_u32 s43, s43, 128
    s_add_u32 m0, s45, 8192
    s_nop 0
    buffer_load_dwordx4 v6, s[16:19], s72 offen lds
    buffer_load_dwordx4 v7, s[16:19], s72 offen offset:1024 lds
    buffer_load_dwordx4 v8, s[16:19], s72 offen offset:2048 lds
    buffer_load_dwordx4 v9, s[16:19], s72 offen offset:3072 lds
    s_add_u32 s72, s72, 128
    s_mov_b32 s24, s14
    s_and_b32 s25, s15, 0xffff
    s_mov_b32 s26, 20971520
    s_mov_b32 s27, 0x00020000
    s_mov_b32 s28, s12
    s_and_b32 s29, s13, 0xffff
    s_mov_b32 s30, 256
    s_mov_b32 s31, 0x00020000
    s_mov_b32 s32, s68
    s_and_b32 s33, s69, 0xffff
    s_mov_b32 s34, 2048
    s_mov_b32 s35, 0x00020000
    v_lshlrev_b32 v26, 4, v1
    s_lshl_b32 s46, s37, 1
    s_add_u32 s46, s46, s40
    s_lshl_b32 s47, s36, 1
    s_add_u32 s47, s47, s39
    s_lshl_b32 s56, s47, 7
    s_lshl_b32 s57, s46, 1
    s_add_u32 s56, s56, s57
    s_lshl_b32 s60, s56, 11
    s_lshl_b32 s55, s56, 2
    s_add_u32 s55, s55, 12582912
    s_lshl_b32 s56, s47, 19
    s_lshl_b32 s57, s46, 13
    s_add_u32 s65, s56, s57
    s_lshl_b32 s56, s37, 17
    s_lshl_b32 s57, s38, 12
    s_add_u32 s61, s56, s57
    s_add_u32 s61, s61, 8388608
    s_lshl_b32 s57, s36, 14
    s_add_u32 s62, s61, s57
    v_lshrrev_b32 v27, 4, v1
    v_lshlrev_b32 v27, 4, v27
    v_and_b32 v30, 7, v1
    v_lshl_add_u32 v30, v30, 14, v27
    s_lshl_b32 s63, s37, 3
    v_mov_b32 v32, -1
    v_mov_b32 v33, -1
    v_mov_b32 v34, -1
    v_mov_b32 v35, -1
    v_lshlrev_b32 v38, 7, v1
    v_mov_b32 v28, 1
    v_mov_b32 v29, 0
    v_and_b32 v21, 15, v1
    v_lshrrev_b32 v22, 4, v1
    v_bfe_u32 v23, v1, 1, 3
    v_xor_b32 v23, v23, v22
    v_lshlrev_b32 v23, 4, v23
    v_lshl_add_u32 v23, v21, 7, v23
    s_lshl_b32 s56, s39, 14
    v_add_u32 v16, s56, v23
    v_xor_b32 v17, 64, v16
    v_bfe_u32 v23, v1, 2, 2
    v_lshl_add_u32 v24, v22, 3, v23
    v_lshlrev_b32 v24, 7, v24
    v_bfe_u32 v25, v1, 1, 1
    s_lshl_b32 s56, s40, 2
    v_or_b32 v25, s56, v25
    v_and_b32 v36, 2, v23
    v_lshlrev_b32 v36, 1, v36
    v_xor_b32 v25, v25, v36
    v_and_b32 v36, 1, v22
    v_lshlrev_b32 v36, 1, v36
    v_xor_b32 v25, v25, v36
    v_lshl_add_u32 v24, v25, 4, v24
    v_and_b32 v36, 1, v1
    v_lshl_add_u32 v24, v36, 3, v24
    s_lshl_b32 s56, s39, 5
    v_xor_b32 v24, s56, v24
    v_xor_b32 v25, 32, v24
    v_add_u32 v18, 65536, v24
    v_add_u32 v19, 65536, v25
    v_add_u32 v20, 90112, v24
    v_add_u32 v21, 90112, v25
    v_add_u32 v22, 114688, v24
    v_add_u32 v23, 114688, v25
    v_mov_b32 v36, 0x358637bd
    v_mov_b32 v37, v36
    v_pk_mov_b32 v[64:65], v[36:37], v[36:37]
    v_pk_mov_b32 v[66:67], v[36:37], v[36:37]
    v_pk_mov_b32 v[68:69], v[36:37], v[36:37]
    v_pk_mov_b32 v[70:71], v[36:37], v[36:37]
    v_pk_mov_b32 v[72:73], v[36:37], v[36:37]
    v_pk_mov_b32 v[74:75], v[36:37], v[36:37]
    v_pk_mov_b32 v[76:77], v[36:37], v[36:37]
    v_pk_mov_b32 v[78:79], v[36:37], v[36:37]
    v_pk_mov_b32 v[88:89], v[36:37], v[36:37]
    v_pk_mov_b32 v[90:91], v[36:37], v[36:37]
    v_pk_mov_b32 v[92:93], v[36:37], v[36:37]
    v_pk_mov_b32 v[94:95], v[36:37], v[36:37]
    v_pk_mov_b32 v[96:97], v[36:37], v[36:37]
    v_pk_mov_b32 v[98:99], v[36:37], v[36:37]
    v_pk_mov_b32 v[100:101], v[36:37], v[36:37]
    v_pk_mov_b32 v[102:103], v[36:37], v[36:37]
    v_pk_mov_b32 v[112:113], v[36:37], v[36:37]
    v_pk_mov_b32 v[114:115], v[36:37], v[36:37]
    v_pk_mov_b32 v[116:117], v[36:37], v[36:37]
    v_pk_mov_b32 v[118:119], v[36:37], v[36:37]
    v_pk_mov_b32 v[120:121], v[36:37], v[36:37]
    v_pk_mov_b32 v[122:123], v[36:37], v[36:37]
    v_pk_mov_b32 v[124:125], v[36:37], v[36:37]
    v_pk_mov_b32 v[126:127], v[36:37], v[36:37]
    v_pk_mov_b32 v[136:137], v[36:37], v[36:37]
    v_pk_mov_b32 v[138:139], v[36:37], v[36:37]
    v_pk_mov_b32 v[140:141], v[36:37], v[36:37]
    v_pk_mov_b32 v[142:143], v[36:37], v[36:37]
    v_pk_mov_b32 v[144:145], v[36:37], v[36:37]
    v_pk_mov_b32 v[146:147], v[36:37], v[36:37]
    v_pk_mov_b32 v[148:149], v[36:37], v[36:37]
    v_pk_mov_b32 v[150:151], v[36:37], v[36:37]
    v_pk_mov_b32 v[160:161], v[36:37], v[36:37]
    v_pk_mov_b32 v[162:163], v[36:37], v[36:37]
    v_pk_mov_b32 v[164:165], v[36:37], v[36:37]
    v_pk_mov_b32 v[166:167], v[36:37], v[36:37]
    v_pk_mov_b32 v[168:169], v[36:37], v[36:37]
    v_pk_mov_b32 v[170:171], v[36:37], v[36:37]
    v_pk_mov_b32 v[172:173], v[36:37], v[36:37]
    v_pk_mov_b32 v[174:175], v[36:37], v[36:37]
    v_pk_mov_b32 v[184:185], v[36:37], v[36:37]
    v_pk_mov_b32 v[186:187], v[36:37], v[36:37]
    v_pk_mov_b32 v[188:189], v[36:37], v[36:37]
    v_pk_mov_b32 v[190:191], v[36:37], v[36:37]
    v_pk_mov_b32 v[192:193], v[36:37], v[36:37]
    v_pk_mov_b32 v[194:195], v[36:37], v[36:37]
    v_pk_mov_b32 v[196:197], v[36:37], v[36:37]
    v_pk_mov_b32 v[198:199], v[36:37], v[36:37]
    v_pk_mov_b32 v[208:209], v[36:37], v[36:37]
    v_pk_mov_b32 v[210:211], v[36:37], v[36:37]
    v_pk_mov_b32 v[212:213], v[36:37], v[36:37]
    v_pk_mov_b32 v[214:215], v[36:37], v[36:37]
    v_pk_mov_b32 v[216:217], v[36:37], v[36:37]
    v_pk_mov_b32 v[218:219], v[36:37], v[36:37]
    v_pk_mov_b32 v[220:221], v[36:37], v[36:37]
    v_pk_mov_b32 v[222:223], v[36:37], v[36:37]
    v_pk_mov_b32 v[232:233], v[36:37], v[36:37]
    v_pk_mov_b32 v[234:235], v[36:37], v[36:37]
    v_pk_mov_b32 v[236:237], v[36:37], v[36:37]
    v_pk_mov_b32 v[238:239], v[36:37], v[36:37]
    v_pk_mov_b32 v[240:241], v[36:37], v[36:37]
    v_pk_mov_b32 v[242:243], v[36:37], v[36:37]
    v_pk_mov_b32 v[244:245], v[36:37], v[36:37]
    v_pk_mov_b32 v[246:247], v[36:37], v[36:37]
    s_lshl_b32 s56, s2, 2
    s_add_u32 s56, s56, s38
    s_bitcmp1_b32 s56, 3
    s_cselect_b32 s84, s8, s6
    s_cselect_b32 s85, s9, s7
    s_and_b32 s85, s85, 0xffff
    s_mov_b32 s86, 6291456
    s_mov_b32 s87, 0x00020000
    s_lshr_b32 s57, s56, 4
    s_add_u32 s57, s57, 384
    s_mul_i32 s73, s57, 6144
    s_and_b32 s57, s56, 7
    s_mul_i32 s57, s57, 768
    s_add_u32 s73, s73, s57
    s_lshl_b32 s56, s2, 2
    s_add_u32 s56, s56, s38
    s_lshr_b32 s57, s56, 4
    s_lshl_b32 s57, s57, 3
    s_and_b32 s58, s56, 7
    s_add_u32 s57, s57, s58
    s_add_u32 s57, s57, 0
    s_cmp_lt_u32 s57, 384
    s_cselect_b32 s57, s57, 1024
    s_mul_i32 s57, s57, 6144
    v_lshlrev_b32 v40, 10, v1
    s_mov_b64 exec, 0x3f
    buffer_load_dword v39, v40, s[84:87], s57 offen offset:384
    s_mov_b64 exec, -1
    s_getpc_b64 s[56:57]
K_CT:
    s_sub_u32 s56, s56, K_CT-gated_mix__linear_attn_block__linear_attn_block__prompt_kernel
    s_subb_u32 s57, s57, 0
    s_mov_b64 s[88:89], s[56:57]
    s_lshr_b32 s58, s2, 3
    s_lshl_b32 s58, s58, 2
    s_add_u32 s58, s58, s38
    s_lshl_b32 s79, s58, 7
    s_mul_i32 s58, s58, 384
    v_add_u32 v40, s58, v38
    v_min_u32 v40, K_LAST-gated_mix__linear_attn_block__linear_attn_block__prompt_kernel, v40
    v_mov_b32 v41, s57
    v_add_co_u32 v40, vcc, s56, v40
    s_nop 1
    v_addc_co_u32 v41, vcc, 0, v41, vcc
    s_mov_b64 exec, 7
    global_load_dword v39, v[40:41], off
    s_mov_b64 exec, -1
    s_add_u32 m0, s49, 90112
    s_nop 0
    buffer_load_dwordx4 v10, s[20:23], s44 offen lds
    buffer_load_dwordx4 v11, s[20:23], s44 offen offset:1024 lds
    buffer_load_dwordx4 v12, s[20:23], s44 offen offset:2048 lds
    buffer_load_dwordx4 v13, s[20:23], s44 offen offset:3072 lds
    s_add_u32 m0, s49, 94208
    s_nop 0
    buffer_load_dwordx4 v14, s[20:23], s44 offen lds
    buffer_load_dwordx4 v15, s[20:23], s44 offen offset:1024 lds
    s_add_u32 s44, s44, 393216
    s_mov_b32 exec_lo, 0x300030
    s_mov_b32 exec_hi, 0
    buffer_load_dword v39, v38, s[16:19], s60 offen
    s_mov_b64 exec, -1
    s_waitcnt vmcnt(13)
    s_barrier
    ds_read_b64_tr_b16 a[0:1], v18 offset:0
    ds_read_b64_tr_b16 a[2:3], v18 offset:512
    ds_read_b64_tr_b16 a[4:5], v18 offset:4096
    ds_read_b64_tr_b16 a[6:7], v18 offset:4608
    ds_read_b128 a[96:99], v16 offset:0
    ds_read_b128 a[100:103], v17 offset:0
    ds_read_b64_tr_b16 a[8:9], v19 offset:0
    ds_read_b64_tr_b16 a[10:11], v19 offset:512
    ds_read_b64_tr_b16 a[12:13], v19 offset:4096
    ds_read_b64_tr_b16 a[14:15], v19 offset:4608
    ds_read_b64_tr_b16 a[16:17], v18 offset:8192
    ds_read_b64_tr_b16 a[18:19], v18 offset:8704
    ds_read_b64_tr_b16 a[20:21], v18 offset:12288
    ds_read_b64_tr_b16 a[22:23], v18 offset:12800
    ds_read_b64_tr_b16 a[24:25], v19 offset:8192
    s_waitcnt lgkmcnt(9)
    v_mfma_f32_16x16x32_bf16 v[64:67], a[0:3], a[96:99], v[64:67]
    ds_read_b64_tr_b16 a[26:27], v19 offset:8704
    ds_read_b64_tr_b16 a[28:29], v19 offset:12288
    ds_read_b64_tr_b16 a[30:31], v19 offset:12800
    ds_read_b64_tr_b16 a[32:33], v18 offset:16384
    ds_read_b64_tr_b16 a[34:35], v18 offset:16896
    ds_read_b64_tr_b16 a[36:37], v18 offset:20480
    ds_read_b64_tr_b16 a[38:39], v18 offset:20992
    ds_read_b64_tr_b16 a[40:41], v19 offset:16384
    ds_read_b64_tr_b16 a[42:43], v19 offset:16896
    ds_read_b64_tr_b16 a[44:45], v19 offset:20480
    ds_read_b64_tr_b16 a[46:47], v19 offset:20992
    ds_read_b128 a[104:107], v16 offset:2048
    v_mfma_f32_16x16x32_bf16 v[64:67], a[4:7], a[100:103], v[64:67]
    ds_read_b128 a[108:111], v17 offset:2048
    s_add_u32 m0, s45, 32768
    s_waitcnt lgkmcnt(15)
    v_mfma_f32_16x16x32_bf16 v[68:71], a[8:11], a[96:99], v[68:71]
    buffer_load_dwordx4 v2, s[16:19], s43 offen lds
    v_mfma_f32_16x16x32_bf16 v[68:71], a[12:15], a[100:103], v[68:71]
    v_mfma_f32_16x16x32_bf16 v[72:75], a[96:99], a[16:19], v[72:75]
    s_waitcnt lgkmcnt(14)
    v_mfma_f32_16x16x32_bf16 v[72:75], a[100:103], a[20:23], v[72:75]
    buffer_load_dwordx4 v3, s[16:19], s43 offen offset:1024 lds
    s_waitcnt lgkmcnt(12)
    v_mfma_f32_16x16x32_bf16 v[76:79], a[96:99], a[24:27], v[76:79]
    s_waitcnt lgkmcnt(10)
    v_mfma_f32_16x16x32_bf16 v[76:79], a[100:103], a[28:31], v[76:79]
    s_waitcnt lgkmcnt(8)
    v_mfma_f32_16x16x32_bf16 v[80:83], a[96:99], a[32:35], 0
    buffer_load_dwordx4 v4, s[16:19], s43 offen offset:2048 lds
    s_waitcnt lgkmcnt(6)
    v_mfma_f32_16x16x32_bf16 v[80:83], a[100:103], a[36:39], v[80:83]
    s_waitcnt lgkmcnt(4)
    v_mfma_f32_16x16x32_bf16 v[84:87], a[96:99], a[40:43], 0
    s_waitcnt lgkmcnt(2)
    v_mfma_f32_16x16x32_bf16 v[84:87], a[100:103], a[44:47], v[84:87]
    s_waitcnt lgkmcnt(0)
    v_mfma_f32_16x16x32_bf16 v[88:91], a[0:3], a[104:107], v[88:91]
    ds_read_b128 a[96:99], v16 offset:4096
    v_mfma_f32_16x16x32_bf16 v[88:91], a[4:7], a[108:111], v[88:91]
    ds_read_b128 a[100:103], v17 offset:4096
    v_mfma_f32_16x16x32_bf16 v[92:95], a[8:11], a[104:107], v[92:95]
    buffer_load_dwordx4 v5, s[16:19], s43 offen offset:3072 lds
    v_mfma_f32_16x16x32_bf16 v[92:95], a[12:15], a[108:111], v[92:95]
    s_add_u32 s43, s43, 128
    s_add_u32 m0, s49, 114688
    v_mfma_f32_16x16x32_bf16 v[96:99], a[104:107], a[16:19], v[96:99]
    buffer_load_dwordx4 v10, s[20:23], s44 offen lds
    v_mfma_f32_16x16x32_bf16 v[96:99], a[108:111], a[20:23], v[96:99]
    v_mfma_f32_16x16x32_bf16 v[100:103], a[104:107], a[24:27], v[100:103]
    v_mfma_f32_16x16x32_bf16 v[100:103], a[108:111], a[28:31], v[100:103]
    buffer_load_dwordx4 v11, s[20:23], s44 offen offset:1024 lds
    v_mfma_f32_16x16x32_bf16 v[104:107], a[104:107], a[32:35], 0
    v_mfma_f32_16x16x32_bf16 v[104:107], a[108:111], a[36:39], v[104:107]
    v_mfma_f32_16x16x32_bf16 v[108:111], a[104:107], a[40:43], 0
    buffer_load_dwordx4 v12, s[20:23], s44 offen offset:2048 lds
    v_mfma_f32_16x16x32_bf16 v[108:111], a[108:111], a[44:47], v[108:111]
    s_waitcnt lgkmcnt(0)
    v_mfma_f32_16x16x32_bf16 v[112:115], a[0:3], a[96:99], v[112:115]
    ds_read_b128 a[104:107], v16 offset:6144
    v_mfma_f32_16x16x32_bf16 v[112:115], a[4:7], a[100:103], v[112:115]
    ds_read_b128 a[108:111], v17 offset:6144
    v_mfma_f32_16x16x32_bf16 v[116:119], a[8:11], a[96:99], v[116:119]
    buffer_load_dwordx4 v13, s[20:23], s44 offen offset:3072 lds
    v_mfma_f32_16x16x32_bf16 v[116:119], a[12:15], a[100:103], v[116:119]
    v_mfma_f32_16x16x32_bf16 v[120:123], a[96:99], a[16:19], v[120:123]
    s_add_u32 m0, s49, 118784
    v_mfma_f32_16x16x32_bf16 v[120:123], a[100:103], a[20:23], v[120:123]
    buffer_load_dwordx4 v14, s[20:23], s44 offen lds
    v_mfma_f32_16x16x32_bf16 v[124:127], a[96:99], a[24:27], v[124:127]
    v_mfma_f32_16x16x32_bf16 v[124:127], a[100:103], a[28:31], v[124:127]
    v_mfma_f32_16x16x32_bf16 v[128:131], a[96:99], a[32:35], 0
    buffer_load_dwordx4 v15, s[20:23], s44 offen offset:1024 lds
    v_mfma_f32_16x16x32_bf16 v[128:131], a[100:103], a[36:39], v[128:131]
    s_add_u32 s44, s44, 393216
    v_mfma_f32_16x16x32_bf16 v[132:135], a[96:99], a[40:43], 0
    v_mfma_f32_16x16x32_bf16 v[132:135], a[100:103], a[44:47], v[132:135]
    s_waitcnt vmcnt(11) lgkmcnt(0)
    s_barrier
    v_mfma_f32_16x16x32_bf16 v[136:139], a[0:3], a[104:107], v[136:139]
    ds_read_b128 a[96:99], v16 offset:8192
    ds_read_b64_tr_b16 a[48:49], v20 offset:0
    v_mfma_f32_16x16x32_bf16 v[136:139], a[4:7], a[108:111], v[136:139]
    ds_read_b128 a[100:103], v17 offset:8192
    s_add_u32 m0, s45, 40960
    v_mfma_f32_16x16x32_bf16 v[140:143], a[8:11], a[104:107], v[140:143]
    buffer_load_dwordx4 v6, s[16:19], s72 offen lds
    v_mfma_f32_16x16x32_bf16 v[140:143], a[12:15], a[108:111], v[140:143]
    ds_read_b64_tr_b16 a[50:51], v20 offset:512
    ds_read_b64_tr_b16 a[52:53], v20 offset:4096
    v_mfma_f32_16x16x32_bf16 v[144:147], a[104:107], a[16:19], v[144:147]
    v_mfma_f32_16x16x32_bf16 v[144:147], a[108:111], a[20:23], v[144:147]
    buffer_load_dwordx4 v7, s[16:19], s72 offen offset:1024 lds
    v_mfma_f32_16x16x32_bf16 v[148:151], a[104:107], a[24:27], v[148:151]
    ds_read_b64_tr_b16 a[54:55], v20 offset:4608
    ds_read_b64_tr_b16 a[56:57], v21 offset:0
    v_mfma_f32_16x16x32_bf16 v[148:151], a[108:111], a[28:31], v[148:151]
    v_mfma_f32_16x16x32_bf16 v[152:155], a[104:107], a[32:35], 0
    buffer_load_dwordx4 v8, s[16:19], s72 offen offset:2048 lds
    v_mfma_f32_16x16x32_bf16 v[152:155], a[108:111], a[36:39], v[152:155]
    ds_read_b64_tr_b16 a[58:59], v21 offset:512
    v_mfma_f32_16x16x32_bf16 v[156:159], a[104:107], a[40:43], 0
    ds_read_b64_tr_b16 a[60:61], v21 offset:4096
    v_mfma_f32_16x16x32_bf16 v[156:159], a[108:111], a[44:47], v[156:159]
    ds_read_b64_tr_b16 a[62:63], v21 offset:4608
    s_waitcnt lgkmcnt(7)
    v_mfma_f32_16x16x32_bf16 v[160:163], a[0:3], a[96:99], v[160:163]
    ds_read_b128 a[104:107], v16 offset:10240
    v_mfma_f32_16x16x32_bf16 v[160:163], a[4:7], a[100:103], v[160:163]
    ds_read_b128 a[108:111], v17 offset:10240
    ds_read_b64_tr_b16 a[64:65], v20 offset:8192
    v_mfma_f32_16x16x32_bf16 v[164:167], a[8:11], a[96:99], v[164:167]
    buffer_load_dwordx4 v9, s[16:19], s72 offen offset:3072 lds
    v_mfma_f32_16x16x32_bf16 v[164:167], a[12:15], a[100:103], v[164:167]
    s_add_u32 s72, s72, 128
    s_add_u32 m0, s45, 0
    v_mfma_f32_16x16x32_bf16 v[168:171], a[96:99], a[16:19], v[168:171]
    buffer_load_dwordx4 v2, s[16:19], s43 offen lds
    v_mfma_f32_16x16x32_bf16 v[168:171], a[100:103], a[20:23], v[168:171]
    ds_read_b64_tr_b16 a[66:67], v20 offset:8704
    ds_read_b64_tr_b16 a[68:69], v20 offset:12288
    v_mfma_f32_16x16x32_bf16 v[172:175], a[96:99], a[24:27], v[172:175]
    ds_read_b64_tr_b16 a[70:71], v20 offset:12800
    v_mfma_f32_16x16x32_bf16 v[172:175], a[100:103], a[28:31], v[172:175]
    buffer_load_dwordx4 v3, s[16:19], s43 offen offset:1024 lds
    v_mfma_f32_16x16x32_bf16 v[176:179], a[96:99], a[32:35], 0
    ds_read_b64_tr_b16 a[72:73], v21 offset:8192
    v_mfma_f32_16x16x32_bf16 v[176:179], a[100:103], a[36:39], v[176:179]
    ds_read_b64_tr_b16 a[74:75], v21 offset:8704
    v_mfma_f32_16x16x32_bf16 v[180:183], a[96:99], a[40:43], 0
    buffer_load_dwordx4 v4, s[16:19], s43 offen offset:2048 lds
    v_mfma_f32_16x16x32_bf16 v[180:183], a[100:103], a[44:47], v[180:183]
    ds_read_b64_tr_b16 a[76:77], v21 offset:12288
    s_waitcnt lgkmcnt(7)
    v_mfma_f32_16x16x32_bf16 v[184:187], a[0:3], a[104:107], v[184:187]
    ds_read_b128 a[96:99], v16 offset:12288
    v_mfma_f32_16x16x32_bf16 v[184:187], a[4:7], a[108:111], v[184:187]
    ds_read_b128 a[100:103], v17 offset:12288
    ds_read_b64_tr_b16 a[78:79], v21 offset:12800
    v_mfma_f32_16x16x32_bf16 v[188:191], a[8:11], a[104:107], v[188:191]
    buffer_load_dwordx4 v5, s[16:19], s43 offen offset:3072 lds
    v_mfma_f32_16x16x32_bf16 v[188:191], a[12:15], a[108:111], v[188:191]
    s_add_u32 s43, s43, 128
    s_add_u32 m0, s49, 65536
    v_mfma_f32_16x16x32_bf16 v[192:195], a[104:107], a[16:19], v[192:195]
    buffer_load_dwordx4 v10, s[20:23], s44 offen lds
    v_mfma_f32_16x16x32_bf16 v[192:195], a[108:111], a[20:23], v[192:195]
    ds_read_b64_tr_b16 a[80:81], v20 offset:16384
    ds_read_b64_tr_b16 a[82:83], v20 offset:16896
    v_mfma_f32_16x16x32_bf16 v[196:199], a[104:107], a[24:27], v[196:199]
    ds_read_b64_tr_b16 a[84:85], v20 offset:20480
    v_mfma_f32_16x16x32_bf16 v[196:199], a[108:111], a[28:31], v[196:199]
    ds_read_b64_tr_b16 a[86:87], v20 offset:20992
    v_mfma_f32_16x16x32_bf16 v[200:203], a[104:107], a[32:35], 0
    buffer_load_dwordx4 v11, s[20:23], s44 offen offset:1024 lds
    v_mfma_f32_16x16x32_bf16 v[200:203], a[108:111], a[36:39], v[200:203]
    ds_read_b64_tr_b16 a[88:89], v21 offset:16384
    v_mfma_f32_16x16x32_bf16 v[204:207], a[104:107], a[40:43], 0
    v_mfma_f32_16x16x32_bf16 v[204:207], a[108:111], a[44:47], v[204:207]
    ds_read_b64_tr_b16 a[90:91], v21 offset:16896
    s_waitcnt lgkmcnt(7)
    v_mfma_f32_16x16x32_bf16 v[208:211], a[0:3], a[96:99], v[208:211]
    ds_read_b128 a[104:107], v16 offset:14336
    ds_read_b64_tr_b16 a[92:93], v21 offset:20480
    v_mfma_f32_16x16x32_bf16 v[208:211], a[4:7], a[100:103], v[208:211]
    ds_read_b128 a[108:111], v17 offset:14336
    v_mfma_f32_16x16x32_bf16 v[212:215], a[8:11], a[96:99], v[212:215]
    buffer_load_dwordx4 v12, s[20:23], s44 offen offset:2048 lds
    v_mfma_f32_16x16x32_bf16 v[212:215], a[12:15], a[100:103], v[212:215]
    buffer_load_dwordx4 v13, s[20:23], s44 offen offset:3072 lds
    v_mfma_f32_16x16x32_bf16 v[216:219], a[96:99], a[16:19], v[216:219]
    ds_read_b64_tr_b16 a[94:95], v21 offset:20992
    v_mfma_f32_16x16x32_bf16 v[216:219], a[100:103], a[20:23], v[216:219]
    s_add_u32 m0, s49, 69632
    v_mfma_f32_16x16x32_bf16 v[220:223], a[96:99], a[24:27], v[220:223]
    buffer_load_dwordx4 v14, s[20:23], s44 offen lds
    v_mfma_f32_16x16x32_bf16 v[220:223], a[100:103], a[28:31], v[220:223]
    v_mfma_f32_16x16x32_bf16 v[224:227], a[96:99], a[32:35], 0
    v_mfma_f32_16x16x32_bf16 v[224:227], a[100:103], a[36:39], v[224:227]
    buffer_load_dwordx4 v15, s[20:23], s44 offen offset:1024 lds
    v_mfma_f32_16x16x32_bf16 v[228:231], a[96:99], a[40:43], 0
    s_add_u32 s44, s44, 393216
    v_mfma_f32_16x16x32_bf16 v[228:231], a[100:103], a[44:47], v[228:231]
K_W0:
    s_waitcnt vmcnt(10) lgkmcnt(0)
    s_barrier
    v_mfma_f32_16x16x32_bf16 v[232:235], a[0:3], a[104:107], v[232:235]
    ds_read_b128 a[96:99], v16 offset:32768
    s_and_b32 s56, s2, 7
    v_mfma_f32_16x16x32_bf16 v[232:235], a[4:7], a[108:111], v[232:235]
    ds_read_b128 a[100:103], v17 offset:32768
    s_add_u32 m0, s45, 8192
    v_mfma_f32_16x16x32_bf16 v[236:239], a[8:11], a[104:107], v[236:239]
    buffer_load_dwordx4 v6, s[16:19], s72 offen lds
    v_mfma_f32_16x16x32_bf16 v[236:239], a[12:15], a[108:111], v[236:239]
    s_lshr_b32 s57, s2, 3
    v_mfma_f32_16x16x32_bf16 v[240:243], a[104:107], a[16:19], v[240:243]
    s_and_b32 s50, s56, 3
    v_mfma_f32_16x16x32_bf16 v[240:243], a[108:111], a[20:23], v[240:243]
    v_mfma_f32_16x16x32_bf16 v[244:247], a[104:107], a[24:27], v[244:247]
    v_mfma_f32_16x16x32_bf16 v[244:247], a[108:111], a[28:31], v[244:247]
    s_lshl_b32 s50, s50, 2
    v_mfma_f32_16x16x32_bf16 v[248:251], a[104:107], a[32:35], 0
    buffer_load_dwordx4 v7, s[16:19], s72 offen offset:1024 lds
    v_mfma_f32_16x16x32_bf16 v[248:251], a[108:111], a[36:39], v[248:251]
    s_and_b32 s58, s57, 3
    v_mfma_f32_16x16x32_bf16 v[252:255], a[104:107], a[40:43], 0
    v_mfma_f32_16x16x32_bf16 v[252:255], a[108:111], a[44:47], v[252:255]
    s_add_u32 s50, s50, s58
    s_waitcnt lgkmcnt(0)
    v_mfma_f32_16x16x32_bf16 v[64:67], a[48:51], a[96:99], v[64:67]
    ds_read_b128 a[104:107], v16 offset:34816
    ds_read_b64_tr_b16 a[0:1], v22 offset:0
    v_mfma_f32_16x16x32_bf16 v[64:67], a[52:55], a[100:103], v[64:67]
    ds_read_b128 a[108:111], v17 offset:34816
    v_mfma_f32_16x16x32_bf16 v[68:71], a[56:59], a[96:99], v[68:71]
    buffer_load_dwordx4 v8, s[16:19], s72 offen offset:2048 lds
    v_mfma_f32_16x16x32_bf16 v[68:71], a[60:63], a[100:103], v[68:71]
    ds_read_b64_tr_b16 a[2:3], v22 offset:512
    s_lshr_b32 s51, s56, 2
    v_mfma_f32_16x16x32_bf16 v[72:75], a[96:99], a[64:67], v[72:75]
    s_lshl_b32 s51, s51, 3
    v_mfma_f32_16x16x32_bf16 v[72:75], a[100:103], a[68:71], v[72:75]
    v_mfma_f32_16x16x32_bf16 v[76:79], a[96:99], a[72:75], v[76:79]
    ds_read_b64_tr_b16 a[4:5], v22 offset:4096
    s_lshr_b32 s58, s57, 2
    v_mfma_f32_16x16x32_bf16 v[76:79], a[100:103], a[76:79], v[76:79]
    v_mfma_f32_16x16x32_bf16 v[80:83], a[96:99], a[80:83], v[80:83]
    buffer_load_dwordx4 v9, s[16:19], s72 offen offset:3072 lds
    v_mfma_f32_16x16x32_bf16 v[80:83], a[100:103], a[84:87], v[80:83]
    s_add_u32 s72, s72, 128
    ds_read_b64_tr_b16 a[6:7], v22 offset:4608
    v_mfma_f32_16x16x32_bf16 v[84:87], a[96:99], a[88:91], v[84:87]
    s_add_u32 s51, s51, s58
    v_mfma_f32_16x16x32_bf16 v[84:87], a[100:103], a[92:95], v[84:87]
    s_waitcnt lgkmcnt(3)
    v_mfma_f32_16x16x32_bf16 v[88:91], a[48:51], a[104:107], v[88:91]
    ds_read_b128 a[96:99], v16 offset:36864
    ds_read_b64_tr_b16 a[8:9], v23 offset:0
    v_mfma_f32_16x16x32_bf16 v[88:91], a[52:55], a[108:111], v[88:91]
    ds_read_b128 a[100:103], v17 offset:36864
    s_add_u32 m0, s49, 90112
    v_mfma_f32_16x16x32_bf16 v[92:95], a[56:59], a[104:107], v[92:95]
    buffer_load_dwordx4 v10, s[20:23], s44 offen lds
    v_mfma_f32_16x16x32_bf16 v[92:95], a[60:63], a[108:111], v[92:95]
    ds_read_b64_tr_b16 a[10:11], v23 offset:512
    v_mfma_f32_16x16x32_bf16 v[96:99], a[104:107], a[64:67], v[96:99]
    s_cmp_lt_u32 s38, 2
    s_cselect_b32 s80, s74, s76
    s_cselect_b32 s81, s75, s77
    v_mfma_f32_16x16x32_bf16 v[96:99], a[108:111], a[68:71], v[96:99]
    s_and_b32 s81, s81, 0xffff
    s_mov_b32 s82, 2097152
    v_mfma_f32_16x16x32_bf16 v[100:103], a[104:107], a[72:75], v[100:103]
    s_mov_b32 s83, 0x00020000
    v_mfma_f32_16x16x32_bf16 v[100:103], a[108:111], a[76:79], v[100:103]
    ds_read_b64_tr_b16 a[12:13], v23 offset:4096
    v_mfma_f32_16x16x32_bf16 v[104:107], a[104:107], a[80:83], v[104:107]
    buffer_load_dwordx4 v11, s[20:23], s44 offen offset:1024 lds
    v_mfma_f32_16x16x32_bf16 v[104:107], a[108:111], a[84:87], v[104:107]
    s_lshl_b32 s52, s39, 20
    v_mfma_f32_16x16x32_bf16 v[108:111], a[104:107], a[88:91], v[108:111]
    ds_read_b64_tr_b16 a[14:15], v23 offset:4608
    v_mfma_f32_16x16x32_bf16 v[108:111], a[108:111], a[92:95], v[108:111]
    s_lshl_b32 s56, s51, 7
    s_waitcnt lgkmcnt(3)
    v_mfma_f32_16x16x32_bf16 v[112:115], a[48:51], a[96:99], v[112:115]
    ds_read_b128 a[104:107], v16 offset:38912
    v_mfma_f32_16x16x32_bf16 v[112:115], a[52:55], a[100:103], v[112:115]
    ds_read_b128 a[108:111], v17 offset:38912
    ds_read_b64_tr_b16 a[16:17], v22 offset:8192
    v_mfma_f32_16x16x32_bf16 v[116:119], a[56:59], a[96:99], v[116:119]
    buffer_load_dwordx4 v12, s[20:23], s44 offen offset:2048 lds
    v_mfma_f32_16x16x32_bf16 v[116:119], a[60:63], a[100:103], v[116:119]
    s_add_u32 s52, s52, s56
    v_mfma_f32_16x16x32_bf16 v[120:123], a[96:99], a[64:67], v[120:123]
    ds_read_b64_tr_b16 a[18:19], v22 offset:8704
    s_lshl_b32 s53, s50, 19
    v_mfma_f32_16x16x32_bf16 v[120:123], a[100:103], a[68:71], v[120:123]
    v_mfma_f32_16x16x32_bf16 v[124:127], a[96:99], a[72:75], v[124:127]
    s_lshl_b32 s56, s38, 17
    v_mfma_f32_16x16x32_bf16 v[124:127], a[100:103], a[76:79], v[124:127]
    ds_read_b64_tr_b16 a[20:21], v22 offset:12288
    v_mfma_f32_16x16x32_bf16 v[128:131], a[96:99], a[80:83], v[128:131]
    buffer_load_dwordx4 v13, s[20:23], s44 offen offset:3072 lds
    v_mfma_f32_16x16x32_bf16 v[128:131], a[100:103], a[84:87], v[128:131]
    s_add_u32 s53, s53, s56
    v_mfma_f32_16x16x32_bf16 v[132:135], a[96:99], a[88:91], v[132:135]
    ds_read_b64_tr_b16 a[22:23], v22 offset:12800
    v_mfma_f32_16x16x32_bf16 v[132:135], a[100:103], a[92:95], v[132:135]
    s_lshl_b32 s56, s50, 9
    s_waitcnt lgkmcnt(4)
    v_mfma_f32_16x16x32_bf16 v[136:139], a[48:51], a[104:107], v[136:139]
    ds_read_b128 a[96:99], v16 offset:40960
    v_mfma_f32_16x16x32_bf16 v[136:139], a[52:55], a[108:111], v[136:139]
    ds_read_b128 a[100:103], v17 offset:40960
    s_add_u32 m0, s49, 94208
    v_mfma_f32_16x16x32_bf16 v[140:143], a[56:59], a[104:107], v[140:143]
    buffer_load_dwordx4 v14, s[20:23], s44 offen lds
    v_mfma_f32_16x16x32_bf16 v[140:143], a[60:63], a[108:111], v[140:143]
    ds_read_b64_tr_b16 a[24:25], v23 offset:8192
    s_lshl_b32 s57, s38, 7
    v_mfma_f32_16x16x32_bf16 v[144:147], a[104:107], a[64:67], v[144:147]
    s_add_u32 s56, s56, s57
    v_mfma_f32_16x16x32_bf16 v[144:147], a[108:111], a[68:71], v[144:147]
    ds_read_b64_tr_b16 a[26:27], v23 offset:8704
    v_mfma_f32_16x16x32_bf16 v[148:151], a[104:107], a[72:75], v[148:151]
    s_add_u32 s54, s56, 12582912
    v_mfma_f32_16x16x32_bf16 v[148:151], a[108:111], a[76:79], v[148:151]
    v_mfma_f32_16x16x32_bf16 v[152:155], a[104:107], a[80:83], v[152:155]
    buffer_load_dwordx4 v15, s[20:23], s44 offen offset:1024 lds
    v_mfma_f32_16x16x32_bf16 v[152:155], a[108:111], a[84:87], v[152:155]
    s_add_u32 s44, s44, 393216
    ds_read_b64_tr_b16 a[28:29], v23 offset:12288
    v_mfma_f32_16x16x32_bf16 v[156:159], a[104:107], a[88:91], v[156:159]
    v_lshrrev_b32 v48, 3, v1
    v_and_b32 v49, 7, v1
    v_mfma_f32_16x16x32_bf16 v[156:159], a[108:111], a[92:95], v[156:159]
    ds_read_b64_tr_b16 a[30:31], v23 offset:12800
    s_waitcnt lgkmcnt(4)
    v_mfma_f32_16x16x32_bf16 v[160:163], a[48:51], a[96:99], v[160:163]
    ds_read_b128 a[104:107], v16 offset:43008
    v_mfma_f32_16x16x32_bf16 v[160:163], a[52:55], a[100:103], v[160:163]
    ds_read_b128 a[108:111], v17 offset:43008
    v_bfe_u32 v50, v1, 4, 1
    v_mfma_f32_16x16x32_bf16 v[164:167], a[56:59], a[96:99], v[164:167]
    s_mov_b32 exec_lo, 0xc000c0
    s_mov_b32 exec_hi, 0
    buffer_load_dword v39, v38, s[16:19], s60 offen
    s_mov_b64 exec, -1
    v_mfma_f32_16x16x32_bf16 v[164:167], a[60:63], a[100:103], v[164:167]
    ds_read_b64_tr_b16 a[32:33], v22 offset:16384
    v_lshlrev_b32 v50, 2, v50
    v_mfma_f32_16x16x32_bf16 v[168:171], a[96:99], a[64:67], v[168:171]
    v_mfma_f32_16x16x32_bf16 v[168:171], a[100:103], a[68:71], v[168:171]
    ds_read_b64_tr_b16 a[34:35], v22 offset:16896
    v_mfma_f32_16x16x32_bf16 v[172:175], a[96:99], a[72:75], v[172:175]
    v_xor_b32 v49, v49, v50
    v_mfma_f32_16x16x32_bf16 v[172:175], a[100:103], a[76:79], v[172:175]
    v_mfma_f32_16x16x32_bf16 v[176:179], a[96:99], a[80:83], v[176:179]
    s_mov_b64 exec, 0x3f
    buffer_load_dword v39, v38, s[84:87], s73 offen
    s_mov_b64 exec, -1
    s_add_u32 s73, s73, 393216
    v_mfma_f32_16x16x32_bf16 v[176:179], a[100:103], a[84:87], v[176:179]
    ds_read_b64_tr_b16 a[36:37], v22 offset:20480
    v_bfe_u32 v50, v1, 5, 1
    v_mfma_f32_16x16x32_bf16 v[180:183], a[96:99], a[88:91], v[180:183]
    v_lshlrev_b32 v50, 1, v50
    v_mfma_f32_16x16x32_bf16 v[180:183], a[100:103], a[92:95], v[180:183]
    s_waitcnt lgkmcnt(3)
    v_mfma_f32_16x16x32_bf16 v[184:187], a[48:51], a[104:107], v[184:187]
    ds_read_b128 a[96:99], v16 offset:45056
    ds_read_b64_tr_b16 a[38:39], v22 offset:20992
    v_mfma_f32_16x16x32_bf16 v[184:187], a[52:55], a[108:111], v[184:187]
    ds_read_b128 a[100:103], v17 offset:45056
    v_xor_b32 v49, v49, v50
    v_mfma_f32_16x16x32_bf16 v[188:191], a[56:59], a[104:107], v[188:191]
    v_mfma_f32_16x16x32_bf16 v[188:191], a[60:63], a[108:111], v[188:191]
    ds_read_b64_tr_b16 a[40:41], v23 offset:16384
    v_lshlrev_b32 v49, 4, v49
    v_mfma_f32_16x16x32_bf16 v[192:195], a[104:107], a[64:67], v[192:195]
    v_mfma_f32_16x16x32_bf16 v[192:195], a[108:111], a[68:71], v[192:195]
    v_lshl_add_u32 v40, v48, 11, v49
    v_mfma_f32_16x16x32_bf16 v[196:199], a[104:107], a[72:75], v[196:199]
    ds_read_b64_tr_b16 a[42:43], v23 offset:16896
    v_mfma_f32_16x16x32_bf16 v[196:199], a[108:111], a[76:79], v[196:199]
    v_mfma_f32_16x16x32_bf16 v[200:203], a[104:107], a[80:83], v[200:203]
    v_add_u32 v41, 15360, v40
    v_mfma_f32_16x16x32_bf16 v[200:203], a[108:111], a[84:87], v[200:203]
    ds_read_b64_tr_b16 a[44:45], v23 offset:20480
    v_mfma_f32_16x16x32_bf16 v[204:207], a[104:107], a[88:91], v[204:207]
    v_add_u32 v42, 30720, v40
    v_mfma_f32_16x16x32_bf16 v[204:207], a[108:111], a[92:95], v[204:207]
    s_waitcnt lgkmcnt(3)
    v_mfma_f32_16x16x32_bf16 v[208:211], a[48:51], a[96:99], v[208:211]
    ds_read_b128 a[104:107], v16 offset:47104
    ds_read_b64_tr_b16 a[46:47], v23 offset:20992
    v_mfma_f32_16x16x32_bf16 v[208:211], a[52:55], a[100:103], v[208:211]
    ds_read_b128 a[108:111], v17 offset:47104
    v_add_u32 v43, 46080, v40
    v_mfma_f32_16x16x32_bf16 v[212:215], a[56:59], a[96:99], v[212:215]
    v_mfma_f32_16x16x32_bf16 v[212:215], a[60:63], a[100:103], v[212:215]
    s_mul_i32 s64, s38, 6144
    v_mfma_f32_16x16x32_bf16 v[216:219], a[96:99], a[64:67], v[216:219]
    v_mfma_f32_16x16x32_bf16 v[216:219], a[100:103], a[68:71], v[216:219]
    s_add_u32 s64, s64, 139264
    v_mfma_f32_16x16x32_bf16 v[220:223], a[96:99], a[72:75], v[220:223]
    v_mfma_f32_16x16x32_bf16 v[220:223], a[100:103], a[76:79], v[220:223]
    v_mfma_f32_16x16x32_bf16 v[224:227], a[96:99], a[80:83], v[224:227]
    v_mfma_f32_16x16x32_bf16 v[224:227], a[100:103], a[84:87], v[224:227]
    v_mfma_f32_16x16x32_bf16 v[228:231], a[96:99], a[88:91], v[228:231]
    v_mfma_f32_16x16x32_bf16 v[228:231], a[100:103], a[92:95], v[228:231]
K_W1:
    s_waitcnt vmcnt(8) lgkmcnt(0)
    s_barrier
    v_mfma_f32_16x16x32_bf16 v[232:235], a[48:51], a[104:107], v[232:235]
    ds_read_b128 a[96:99], v16 offset:0
    v_lshrrev_b32 v48, 4, v1
    v_mfma_f32_16x16x32_bf16 v[232:235], a[52:55], a[108:111], v[232:235]
    ds_read_b128 a[100:103], v17 offset:0
    s_add_u32 m0, s45, 32768
    v_mfma_f32_16x16x32_bf16 v[236:239], a[56:59], a[104:107], v[236:239]
    buffer_load_dwordx4 v2, s[16:19], s43 offen lds
    v_mfma_f32_16x16x32_bf16 v[236:239], a[60:63], a[108:111], v[236:239]
    v_mfma_f32_16x16x32_bf16 v[240:243], a[104:107], a[64:67], v[240:243]
    v_bfe_u32 v49, v1, 2, 2
    v_mfma_f32_16x16x32_bf16 v[240:243], a[108:111], a[68:71], v[240:243]
    v_mfma_f32_16x16x32_bf16 v[244:247], a[104:107], a[72:75], v[244:247]
    v_mfma_f32_16x16x32_bf16 v[244:247], a[108:111], a[76:79], v[244:247]
    buffer_load_dwordx4 v3, s[16:19], s43 offen offset:1024 lds
    v_mfma_f32_16x16x32_bf16 v[248:251], a[104:107], a[80:83], v[248:251]
    v_mfma_f32_16x16x32_bf16 v[248:251], a[108:111], a[84:87], v[248:251]
    v_lshl_add_u32 v50, v48, 2, v49
    v_mfma_f32_16x16x32_bf16 v[252:255], a[104:107], a[88:91], v[252:255]
    v_mfma_f32_16x16x32_bf16 v[252:255], a[108:111], a[92:95], v[252:255]
    s_waitcnt lgkmcnt(0)
    v_mfma_f32_16x16x32_bf16 v[64:67], a[0:3], a[96:99], v[64:67]
    ds_read_b128 a[104:107], v16 offset:2048
    ds_read_b64_tr_b16 a[48:49], v18 offset:0
    v_mfma_f32_16x16x32_bf16 v[64:67], a[4:7], a[100:103], v[64:67]
    ds_read_b128 a[108:111], v17 offset:2048
    v_mfma_f32_16x16x32_bf16 v[68:71], a[8:11], a[96:99], v[68:71]
    buffer_load_dwordx4 v4, s[16:19], s43 offen offset:2048 lds
    v_mfma_f32_16x16x32_bf16 v[68:71], a[12:15], a[100:103], v[68:71]
    ds_read_b64_tr_b16 a[50:51], v18 offset:512
    v_lshlrev_b32 v50, 7, v50
    v_mfma_f32_16x16x32_bf16 v[72:75], a[96:99], a[16:19], v[72:75]
    v_mfma_f32_16x16x32_bf16 v[72:75], a[100:103], a[20:23], v[72:75]
    v_mfma_f32_16x16x32_bf16 v[76:79], a[96:99], a[24:27], v[76:79]
    ds_read_b64_tr_b16 a[52:53], v18 offset:4096
    v_mfma_f32_16x16x32_bf16 v[76:79], a[100:103], a[28:31], v[76:79]
    buffer_load_dwordx4 v5, s[16:19], s43 offen offset:3072 lds
    v_mfma_f32_16x16x32_bf16 v[80:83], a[96:99], a[32:35], v[80:83]
    s_add_u32 s43, s43, 128
    v_bfe_u32 v51, v1, 1, 1
    v_mfma_f32_16x16x32_bf16 v[80:83], a[100:103], a[36:39], v[80:83]
    ds_read_b64_tr_b16 a[54:55], v18 offset:4608
    v_mfma_f32_16x16x32_bf16 v[84:87], a[96:99], a[40:43], v[84:87]
    v_mfma_f32_16x16x32_bf16 v[84:87], a[100:103], a[44:47], v[84:87]
    s_waitcnt lgkmcnt(3)
    v_mfma_f32_16x16x32_bf16 v[88:91], a[0:3], a[104:107], v[88:91]
    ds_read_b128 a[96:99], v16 offset:4096
    s_add_u32 m0, s45, 40960
    v_mfma_f32_16x16x32_bf16 v[88:91], a[4:7], a[108:111], v[88:91]
    ds_read_b128 a[100:103], v17 offset:4096
    ds_read_b64_tr_b16 a[56:57], v19 offset:0
    v_mfma_f32_16x16x32_bf16 v[92:95], a[8:11], a[104:107], v[92:95]
    buffer_load_dwordx4 v6, s[16:19], s72 offen lds
    v_mfma_f32_16x16x32_bf16 v[92:95], a[12:15], a[108:111], v[92:95]
    ds_read_b64_tr_b16 a[58:59], v19 offset:512
    v_and_b32 v52, 2, v49
    v_mfma_f32_16x16x32_bf16 v[96:99], a[104:107], a[16:19], v[96:99]
    v_mfma_f32_16x16x32_bf16 v[96:99], a[108:111], a[20:23], v[96:99]
    v_lshlrev_b32 v52, 1, v52
    v_mfma_f32_16x16x32_bf16 v[100:103], a[104:107], a[24:27], v[100:103]
    v_mfma_f32_16x16x32_bf16 v[100:103], a[108:111], a[28:31], v[100:103]
    buffer_load_dwordx4 v7, s[16:19], s72 offen offset:1024 lds
    v_mfma_f32_16x16x32_bf16 v[104:107], a[104:107], a[32:35], v[104:107]
    ds_read_b64_tr_b16 a[60:61], v19 offset:4096
    v_mfma_f32_16x16x32_bf16 v[104:107], a[108:111], a[36:39], v[104:107]
    v_xor_b32 v51, v51, v52
    v_mfma_f32_16x16x32_bf16 v[108:111], a[104:107], a[40:43], v[108:111]
    ds_read_b64_tr_b16 a[62:63], v19 offset:4608
    v_mfma_f32_16x16x32_bf16 v[108:111], a[108:111], a[44:47], v[108:111]
    s_waitcnt lgkmcnt(4)
    v_mfma_f32_16x16x32_bf16 v[112:115], a[0:3], a[96:99], v[112:115]
    ds_read_b128 a[104:107], v16 offset:6144
    v_mfma_f32_16x16x32_bf16 v[112:115], a[4:7], a[100:103], v[112:115]
    ds_read_b128 a[108:111], v17 offset:6144
    ds_read_b64_tr_b16 a[64:65], v18 offset:8192
    v_mfma_f32_16x16x32_bf16 v[116:119], a[8:11], a[96:99], v[116:119]
    buffer_load_dwordx4 v8, s[16:19], s72 offen offset:2048 lds
    v_mfma_f32_16x16x32_bf16 v[116:119], a[12:15], a[100:103], v[116:119]
    v_and_b32 v52, 1, v48
    v_mfma_f32_16x16x32_bf16 v[120:123], a[96:99], a[16:19], v[120:123]
    ds_read_b64_tr_b16 a[66:67], v18 offset:8704
    v_mfma_f32_16x16x32_bf16 v[120:123], a[100:103], a[20:23], v[120:123]
    v_mfma_f32_16x16x32_bf16 v[124:127], a[96:99], a[24:27], v[124:127]
    buffer_load_dwordx4 v9, s[16:19], s72 offen offset:3072 lds
    v_mfma_f32_16x16x32_bf16 v[124:127], a[100:103], a[28:31], v[124:127]
    s_add_u32 s72, s72, 128
    ds_read_b64_tr_b16 a[68:69], v18 offset:12288
    v_mfma_f32_16x16x32_bf16 v[128:131], a[96:99], a[32:35], v[128:131]
    v_lshlrev_b32 v52, 1, v52
    v_mfma_f32_16x16x32_bf16 v[128:131], a[100:103], a[36:39], v[128:131]
    v_mfma_f32_16x16x32_bf16 v[132:135], a[96:99], a[40:43], v[132:135]
    ds_read_b64_tr_b16 a[70:71], v18 offset:12800
    v_mfma_f32_16x16x32_bf16 v[132:135], a[100:103], a[44:47], v[132:135]
    s_add_u32 m0, s49, 114688
    s_waitcnt lgkmcnt(4)
    v_mfma_f32_16x16x32_bf16 v[136:139], a[0:3], a[104:107], v[136:139]
    ds_read_b128 a[96:99], v16 offset:8192
    v_xor_b32 v51, v51, v52
    v_mfma_f32_16x16x32_bf16 v[136:139], a[4:7], a[108:111], v[136:139]
    ds_read_b128 a[100:103], v17 offset:8192
    v_mfma_f32_16x16x32_bf16 v[140:143], a[8:11], a[104:107], v[140:143]
    buffer_load_dwordx4 v10, s[20:23], s44 offen lds
    v_mfma_f32_16x16x32_bf16 v[140:143], a[12:15], a[108:111], v[140:143]
    ds_read_b64_tr_b16 a[72:73], v19 offset:8192
    v_mfma_f32_16x16x32_bf16 v[144:147], a[104:107], a[16:19], v[144:147]
    v_mfma_f32_16x16x32_bf16 v[144:147], a[108:111], a[20:23], v[144:147]
    ds_read_b64_tr_b16 a[74:75], v19 offset:8704
    v_lshl_add_u32 v50, v51, 4, v50
    v_mfma_f32_16x16x32_bf16 v[148:151], a[104:107], a[24:27], v[148:151]
    buffer_load_dwordx4 v11, s[20:23], s44 offen offset:1024 lds
    v_mfma_f32_16x16x32_bf16 v[148:151], a[108:111], a[28:31], v[148:151]
    v_mfma_f32_16x16x32_bf16 v[152:155], a[104:107], a[32:35], v[152:155]
    ds_read_b64_tr_b16 a[76:77], v19 offset:12288
    v_mfma_f32_16x16x32_bf16 v[152:155], a[108:111], a[36:39], v[152:155]
    v_mfma_f32_16x16x32_bf16 v[156:159], a[104:107], a[40:43], v[156:159]
    v_and_b32 v52, 1, v1
    v_mfma_f32_16x16x32_bf16 v[156:159], a[108:111], a[44:47], v[156:159]
    ds_read_b64_tr_b16 a[78:79], v19 offset:12800
    s_waitcnt lgkmcnt(4)
    v_mfma_f32_16x16x32_bf16 v[160:163], a[0:3], a[96:99], v[160:163]
    ds_read_b128 a[104:107], v16 offset:10240
    v_mfma_f32_16x16x32_bf16 v[160:163], a[4:7], a[100:103], v[160:163]
    ds_read_b128 a[108:111], v17 offset:10240
    v_mfma_f32_16x16x32_bf16 v[164:167], a[8:11], a[96:99], v[164:167]
    buffer_load_dwordx4 v12, s[20:23], s44 offen offset:2048 lds
    v_mfma_f32_16x16x32_bf16 v[164:167], a[12:15], a[100:103], v[164:167]
    ds_read_b64_tr_b16 a[80:81], v18 offset:16384
    v_lshl_add_u32 v50, v52, 3, v50
    v_mfma_f32_16x16x32_bf16 v[168:171], a[96:99], a[16:19], v[168:171]
    v_mfma_f32_16x16x32_bf16 v[168:171], a[100:103], a[20:23], v[168:171]
    buffer_load_dwordx4 v13, s[20:23], s44 offen offset:3072 lds
    v_mfma_f32_16x16x32_bf16 v[172:175], a[96:99], a[24:27], v[172:175]
    ds_read_b64_tr_b16 a[82:83], v18 offset:16896
    v_mfma_f32_16x16x32_bf16 v[172:175], a[100:103], a[28:31], v[172:175]
    v_add_u32 v44, s64, v50
    v_mfma_f32_16x16x32_bf16 v[176:179], a[96:99], a[32:35], v[176:179]
    v_mfma_f32_16x16x32_bf16 v[176:179], a[100:103], a[36:39], v[176:179]
    ds_read_b64_tr_b16 a[84:85], v18 offset:20480
    v_mfma_f32_16x16x32_bf16 v[180:183], a[96:99], a[40:43], v[180:183]
    s_add_u32 m0, s49, 118784
    v_mfma_f32_16x16x32_bf16 v[180:183], a[100:103], a[44:47], v[180:183]
    s_waitcnt lgkmcnt(3)
    v_mfma_f32_16x16x32_bf16 v[184:187], a[0:3], a[104:107], v[184:187]
    ds_read_b128 a[96:99], v16 offset:12288
    ds_read_b64_tr_b16 a[86:87], v18 offset:20992
    v_mfma_f32_16x16x32_bf16 v[184:187], a[4:7], a[108:111], v[184:187]
    ds_read_b128 a[100:103], v17 offset:12288
    v_xor_b32 v45, 32, v44
    v_mfma_f32_16x16x32_bf16 v[188:191], a[8:11], a[104:107], v[188:191]
    buffer_load_dwordx4 v14, s[20:23], s44 offen lds
    v_mfma_f32_16x16x32_bf16 v[188:191], a[12:15], a[108:111], v[188:191]
    ds_read_b64_tr_b16 a[88:89], v19 offset:16384
    v_mfma_f32_16x16x32_bf16 v[192:195], a[104:107], a[16:19], v[192:195]
    v_mfma_f32_16x16x32_bf16 v[192:195], a[108:111], a[20:23], v[192:195]
    buffer_load_dwordx4 v15, s[20:23], s44 offen offset:1024 lds
    v_mfma_f32_16x16x32_bf16 v[196:199], a[104:107], a[24:27], v[196:199]
    s_add_u32 s44, s44, 393216
    ds_read_b64_tr_b16 a[90:91], v19 offset:16896
    v_mfma_f32_16x16x32_bf16 v[196:199], a[108:111], a[28:31], v[196:199]
    v_xor_b32 v46, 64, v44
    v_mfma_f32_16x16x32_bf16 v[200:203], a[104:107], a[32:35], v[200:203]
    v_mfma_f32_16x16x32_bf16 v[200:203], a[108:111], a[36:39], v[200:203]
    ds_read_b64_tr_b16 a[92:93], v19 offset:20480
    v_mfma_f32_16x16x32_bf16 v[204:207], a[104:107], a[40:43], v[204:207]
    v_xor_b32 v47, 96, v44
    v_mfma_f32_16x16x32_bf16 v[204:207], a[108:111], a[44:47], v[204:207]
    s_waitcnt lgkmcnt(3)
    v_mfma_f32_16x16x32_bf16 v[208:211], a[0:3], a[96:99], v[208:211]
    ds_read_b128 a[104:107], v16 offset:14336
    ds_read_b64_tr_b16 a[94:95], v19 offset:20992
    v_mfma_f32_16x16x32_bf16 v[208:211], a[4:7], a[100:103], v[208:211]
    ds_read_b128 a[108:111], v17 offset:14336
    v_mfma_f32_16x16x32_bf16 v[212:215], a[8:11], a[96:99], v[212:215]
    s_mov_b32 exec_lo, 0x3000300
    s_mov_b32 exec_hi, 0
    buffer_load_dword v39, v38, s[16:19], s60 offen
    s_mov_b64 exec, -1
    v_mfma_f32_16x16x32_bf16 v[212:215], a[12:15], a[100:103], v[212:215]
    v_lshlrev_b32 v53, 3, v1
    v_mfma_f32_16x16x32_bf16 v[216:219], a[96:99], a[16:19], v[216:219]
    v_mfma_f32_16x16x32_bf16 v[216:219], a[100:103], a[20:23], v[216:219]
    s_mov_b64 exec, 0x3f
    buffer_load_dword v39, v38, s[84:87], s73 offen
    s_mov_b64 exec, -1
    s_add_u32 s73, s73, 393216
    v_mfma_f32_16x16x32_bf16 v[220:223], a[96:99], a[24:27], v[220:223]
    v_mfma_f32_16x16x32_bf16 v[220:223], a[100:103], a[28:31], v[220:223]
    v_mfma_f32_16x16x32_bf16 v[224:227], a[96:99], a[32:35], v[224:227]
    v_mfma_f32_16x16x32_bf16 v[224:227], a[100:103], a[36:39], v[224:227]
    v_mfma_f32_16x16x32_bf16 v[228:231], a[96:99], a[40:43], v[228:231]
    v_mfma_f32_16x16x32_bf16 v[228:231], a[100:103], a[44:47], v[228:231]
K_W2:
    s_waitcnt vmcnt(8) lgkmcnt(0)
    s_barrier
    v_mfma_f32_16x16x32_bf16 v[232:235], a[0:3], a[104:107], v[232:235]
    ds_read_b128 a[96:99], v16 offset:32768
    v_mfma_f32_16x16x32_bf16 v[232:235], a[4:7], a[108:111], v[232:235]
    ds_read_b128 a[100:103], v17 offset:32768
    s_add_u32 m0, s45, 0
    v_mfma_f32_16x16x32_bf16 v[236:239], a[8:11], a[104:107], v[236:239]
    buffer_load_dwordx4 v2, s[16:19], s43 offen lds
    v_mfma_f32_16x16x32_bf16 v[236:239], a[12:15], a[108:111], v[236:239]
    v_mfma_f32_16x16x32_bf16 v[240:243], a[104:107], a[16:19], v[240:243]
    v_mfma_f32_16x16x32_bf16 v[240:243], a[108:111], a[20:23], v[240:243]
    v_mfma_f32_16x16x32_bf16 v[244:247], a[104:107], a[24:27], v[244:247]
    v_mfma_f32_16x16x32_bf16 v[244:247], a[108:111], a[28:31], v[244:247]
    buffer_load_dwordx4 v3, s[16:19], s43 offen offset:1024 lds
    v_mfma_f32_16x16x32_bf16 v[248:251], a[104:107], a[32:35], v[248:251]
    v_mfma_f32_16x16x32_bf16 v[248:251], a[108:111], a[36:39], v[248:251]
    v_mfma_f32_16x16x32_bf16 v[252:255], a[104:107], a[40:43], v[252:255]
    v_mfma_f32_16x16x32_bf16 v[252:255], a[108:111], a[44:47], v[252:255]
    s_waitcnt lgkmcnt(0)
    v_mfma_f32_16x16x32_bf16 v[64:67], a[48:51], a[96:99], v[64:67]
    ds_read_b128 a[104:107], v16 offset:34816
    ds_read_b64_tr_b16 a[0:1], v20 offset:0
    v_mfma_f32_16x16x32_bf16 v[64:67], a[52:55], a[100:103], v[64:67]
    ds_read_b128 a[108:111], v17 offset:34816
    v_mfma_f32_16x16x32_bf16 v[68:71], a[56:59], a[96:99], v[68:71]
    buffer_load_dwordx4 v4, s[16:19], s43 offen offset:2048 lds
    v_mfma_f32_16x16x32_bf16 v[68:71], a[60:63], a[100:103], v[68:71]
    ds_read_b64_tr_b16 a[2:3], v20 offset:512
    v_mfma_f32_16x16x32_bf16 v[72:75], a[96:99], a[64:67], v[72:75]
    v_mfma_f32_16x16x32_bf16 v[72:75], a[100:103], a[68:71], v[72:75]
    buffer_load_dwordx4 v5, s[16:19], s43 offen offset:3072 lds
    v_mfma_f32_16x16x32_bf16 v[76:79], a[96:99], a[72:75], v[76:79]
    s_add_u32 s43, s43, 128
    ds_read_b64_tr_b16 a[4:5], v20 offset:4096
    v_mfma_f32_16x16x32_bf16 v[76:79], a[100:103], a[76:79], v[76:79]
    v_mfma_f32_16x16x32_bf16 v[80:83], a[96:99], a[80:83], v[80:83]
    v_mfma_f32_16x16x32_bf16 v[80:83], a[100:103], a[84:87], v[80:83]
    s_add_u32 m0, s45, 8192
    ds_read_b64_tr_b16 a[6:7], v20 offset:4608
    v_mfma_f32_16x16x32_bf16 v[84:87], a[96:99], a[88:91], v[84:87]
    buffer_load_dwordx4 v6, s[16:19], s72 offen lds
    v_mfma_f32_16x16x32_bf16 v[84:87], a[100:103], a[92:95], v[84:87]
    s_waitcnt lgkmcnt(3)
    v_mfma_f32_16x16x32_bf16 v[88:91], a[48:51], a[104:107], v[88:91]
    ds_read_b128 a[96:99], v16 offset:36864
    ds_read_b64_tr_b16 a[8:9], v21 offset:0
    v_mfma_f32_16x16x32_bf16 v[88:91], a[52:55], a[108:111], v[88:91]
    ds_read_b128 a[100:103], v17 offset:36864
    v_mfma_f32_16x16x32_bf16 v[92:95], a[56:59], a[104:107], v[92:95]
    v_mfma_f32_16x16x32_bf16 v[92:95], a[60:63], a[108:111], v[92:95]
    buffer_load_dwordx4 v7, s[16:19], s72 offen offset:1024 lds
    v_mfma_f32_16x16x32_bf16 v[96:99], a[104:107], a[64:67], v[96:99]
    ds_read_b64_tr_b16 a[10:11], v21 offset:512
    v_mfma_f32_16x16x32_bf16 v[96:99], a[108:111], a[68:71], v[96:99]
    v_mfma_f32_16x16x32_bf16 v[100:103], a[104:107], a[72:75], v[100:103]
    v_mfma_f32_16x16x32_bf16 v[100:103], a[108:111], a[76:79], v[100:103]
    ds_read_b64_tr_b16 a[12:13], v21 offset:4096
    v_mfma_f32_16x16x32_bf16 v[104:107], a[104:107], a[80:83], v[104:107]
    v_mfma_f32_16x16x32_bf16 v[104:107], a[108:111], a[84:87], v[104:107]
    buffer_load_dwordx4 v8, s[16:19], s72 offen offset:2048 lds
    v_mfma_f32_16x16x32_bf16 v[108:111], a[104:107], a[88:91], v[108:111]
    ds_read_b64_tr_b16 a[14:15], v21 offset:4608
    v_mfma_f32_16x16x32_bf16 v[108:111], a[108:111], a[92:95], v[108:111]
    s_waitcnt lgkmcnt(3)
    v_mfma_f32_16x16x32_bf16 v[112:115], a[48:51], a[96:99], v[112:115]
    ds_read_b128 a[104:107], v16 offset:38912
    v_mfma_f32_16x16x32_bf16 v[112:115], a[52:55], a[100:103], v[112:115]
    ds_read_b128 a[108:111], v17 offset:38912
    ds_read_b64_tr_b16 a[16:17], v20 offset:8192
    v_mfma_f32_16x16x32_bf16 v[116:119], a[56:59], a[96:99], v[116:119]
    buffer_load_dwordx4 v9, s[16:19], s72 offen offset:3072 lds
    v_mfma_f32_16x16x32_bf16 v[116:119], a[60:63], a[100:103], v[116:119]
    s_add_u32 s72, s72, 128
    v_mfma_f32_16x16x32_bf16 v[120:123], a[96:99], a[64:67], v[120:123]
    ds_read_b64_tr_b16 a[18:19], v20 offset:8704
    v_mfma_f32_16x16x32_bf16 v[120:123], a[100:103], a[68:71], v[120:123]
    v_mfma_f32_16x16x32_bf16 v[124:127], a[96:99], a[72:75], v[124:127]
    s_add_u32 m0, s49, 65536
    v_mfma_f32_16x16x32_bf16 v[124:127], a[100:103], a[76:79], v[124:127]
    buffer_load_dwordx4 v10, s[20:23], s44 offen lds
    v_mfma_f32_16x16x32_bf16 v[128:131], a[96:99], a[80:83], v[128:131]
    ds_read_b64_tr_b16 a[20:21], v20 offset:12288
    v_mfma_f32_16x16x32_bf16 v[128:131], a[100:103], a[84:87], v[128:131]
    v_mfma_f32_16x16x32_bf16 v[132:135], a[96:99], a[88:91], v[132:135]
    ds_read_b64_tr_b16 a[22:23], v20 offset:12800
    v_mfma_f32_16x16x32_bf16 v[132:135], a[100:103], a[92:95], v[132:135]
    s_waitcnt lgkmcnt(4)
    v_mfma_f32_16x16x32_bf16 v[136:139], a[48:51], a[104:107], v[136:139]
    ds_read_b128 a[96:99], v16 offset:40960
    v_mfma_f32_16x16x32_bf16 v[136:139], a[52:55], a[108:111], v[136:139]
    ds_read_b128 a[100:103], v17 offset:40960
    v_mfma_f32_16x16x32_bf16 v[140:143], a[56:59], a[104:107], v[140:143]
    buffer_load_dwordx4 v11, s[20:23], s44 offen offset:1024 lds
    v_mfma_f32_16x16x32_bf16 v[140:143], a[60:63], a[108:111], v[140:143]
    ds_read_b64_tr_b16 a[24:25], v21 offset:8192
    v_mfma_f32_16x16x32_bf16 v[144:147], a[104:107], a[64:67], v[144:147]
    v_mfma_f32_16x16x32_bf16 v[144:147], a[108:111], a[68:71], v[144:147]
    buffer_load_dwordx4 v12, s[20:23], s44 offen offset:2048 lds
    v_mfma_f32_16x16x32_bf16 v[148:151], a[104:107], a[72:75], v[148:151]
    ds_read_b64_tr_b16 a[26:27], v21 offset:8704
    v_mfma_f32_16x16x32_bf16 v[148:151], a[108:111], a[76:79], v[148:151]
    v_mfma_f32_16x16x32_bf16 v[152:155], a[104:107], a[80:83], v[152:155]
    ds_read_b64_tr_b16 a[28:29], v21 offset:12288
    v_mfma_f32_16x16x32_bf16 v[152:155], a[108:111], a[84:87], v[152:155]
    v_mfma_f32_16x16x32_bf16 v[156:159], a[104:107], a[88:91], v[156:159]
    buffer_load_dwordx4 v13, s[20:23], s44 offen offset:3072 lds
    v_mfma_f32_16x16x32_bf16 v[156:159], a[108:111], a[92:95], v[156:159]
    ds_read_b64_tr_b16 a[30:31], v21 offset:12800
    s_waitcnt lgkmcnt(4)
    v_mfma_f32_16x16x32_bf16 v[160:163], a[48:51], a[96:99], v[160:163]
    ds_read_b128 a[104:107], v16 offset:43008
    v_mfma_f32_16x16x32_bf16 v[160:163], a[52:55], a[100:103], v[160:163]
    ds_read_b128 a[108:111], v17 offset:43008
    v_mfma_f32_16x16x32_bf16 v[164:167], a[56:59], a[96:99], v[164:167]
    s_add_u32 m0, s49, 69632
    ds_read_b64_tr_b16 a[32:33], v20 offset:16384
    v_mfma_f32_16x16x32_bf16 v[164:167], a[60:63], a[100:103], v[164:167]
    buffer_load_dwordx4 v14, s[20:23], s44 offen lds
    v_mfma_f32_16x16x32_bf16 v[168:171], a[96:99], a[64:67], v[168:171]
    v_mfma_f32_16x16x32_bf16 v[168:171], a[100:103], a[68:71], v[168:171]
    ds_read_b64_tr_b16 a[34:35], v20 offset:16896
    v_mfma_f32_16x16x32_bf16 v[172:175], a[96:99], a[72:75], v[172:175]
    v_mfma_f32_16x16x32_bf16 v[172:175], a[100:103], a[76:79], v[172:175]
    v_mfma_f32_16x16x32_bf16 v[176:179], a[96:99], a[80:83], v[176:179]
    v_mfma_f32_16x16x32_bf16 v[176:179], a[100:103], a[84:87], v[176:179]
    buffer_load_dwordx4 v15, s[20:23], s44 offen offset:1024 lds
    v_mfma_f32_16x16x32_bf16 v[180:183], a[96:99], a[88:91], v[180:183]
    s_add_u32 s44, s44, 393216
    ds_read_b64_tr_b16 a[36:37], v20 offset:20480
    v_mfma_f32_16x16x32_bf16 v[180:183], a[100:103], a[92:95], v[180:183]
    s_waitcnt lgkmcnt(3)
    v_mfma_f32_16x16x32_bf16 v[184:187], a[48:51], a[104:107], v[184:187]
    ds_read_b128 a[96:99], v16 offset:45056
    ds_read_b64_tr_b16 a[38:39], v20 offset:20992
    v_mfma_f32_16x16x32_bf16 v[184:187], a[52:55], a[108:111], v[184:187]
    ds_read_b128 a[100:103], v17 offset:45056
    v_mfma_f32_16x16x32_bf16 v[188:191], a[56:59], a[104:107], v[188:191]
    s_mov_b32 exec_lo, 0xc000c00
    s_mov_b32 exec_hi, 0
    buffer_load_dword v39, v38, s[16:19], s60 offen
    s_mov_b64 exec, -1
    v_mfma_f32_16x16x32_bf16 v[188:191], a[60:63], a[108:111], v[188:191]
    ds_read_b64_tr_b16 a[40:41], v21 offset:16384
    v_mfma_f32_16x16x32_bf16 v[192:195], a[104:107], a[64:67], v[192:195]
    v_mfma_f32_16x16x32_bf16 v[192:195], a[108:111], a[68:71], v[192:195]
    v_mfma_f32_16x16x32_bf16 v[196:199], a[104:107], a[72:75], v[196:199]
    ds_read_b64_tr_b16 a[42:43], v21 offset:16896
    v_mfma_f32_16x16x32_bf16 v[196:199], a[108:111], a[76:79], v[196:199]
    s_mov_b64 exec, 0x3f
    buffer_load_dword v39, v38, s[84:87], s73 offen
    s_mov_b64 exec, -1
    s_add_u32 s73, s73, 393216
    v_mfma_f32_16x16x32_bf16 v[200:203], a[104:107], a[80:83], v[200:203]
    v_mfma_f32_16x16x32_bf16 v[200:203], a[108:111], a[84:87], v[200:203]
    ds_read_b64_tr_b16 a[44:45], v21 offset:20480
    v_mfma_f32_16x16x32_bf16 v[204:207], a[104:107], a[88:91], v[204:207]
    v_mfma_f32_16x16x32_bf16 v[204:207], a[108:111], a[92:95], v[204:207]
    s_add_u32 m0, s64, 0
    s_waitcnt lgkmcnt(3)
    v_mfma_f32_16x16x32_bf16 v[208:211], a[48:51], a[96:99], v[208:211]
    ds_read_b128 a[104:107], v16 offset:47104
    ds_read_b64_tr_b16 a[46:47], v21 offset:20992
    v_mfma_f32_16x16x32_bf16 v[208:211], a[52:55], a[100:103], v[208:211]
    ds_read_b128 a[108:111], v17 offset:47104
    v_mfma_f32_16x16x32_bf16 v[212:215], a[56:59], a[96:99], v[212:215]
    buffer_load_dwordx4 v40, s[80:83], s52 offen lds
    v_mfma_f32_16x16x32_bf16 v[212:215], a[60:63], a[100:103], v[212:215]
    v_mfma_f32_16x16x32_bf16 v[216:219], a[96:99], a[64:67], v[216:219]
    v_mfma_f32_16x16x32_bf16 v[216:219], a[100:103], a[68:71], v[216:219]
    buffer_load_dwordx4 v41, s[80:83], s52 offen offset:1024 lds
    v_mfma_f32_16x16x32_bf16 v[220:223], a[96:99], a[72:75], v[220:223]
    v_mfma_f32_16x16x32_bf16 v[220:223], a[100:103], a[76:79], v[220:223]
    v_mfma_f32_16x16x32_bf16 v[224:227], a[96:99], a[80:83], v[224:227]
    v_mfma_f32_16x16x32_bf16 v[224:227], a[100:103], a[84:87], v[224:227]
    v_mfma_f32_16x16x32_bf16 v[228:231], a[96:99], a[88:91], v[228:231]
    v_mfma_f32_16x16x32_bf16 v[228:231], a[100:103], a[92:95], v[228:231]
K_W3:
    s_waitcnt vmcnt(10) lgkmcnt(0)
    s_barrier
    v_mfma_f32_16x16x32_bf16 v[232:235], a[48:51], a[104:107], v[232:235]
    ds_read_b128 a[96:99], v16 offset:0
    v_mfma_f32_16x16x32_bf16 v[232:235], a[52:55], a[108:111], v[232:235]
    ds_read_b128 a[100:103], v17 offset:0
    s_add_u32 m0, s45, 32768
    v_mfma_f32_16x16x32_bf16 v[236:239], a[56:59], a[104:107], v[236:239]
    buffer_load_dwordx4 v2, s[16:19], s43 offen lds
    v_mfma_f32_16x16x32_bf16 v[236:239], a[60:63], a[108:111], v[236:239]
    v_mfma_f32_16x16x32_bf16 v[240:243], a[104:107], a[64:67], v[240:243]
    v_mfma_f32_16x16x32_bf16 v[240:243], a[108:111], a[68:71], v[240:243]
    v_mfma_f32_16x16x32_bf16 v[244:247], a[104:107], a[72:75], v[244:247]
    v_mfma_f32_16x16x32_bf16 v[244:247], a[108:111], a[76:79], v[244:247]
    buffer_load_dwordx4 v3, s[16:19], s43 offen offset:1024 lds
    v_mfma_f32_16x16x32_bf16 v[248:251], a[104:107], a[80:83], v[248:251]
    v_mfma_f32_16x16x32_bf16 v[248:251], a[108:111], a[84:87], v[248:251]
    v_mfma_f32_16x16x32_bf16 v[252:255], a[104:107], a[88:91], v[252:255]
    v_mfma_f32_16x16x32_bf16 v[252:255], a[108:111], a[92:95], v[252:255]
    s_waitcnt lgkmcnt(0)
    v_mfma_f32_16x16x32_bf16 v[64:67], a[0:3], a[96:99], v[64:67]
    ds_read_b128 a[104:107], v16 offset:2048
    ds_read_b64_tr_b16 a[48:49], v22 offset:0
    v_mfma_f32_16x16x32_bf16 v[64:67], a[4:7], a[100:103], v[64:67]
    ds_read_b128 a[108:111], v17 offset:2048
    v_mfma_f32_16x16x32_bf16 v[68:71], a[8:11], a[96:99], v[68:71]
    buffer_load_dwordx4 v4, s[16:19], s43 offen offset:2048 lds
    v_mfma_f32_16x16x32_bf16 v[68:71], a[12:15], a[100:103], v[68:71]
    ds_read_b64_tr_b16 a[50:51], v22 offset:512
    v_mfma_f32_16x16x32_bf16 v[72:75], a[96:99], a[16:19], v[72:75]
    v_mfma_f32_16x16x32_bf16 v[72:75], a[100:103], a[20:23], v[72:75]
    buffer_load_dwordx4 v5, s[16:19], s43 offen offset:3072 lds
    v_mfma_f32_16x16x32_bf16 v[76:79], a[96:99], a[24:27], v[76:79]
    s_add_u32 s43, s43, 128
    ds_read_b64_tr_b16 a[52:53], v22 offset:4096
    v_mfma_f32_16x16x32_bf16 v[76:79], a[100:103], a[28:31], v[76:79]
    v_mfma_f32_16x16x32_bf16 v[80:83], a[96:99], a[32:35], v[80:83]
    v_mfma_f32_16x16x32_bf16 v[80:83], a[100:103], a[36:39], v[80:83]
    s_add_u32 m0, s45, 40960
    ds_read_b64_tr_b16 a[54:55], v22 offset:4608
    v_mfma_f32_16x16x32_bf16 v[84:87], a[96:99], a[40:43], v[84:87]
    buffer_load_dwordx4 v6, s[16:19], s72 offen lds
    v_mfma_f32_16x16x32_bf16 v[84:87], a[100:103], a[44:47], v[84:87]
    s_waitcnt lgkmcnt(3)
    v_mfma_f32_16x16x32_bf16 v[88:91], a[0:3], a[104:107], v[88:91]
    ds_read_b128 a[96:99], v16 offset:4096
    ds_read_b64_tr_b16 a[56:57], v23 offset:0
    v_mfma_f32_16x16x32_bf16 v[88:91], a[4:7], a[108:111], v[88:91]
    ds_read_b128 a[100:103], v17 offset:4096
    v_mfma_f32_16x16x32_bf16 v[92:95], a[8:11], a[104:107], v[92:95]
    v_mfma_f32_16x16x32_bf16 v[92:95], a[12:15], a[108:111], v[92:95]
    buffer_load_dwordx4 v7, s[16:19], s72 offen offset:1024 lds
    v_mfma_f32_16x16x32_bf16 v[96:99], a[104:107], a[16:19], v[96:99]
    ds_read_b64_tr_b16 a[58:59], v23 offset:512
    v_mfma_f32_16x16x32_bf16 v[96:99], a[108:111], a[20:23], v[96:99]
    v_mfma_f32_16x16x32_bf16 v[100:103], a[104:107], a[24:27], v[100:103]
    v_mfma_f32_16x16x32_bf16 v[100:103], a[108:111], a[28:31], v[100:103]
    ds_read_b64_tr_b16 a[60:61], v23 offset:4096
    v_mfma_f32_16x16x32_bf16 v[104:107], a[104:107], a[32:35], v[104:107]
    v_mfma_f32_16x16x32_bf16 v[104:107], a[108:111], a[36:39], v[104:107]
    buffer_load_dwordx4 v8, s[16:19], s72 offen offset:2048 lds
    v_mfma_f32_16x16x32_bf16 v[108:111], a[104:107], a[40:43], v[108:111]
    ds_read_b64_tr_b16 a[62:63], v23 offset:4608
    v_mfma_f32_16x16x32_bf16 v[108:111], a[108:111], a[44:47], v[108:111]
    s_waitcnt lgkmcnt(3)
    v_mfma_f32_16x16x32_bf16 v[112:115], a[0:3], a[96:99], v[112:115]
    ds_read_b128 a[104:107], v16 offset:6144
    v_mfma_f32_16x16x32_bf16 v[112:115], a[4:7], a[100:103], v[112:115]
    ds_read_b128 a[108:111], v17 offset:6144
    ds_read_b64_tr_b16 a[64:65], v22 offset:8192
    v_mfma_f32_16x16x32_bf16 v[116:119], a[8:11], a[96:99], v[116:119]
    buffer_load_dwordx4 v9, s[16:19], s72 offen offset:3072 lds
    v_mfma_f32_16x16x32_bf16 v[116:119], a[12:15], a[100:103], v[116:119]
    s_add_u32 s72, s72, 128
    v_mfma_f32_16x16x32_bf16 v[120:123], a[96:99], a[16:19], v[120:123]
    ds_read_b64_tr_b16 a[66:67], v22 offset:8704
    v_mfma_f32_16x16x32_bf16 v[120:123], a[100:103], a[20:23], v[120:123]
    v_mfma_f32_16x16x32_bf16 v[124:127], a[96:99], a[24:27], v[124:127]
    s_add_u32 m0, s49, 90112
    v_mfma_f32_16x16x32_bf16 v[124:127], a[100:103], a[28:31], v[124:127]
    buffer_load_dwordx4 v10, s[20:23], s44 offen lds
    v_mfma_f32_16x16x32_bf16 v[128:131], a[96:99], a[32:35], v[128:131]
    ds_read_b64_tr_b16 a[68:69], v22 offset:12288
    v_mfma_f32_16x16x32_bf16 v[128:131], a[100:103], a[36:39], v[128:131]
    v_mfma_f32_16x16x32_bf16 v[132:135], a[96:99], a[40:43], v[132:135]
    ds_read_b64_tr_b16 a[70:71], v22 offset:12800
    v_mfma_f32_16x16x32_bf16 v[132:135], a[100:103], a[44:47], v[132:135]
    s_waitcnt lgkmcnt(4)
    v_mfma_f32_16x16x32_bf16 v[136:139], a[0:3], a[104:107], v[136:139]
    ds_read_b128 a[96:99], v16 offset:8192
    v_mfma_f32_16x16x32_bf16 v[136:139], a[4:7], a[108:111], v[136:139]
    ds_read_b128 a[100:103], v17 offset:8192
    v_mfma_f32_16x16x32_bf16 v[140:143], a[8:11], a[104:107], v[140:143]
    buffer_load_dwordx4 v11, s[20:23], s44 offen offset:1024 lds
    v_mfma_f32_16x16x32_bf16 v[140:143], a[12:15], a[108:111], v[140:143]
    ds_read_b64_tr_b16 a[72:73], v23 offset:8192
    v_mfma_f32_16x16x32_bf16 v[144:147], a[104:107], a[16:19], v[144:147]
    v_mfma_f32_16x16x32_bf16 v[144:147], a[108:111], a[20:23], v[144:147]
    buffer_load_dwordx4 v12, s[20:23], s44 offen offset:2048 lds
    v_mfma_f32_16x16x32_bf16 v[148:151], a[104:107], a[24:27], v[148:151]
    ds_read_b64_tr_b16 a[74:75], v23 offset:8704
    v_mfma_f32_16x16x32_bf16 v[148:151], a[108:111], a[28:31], v[148:151]
    v_mfma_f32_16x16x32_bf16 v[152:155], a[104:107], a[32:35], v[152:155]
    ds_read_b64_tr_b16 a[76:77], v23 offset:12288
    v_mfma_f32_16x16x32_bf16 v[152:155], a[108:111], a[36:39], v[152:155]
    v_mfma_f32_16x16x32_bf16 v[156:159], a[104:107], a[40:43], v[156:159]
    buffer_load_dwordx4 v13, s[20:23], s44 offen offset:3072 lds
    v_mfma_f32_16x16x32_bf16 v[156:159], a[108:111], a[44:47], v[156:159]
    ds_read_b64_tr_b16 a[78:79], v23 offset:12800
    s_waitcnt lgkmcnt(4)
    v_mfma_f32_16x16x32_bf16 v[160:163], a[0:3], a[96:99], v[160:163]
    ds_read_b128 a[104:107], v16 offset:10240
    v_mfma_f32_16x16x32_bf16 v[160:163], a[4:7], a[100:103], v[160:163]
    ds_read_b128 a[108:111], v17 offset:10240
    v_mfma_f32_16x16x32_bf16 v[164:167], a[8:11], a[96:99], v[164:167]
    s_add_u32 m0, s49, 94208
    ds_read_b64_tr_b16 a[80:81], v22 offset:16384
    v_mfma_f32_16x16x32_bf16 v[164:167], a[12:15], a[100:103], v[164:167]
    buffer_load_dwordx4 v14, s[20:23], s44 offen lds
    v_mfma_f32_16x16x32_bf16 v[168:171], a[96:99], a[16:19], v[168:171]
    v_mfma_f32_16x16x32_bf16 v[168:171], a[100:103], a[20:23], v[168:171]
    ds_read_b64_tr_b16 a[82:83], v22 offset:16896
    v_mfma_f32_16x16x32_bf16 v[172:175], a[96:99], a[24:27], v[172:175]
    v_mfma_f32_16x16x32_bf16 v[172:175], a[100:103], a[28:31], v[172:175]
    v_mfma_f32_16x16x32_bf16 v[176:179], a[96:99], a[32:35], v[176:179]
    v_mfma_f32_16x16x32_bf16 v[176:179], a[100:103], a[36:39], v[176:179]
    buffer_load_dwordx4 v15, s[20:23], s44 offen offset:1024 lds
    v_mfma_f32_16x16x32_bf16 v[180:183], a[96:99], a[40:43], v[180:183]
    s_add_u32 s44, s44, 393216
    ds_read_b64_tr_b16 a[84:85], v22 offset:20480
    v_mfma_f32_16x16x32_bf16 v[180:183], a[100:103], a[44:47], v[180:183]
    s_waitcnt lgkmcnt(3)
    v_mfma_f32_16x16x32_bf16 v[184:187], a[0:3], a[104:107], v[184:187]
    ds_read_b128 a[96:99], v16 offset:12288
    ds_read_b64_tr_b16 a[86:87], v22 offset:20992
    v_mfma_f32_16x16x32_bf16 v[184:187], a[4:7], a[108:111], v[184:187]
    ds_read_b128 a[100:103], v17 offset:12288
    v_mfma_f32_16x16x32_bf16 v[188:191], a[8:11], a[104:107], v[188:191]
    s_mov_b32 exec_lo, 0x30003000
    s_mov_b32 exec_hi, 0
    buffer_load_dword v39, v38, s[16:19], s60 offen
    s_mov_b64 exec, -1
    v_mfma_f32_16x16x32_bf16 v[188:191], a[12:15], a[108:111], v[188:191]
    ds_read_b64_tr_b16 a[88:89], v23 offset:16384
    v_mfma_f32_16x16x32_bf16 v[192:195], a[104:107], a[16:19], v[192:195]
    v_mfma_f32_16x16x32_bf16 v[192:195], a[108:111], a[20:23], v[192:195]
    v_mfma_f32_16x16x32_bf16 v[196:199], a[104:107], a[24:27], v[196:199]
    ds_read_b64_tr_b16 a[90:91], v23 offset:16896
    v_mfma_f32_16x16x32_bf16 v[196:199], a[108:111], a[28:31], v[196:199]
    s_mov_b64 exec, 0x3f
    buffer_load_dword v39, v38, s[84:87], s73 offen
    s_mov_b64 exec, -1
    s_add_u32 s73, s73, 393216
    v_mfma_f32_16x16x32_bf16 v[200:203], a[104:107], a[32:35], v[200:203]
    v_mfma_f32_16x16x32_bf16 v[200:203], a[108:111], a[36:39], v[200:203]
    ds_read_b64_tr_b16 a[92:93], v23 offset:20480
    v_mfma_f32_16x16x32_bf16 v[204:207], a[104:107], a[40:43], v[204:207]
    v_mfma_f32_16x16x32_bf16 v[204:207], a[108:111], a[44:47], v[204:207]
    s_add_u32 m0, s64, 0
    s_waitcnt lgkmcnt(3)
    v_mfma_f32_16x16x32_bf16 v[208:211], a[0:3], a[96:99], v[208:211]
    ds_read_b128 a[104:107], v16 offset:14336
    ds_read_b64_tr_b16 a[94:95], v23 offset:20992
    v_mfma_f32_16x16x32_bf16 v[208:211], a[4:7], a[100:103], v[208:211]
    ds_read_b128 a[108:111], v17 offset:14336
    v_mfma_f32_16x16x32_bf16 v[212:215], a[8:11], a[96:99], v[212:215]
    buffer_load_dwordx4 v42, s[80:83], s52 offen offset:2048 lds
    v_mfma_f32_16x16x32_bf16 v[212:215], a[12:15], a[100:103], v[212:215]
    v_mfma_f32_16x16x32_bf16 v[216:219], a[96:99], a[16:19], v[216:219]
    v_mfma_f32_16x16x32_bf16 v[216:219], a[100:103], a[20:23], v[216:219]
    buffer_load_dwordx4 v43, s[80:83], s52 offen offset:3072 lds
    v_mfma_f32_16x16x32_bf16 v[220:223], a[96:99], a[24:27], v[220:223]
    s_add_u32 s52, s52, 65536
    v_mfma_f32_16x16x32_bf16 v[220:223], a[100:103], a[28:31], v[220:223]
    v_mfma_f32_16x16x32_bf16 v[224:227], a[96:99], a[32:35], v[224:227]
    v_mfma_f32_16x16x32_bf16 v[224:227], a[100:103], a[36:39], v[224:227]
    v_mfma_f32_16x16x32_bf16 v[228:231], a[96:99], a[40:43], v[228:231]
    v_mfma_f32_16x16x32_bf16 v[228:231], a[100:103], a[44:47], v[228:231]
K_W4:
    s_waitcnt vmcnt(10) lgkmcnt(0)
    s_barrier
    v_mfma_f32_16x16x32_bf16 v[232:235], a[0:3], a[104:107], v[232:235]
    ds_read_b128 a[96:99], v16 offset:32768
    v_mfma_f32_16x16x32_bf16 v[232:235], a[4:7], a[108:111], v[232:235]
    ds_read_b128 a[100:103], v17 offset:32768
    s_add_u32 m0, s45, 0
    v_mfma_f32_16x16x32_bf16 v[236:239], a[8:11], a[104:107], v[236:239]
    buffer_load_dwordx4 v2, s[16:19], s43 offen lds
    v_mfma_f32_16x16x32_bf16 v[236:239], a[12:15], a[108:111], v[236:239]
    v_mfma_f32_16x16x32_bf16 v[240:243], a[104:107], a[16:19], v[240:243]
    v_mfma_f32_16x16x32_bf16 v[240:243], a[108:111], a[20:23], v[240:243]
    v_mfma_f32_16x16x32_bf16 v[244:247], a[104:107], a[24:27], v[244:247]
    buffer_load_dwordx4 v3, s[16:19], s43 offen offset:1024 lds
    v_mfma_f32_16x16x32_bf16 v[244:247], a[108:111], a[28:31], v[244:247]
    v_mfma_f32_16x16x32_bf16 v[248:251], a[104:107], a[32:35], v[248:251]
    v_mfma_f32_16x16x32_bf16 v[248:251], a[108:111], a[36:39], v[248:251]
    v_mfma_f32_16x16x32_bf16 v[252:255], a[104:107], a[40:43], v[252:255]
    v_mfma_f32_16x16x32_bf16 v[252:255], a[108:111], a[44:47], v[252:255]
    s_waitcnt lgkmcnt(0)
    v_mfma_f32_16x16x32_bf16 v[64:67], a[48:51], a[96:99], v[64:67]
    ds_read_b128 a[104:107], v16 offset:34816
    ds_read_b64_tr_b16 a[0:1], v18 offset:0
    v_mfma_f32_16x16x32_bf16 v[64:67], a[52:55], a[100:103], v[64:67]
    ds_read_b128 a[108:111], v17 offset:34816
    v_mfma_f32_16x16x32_bf16 v[68:71], a[56:59], a[96:99], v[68:71]
    buffer_load_dwordx4 v4, s[16:19], s43 offen offset:2048 lds
    v_mfma_f32_16x16x32_bf16 v[68:71], a[60:63], a[100:103], v[68:71]
    buffer_load_dwordx4 v5, s[16:19], s43 offen offset:3072 lds
    v_mfma_f32_16x16x32_bf16 v[72:75], a[96:99], a[64:67], v[72:75]
    s_add_u32 s43, s43, 128
    ds_read_b64_tr_b16 a[2:3], v18 offset:512
    v_mfma_f32_16x16x32_bf16 v[72:75], a[100:103], a[68:71], v[72:75]
    v_mfma_f32_16x16x32_bf16 v[76:79], a[96:99], a[72:75], v[76:79]
    ds_read_b64_tr_b16 a[4:5], v18 offset:4096
    ds_read_b64_tr_b16 a[176:177], v44 offset:0
    v_mfma_f32_16x16x32_bf16 v[76:79], a[100:103], a[76:79], v[76:79]
    s_add_u32 m0, s45, 8192
    v_mfma_f32_16x16x32_bf16 v[80:83], a[96:99], a[80:83], v[80:83]
    buffer_load_dwordx4 v6, s[16:19], s72 offen lds
    v_mfma_f32_16x16x32_bf16 v[80:83], a[100:103], a[84:87], v[80:83]
    ds_read_b64_tr_b16 a[6:7], v18 offset:4608
    v_mfma_f32_16x16x32_bf16 v[84:87], a[96:99], a[88:91], v[84:87]
    v_mfma_f32_16x16x32_bf16 v[84:87], a[100:103], a[92:95], v[84:87]
    s_waitcnt lgkmcnt(4)
    v_mfma_f32_16x16x32_bf16 v[88:91], a[48:51], a[104:107], v[88:91]
    ds_read_b128 a[96:99], v16 offset:36864
    ds_read_b64_tr_b16 a[8:9], v19 offset:0
    v_mfma_f32_16x16x32_bf16 v[88:91], a[52:55], a[108:111], v[88:91]
    ds_read_b128 a[100:103], v17 offset:36864
    v_mfma_f32_16x16x32_bf16 v[92:95], a[56:59], a[104:107], v[92:95]
    buffer_load_dwordx4 v7, s[16:19], s72 offen offset:1024 lds
    v_mfma_f32_16x16x32_bf16 v[92:95], a[60:63], a[108:111], v[92:95]
    ds_read_b64_tr_b16 a[10:11], v19 offset:512
    v_mfma_f32_16x16x32_bf16 v[96:99], a[104:107], a[64:67], v[96:99]
    v_mfma_f32_16x16x32_bf16 v[96:99], a[108:111], a[68:71], v[96:99]
    buffer_load_dwordx4 v8, s[16:19], s72 offen offset:2048 lds
    v_mfma_f32_16x16x32_bf16 v[100:103], a[104:107], a[72:75], v[100:103]
    v_mfma_f32_16x16x32_bf16 v[100:103], a[108:111], a[76:79], v[100:103]
    ds_read_b64_tr_b16 a[12:13], v19 offset:4096
    v_mfma_f32_16x16x32_bf16 v[104:107], a[104:107], a[80:83], v[104:107]
    v_mfma_f32_16x16x32_bf16 v[104:107], a[108:111], a[84:87], v[104:107]
    v_mfma_f32_16x16x32_bf16 v[108:111], a[104:107], a[88:91], v[108:111]
    buffer_load_dwordx4 v9, s[16:19], s72 offen offset:3072 lds
    v_mfma_f32_16x16x32_bf16 v[108:111], a[108:111], a[92:95], v[108:111]
    s_add_u32 s72, s72, 128
    s_waitcnt lgkmcnt(2)
    v_mfma_f32_16x16x32_bf16 v[112:115], a[48:51], a[96:99], v[112:115]
    ds_read_b128 a[104:107], v16 offset:38912
    ds_read_b64_tr_b16 a[14:15], v19 offset:4608
    v_mfma_f32_16x16x32_bf16 v[112:115], a[52:55], a[100:103], v[112:115]
    ds_read_b128 a[108:111], v17 offset:38912
    ds_read_b64_tr_b16 a[16:17], v18 offset:8192
    v_mfma_f32_16x16x32_bf16 v[116:119], a[56:59], a[96:99], v[116:119]
    s_add_u32 m0, s49, 114688
    ds_read_b64_tr_b16 a[180:181], v45 offset:0
    v_mfma_f32_16x16x32_bf16 v[116:119], a[60:63], a[100:103], v[116:119]
    buffer_load_dwordx4 v10, s[20:23], s44 offen lds
    v_mfma_f32_16x16x32_bf16 v[120:123], a[96:99], a[64:67], v[120:123]
    ds_read_b64_tr_b16 a[18:19], v18 offset:8704
    v_mfma_f32_16x16x32_bf16 v[120:123], a[100:103], a[68:71], v[120:123]
    v_mfma_f32_16x16x32_bf16 v[124:127], a[96:99], a[72:75], v[124:127]
    v_mfma_f32_16x16x32_bf16 v[124:127], a[100:103], a[76:79], v[124:127]
    buffer_load_dwordx4 v11, s[20:23], s44 offen offset:1024 lds
    v_mfma_f32_16x16x32_bf16 v[128:131], a[96:99], a[80:83], v[128:131]
    ds_read_b64_tr_b16 a[20:21], v18 offset:12288
    v_mfma_f32_16x16x32_bf16 v[128:131], a[100:103], a[84:87], v[128:131]
    v_mfma_f32_16x16x32_bf16 v[132:135], a[96:99], a[88:91], v[132:135]
    ds_read_b64_tr_b16 a[22:23], v18 offset:12800
    v_mfma_f32_16x16x32_bf16 v[132:135], a[100:103], a[92:95], v[132:135]
    s_waitcnt lgkmcnt(5)
    v_mfma_f32_16x16x32_bf16 v[136:139], a[48:51], a[104:107], v[136:139]
    ds_read_b128 a[96:99], v16 offset:40960
    v_mfma_f32_16x16x32_bf16 v[136:139], a[52:55], a[108:111], v[136:139]
    ds_read_b128 a[100:103], v17 offset:40960
    v_mfma_f32_16x16x32_bf16 v[140:143], a[56:59], a[104:107], v[140:143]
    buffer_load_dwordx4 v12, s[20:23], s44 offen offset:2048 lds
    v_mfma_f32_16x16x32_bf16 v[140:143], a[60:63], a[108:111], v[140:143]
    ds_read_b64_tr_b16 a[24:25], v19 offset:8192
    v_mfma_f32_16x16x32_bf16 v[144:147], a[104:107], a[64:67], v[144:147]
    v_mfma_f32_16x16x32_bf16 v[144:147], a[108:111], a[68:71], v[144:147]
    buffer_load_dwordx4 v13, s[20:23], s44 offen offset:3072 lds
    v_mfma_f32_16x16x32_bf16 v[148:151], a[104:107], a[72:75], v[148:151]
    ds_read_b64_tr_b16 a[26:27], v19 offset:8704
    v_mfma_f32_16x16x32_bf16 v[148:151], a[108:111], a[76:79], v[148:151]
    ds_read_b64_tr_b16 a[184:185], v46 offset:0
    v_mfma_f32_16x16x32_bf16 v[152:155], a[104:107], a[80:83], v[152:155]
    s_add_u32 m0, s49, 118784
    ds_read_b64_tr_b16 a[28:29], v19 offset:12288
    v_mfma_f32_16x16x32_bf16 v[152:155], a[108:111], a[84:87], v[152:155]
    buffer_load_dwordx4 v14, s[20:23], s44 offen lds
    v_mfma_f32_16x16x32_bf16 v[156:159], a[104:107], a[88:91], v[156:159]
    v_mfma_f32_16x16x32_bf16 v[156:159], a[108:111], a[92:95], v[156:159]
    ds_read_b64_tr_b16 a[30:31], v19 offset:12800
    s_waitcnt lgkmcnt(5)
    v_mfma_f32_16x16x32_bf16 v[160:163], a[48:51], a[96:99], v[160:163]
    ds_read_b128 a[104:107], v16 offset:43008
    v_mfma_f32_16x16x32_bf16 v[160:163], a[52:55], a[100:103], v[160:163]
    ds_read_b128 a[108:111], v17 offset:43008
    v_mfma_f32_16x16x32_bf16 v[164:167], a[56:59], a[96:99], v[164:167]
    buffer_load_dwordx4 v15, s[20:23], s44 offen offset:1024 lds
    v_mfma_f32_16x16x32_bf16 v[164:167], a[60:63], a[100:103], v[164:167]
    s_add_u32 s44, s44, 393216
    ds_read_b64_tr_b16 a[32:33], v18 offset:16384
    v_mfma_f32_16x16x32_bf16 v[168:171], a[96:99], a[64:67], v[168:171]
    v_mfma_f32_16x16x32_bf16 v[168:171], a[100:103], a[68:71], v[168:171]
    ds_read_b64_tr_b16 a[34:35], v18 offset:16896
    v_mfma_f32_16x16x32_bf16 v[172:175], a[96:99], a[72:75], v[172:175]
    v_mfma_f32_16x16x32_bf16 v[172:175], a[100:103], a[76:79], v[172:175]
    s_mov_b32 exec_lo, 0xc000c000
    s_mov_b32 exec_hi, 0
    buffer_load_dword v39, v38, s[16:19], s60 offen
    s_mov_b64 exec, -1
    v_mfma_f32_16x16x32_bf16 v[176:179], a[96:99], a[80:83], v[176:179]
    v_mfma_f32_16x16x32_bf16 v[176:179], a[100:103], a[84:87], v[176:179]
    ds_read_b64_tr_b16 a[36:37], v18 offset:20480
    v_mfma_f32_16x16x32_bf16 v[180:183], a[96:99], a[88:91], v[180:183]
    v_mfma_f32_16x16x32_bf16 v[180:183], a[100:103], a[92:95], v[180:183]
    s_waitcnt lgkmcnt(3)
    v_mfma_f32_16x16x32_bf16 v[184:187], a[48:51], a[104:107], v[184:187]
    ds_read_b128 a[96:99], v16 offset:45056
    ds_read_b64_tr_b16 a[38:39], v18 offset:20992
    v_mfma_f32_16x16x32_bf16 v[184:187], a[52:55], a[108:111], v[184:187]
    ds_read_b128 a[100:103], v17 offset:45056
    ds_read_b64_tr_b16 a[188:189], v47 offset:0
    v_mfma_f32_16x16x32_bf16 v[188:191], a[56:59], a[104:107], v[188:191]
    s_mov_b64 exec, 0x3f
    buffer_load_dword v39, v38, s[84:87], s73 offen
    s_mov_b64 exec, -1
    s_add_u32 s73, s73, 393216
    v_mfma_f32_16x16x32_bf16 v[188:191], a[60:63], a[108:111], v[188:191]
    ds_read_b64_tr_b16 a[40:41], v19 offset:16384
    v_mfma_f32_16x16x32_bf16 v[192:195], a[104:107], a[64:67], v[192:195]
    buffer_store_dwordx4 v[32:35], v26, s[24:27], s62 offen sc1
    v_mfma_f32_16x16x32_bf16 v[192:195], a[108:111], a[68:71], v[192:195]
    s_add_u32 s59, s79, K_W7-gated_mix__linear_attn_block__linear_attn_block__prompt_kernel
    v_lshlrev_b32 v54, 14, v1
    v_mfma_f32_16x16x32_bf16 v[196:199], a[104:107], a[72:75], v[196:199]
    v_add_u32 v54, s59, v54
    v_min_u32 v54, K_LAST-gated_mix__linear_attn_block__linear_attn_block__prompt_kernel, v54
    v_mfma_f32_16x16x32_bf16 v[196:199], a[108:111], a[76:79], v[196:199]
    v_mov_b32 v55, s89
    ds_read_b64_tr_b16 a[42:43], v19 offset:16896
    v_mfma_f32_16x16x32_bf16 v[200:203], a[104:107], a[80:83], v[200:203]
    v_mfma_f32_16x16x32_bf16 v[200:203], a[108:111], a[84:87], v[200:203]
    v_add_co_u32 v54, vcc, s88, v54
    s_nop 1
    v_addc_co_u32 v55, vcc, 0, v55, vcc
    s_mov_b64 exec, 1
    global_load_dword v39, v[54:55], off
    s_mov_b64 exec, -1
    v_mfma_f32_16x16x32_bf16 v[204:207], a[104:107], a[88:91], v[204:207]
    ds_read_b64_tr_b16 a[44:45], v19 offset:20480
    v_mfma_f32_16x16x32_bf16 v[204:207], a[108:111], a[92:95], v[204:207]
    s_waitcnt lgkmcnt(4)
    v_mfma_f32_16x16x32_bf16 v[208:211], a[48:51], a[96:99], v[208:211]
    ds_read_b128 a[104:107], v16 offset:47104
    s_add_u32 m0, s64, 4096
    v_mfma_f32_16x16x32_bf16 v[208:211], a[52:55], a[100:103], v[208:211]
    ds_read_b128 a[108:111], v17 offset:47104
    ds_read_b64_tr_b16 a[46:47], v19 offset:20992
    v_mfma_f32_16x16x32_bf16 v[212:215], a[56:59], a[96:99], v[212:215]
    buffer_load_dwordx4 v40, s[80:83], s52 offen lds
    v_mfma_f32_16x16x32_bf16 v[212:215], a[60:63], a[100:103], v[212:215]
    v_mfma_f32_16x16x32_bf16 v[216:219], a[96:99], a[64:67], v[216:219]
    v_mfma_f32_16x16x32_bf16 v[216:219], a[100:103], a[68:71], v[216:219]
    v_mfma_f32_16x16x32_bf16 v[220:223], a[96:99], a[72:75], v[220:223]
    buffer_load_dwordx4 v41, s[80:83], s52 offen offset:1024 lds
    v_mfma_f32_16x16x32_bf16 v[220:223], a[100:103], a[76:79], v[220:223]
    v_mfma_f32_16x16x32_bf16 v[224:227], a[96:99], a[80:83], v[224:227]
    v_mfma_f32_16x16x32_bf16 v[224:227], a[100:103], a[84:87], v[224:227]
    v_mfma_f32_16x16x32_bf16 v[228:231], a[96:99], a[88:91], v[228:231]
    v_mfma_f32_16x16x32_bf16 v[228:231], a[100:103], a[92:95], v[228:231]
K_W5:
    s_waitcnt vmcnt(12) lgkmcnt(0)
    s_barrier
    v_mfma_f32_16x16x32_bf16 v[232:235], a[48:51], a[104:107], v[232:235]
    ds_read_b128 a[96:99], v16 offset:0
    v_mfma_f32_16x16x32_bf16 v[232:235], a[52:55], a[108:111], v[232:235]
    ds_read_b128 a[100:103], v17 offset:0
    s_add_u32 m0, s45, 32768
    v_mfma_f32_16x16x32_bf16 v[236:239], a[56:59], a[104:107], v[236:239]
    buffer_load_dwordx4 v2, s[16:19], s43 offen lds
    v_mfma_f32_16x16x32_bf16 v[236:239], a[60:63], a[108:111], v[236:239]
    v_mfma_f32_16x16x32_bf16 v[240:243], a[104:107], a[64:67], v[240:243]
    v_mfma_f32_16x16x32_bf16 v[240:243], a[108:111], a[68:71], v[240:243]
    v_mfma_f32_16x16x32_bf16 v[244:247], a[104:107], a[72:75], v[244:247]
    v_mfma_f32_16x16x32_bf16 v[244:247], a[108:111], a[76:79], v[244:247]
    buffer_load_dwordx4 v3, s[16:19], s43 offen offset:1024 lds
    v_mfma_f32_16x16x32_bf16 v[248:251], a[104:107], a[80:83], v[248:251]
    v_mfma_f32_16x16x32_bf16 v[248:251], a[108:111], a[84:87], v[248:251]
    v_mfma_f32_16x16x32_bf16 v[252:255], a[104:107], a[88:91], v[252:255]
    v_mfma_f32_16x16x32_bf16 v[252:255], a[108:111], a[92:95], v[252:255]
    s_waitcnt lgkmcnt(0)
    v_mfma_f32_16x16x32_bf16 v[64:67], a[0:3], a[96:99], v[64:67]
    ds_read_b128 a[104:107], v16 offset:2048
    ds_read_b64_tr_b16 a[48:49], v20 offset:0
    v_mfma_f32_16x16x32_bf16 v[64:67], a[4:7], a[100:103], v[64:67]
    ds_read_b128 a[108:111], v17 offset:2048
    v_mfma_f32_16x16x32_bf16 v[68:71], a[8:11], a[96:99], v[68:71]
    buffer_load_dwordx4 v4, s[16:19], s43 offen offset:2048 lds
    v_mfma_f32_16x16x32_bf16 v[68:71], a[12:15], a[100:103], v[68:71]
    ds_read_b64_tr_b16 a[50:51], v20 offset:512
    v_mfma_f32_16x16x32_bf16 v[72:75], a[96:99], a[16:19], v[72:75]
    v_mfma_f32_16x16x32_bf16 v[72:75], a[100:103], a[20:23], v[72:75]
    buffer_load_dwordx4 v5, s[16:19], s43 offen offset:3072 lds
    v_mfma_f32_16x16x32_bf16 v[76:79], a[96:99], a[24:27], v[76:79]
    s_add_u32 s43, s43, 128
    ds_read_b64_tr_b16 a[52:53], v20 offset:4096
    v_mfma_f32_16x16x32_bf16 v[76:79], a[100:103], a[28:31], v[76:79]
    ds_read_b64_tr_b16 a[178:179], v44 offset:2048
    v_mfma_f32_16x16x32_bf16 v[80:83], a[96:99], a[32:35], v[80:83]
    v_mfma_f32_16x16x32_bf16 v[80:83], a[100:103], a[36:39], v[80:83]
    s_add_u32 m0, s45, 40960
    ds_read_b64_tr_b16 a[54:55], v20 offset:4608
    v_mfma_f32_16x16x32_bf16 v[84:87], a[96:99], a[40:43], v[84:87]
    buffer_load_dwordx4 v6, s[16:19], s72 offen lds
    v_mfma_f32_16x16x32_bf16 v[84:87], a[100:103], a[44:47], v[84:87]
    s_waitcnt lgkmcnt(4)
    v_mfma_f32_16x16x32_bf16 v[88:91], a[0:3], a[104:107], v[88:91]
    ds_read_b128 a[96:99], v16 offset:4096
    ds_read_b64_tr_b16 a[56:57], v21 offset:0
    v_mfma_f32_16x16x32_bf16 v[88:91], a[4:7], a[108:111], v[88:91]
    ds_read_b128 a[100:103], v17 offset:4096
    v_mfma_f32_16x16x32_bf16 v[92:95], a[8:11], a[104:107], v[92:95]
    v_mfma_f32_16x16x32_bf16 v[92:95], a[12:15], a[108:111], v[92:95]
    buffer_load_dwordx4 v7, s[16:19], s72 offen offset:1024 lds
    v_mfma_f32_16x16x32_bf16 v[96:99], a[104:107], a[16:19], v[96:99]
    ds_read_b64_tr_b16 a[58:59], v21 offset:512
    v_mfma_f32_16x16x32_bf16 v[96:99], a[108:111], a[20:23], v[96:99]
    v_mfma_f32_16x16x32_bf16 v[100:103], a[104:107], a[24:27], v[100:103]
    v_mfma_f32_16x16x32_bf16 v[100:103], a[108:111], a[28:31], v[100:103]
    ds_read_b64_tr_b16 a[60:61], v21 offset:4096
    v_mfma_f32_16x16x32_bf16 v[104:107], a[104:107], a[32:35], v[104:107]
    v_mfma_f32_16x16x32_bf16 v[104:107], a[108:111], a[36:39], v[104:107]
    buffer_load_dwordx4 v8, s[16:19], s72 offen offset:2048 lds
    v_mfma_f32_16x16x32_bf16 v[108:111], a[104:107], a[40:43], v[108:111]
    ds_read_b64_tr_b16 a[62:63], v21 offset:4608
    v_mfma_f32_16x16x32_bf16 v[108:111], a[108:111], a[44:47], v[108:111]
    s_waitcnt lgkmcnt(3)
    v_mfma_f32_16x16x32_bf16 v[112:115], a[0:3], a[96:99], v[112:115]
    ds_read_b128 a[104:107], v16 offset:6144
    ds_read_b64_tr_b16 a[182:183], v45 offset:2048
    v_mfma_f32_16x16x32_bf16 v[112:115], a[4:7], a[100:103], v[112:115]
    ds_read_b128 a[108:111], v17 offset:6144
    ds_read_b64_tr_b16 a[64:65], v20 offset:8192
    v_mfma_f32_16x16x32_bf16 v[116:119], a[8:11], a[96:99], v[116:119]
    buffer_load_dwordx4 v9, s[16:19], s72 offen offset:3072 lds
    v_mfma_f32_16x16x32_bf16 v[116:119], a[12:15], a[100:103], v[116:119]
    s_add_u32 s72, s72, 128
    v_mfma_f32_16x16x32_bf16 v[120:123], a[96:99], a[16:19], v[120:123]
    ds_read_b64_tr_b16 a[66:67], v20 offset:8704
    v_mfma_f32_16x16x32_bf16 v[120:123], a[100:103], a[20:23], v[120:123]
    v_mfma_f32_16x16x32_bf16 v[124:127], a[96:99], a[24:27], v[124:127]
    s_add_u32 m0, s49, 65536
    v_mfma_f32_16x16x32_bf16 v[124:127], a[100:103], a[28:31], v[124:127]
    buffer_load_dwordx4 v10, s[20:23], s44 offen lds
    v_mfma_f32_16x16x32_bf16 v[128:131], a[96:99], a[32:35], v[128:131]
    ds_read_b64_tr_b16 a[68:69], v20 offset:12288
    v_mfma_f32_16x16x32_bf16 v[128:131], a[100:103], a[36:39], v[128:131]
    v_mfma_f32_16x16x32_bf16 v[132:135], a[96:99], a[40:43], v[132:135]
    ds_read_b64_tr_b16 a[70:71], v20 offset:12800
    v_mfma_f32_16x16x32_bf16 v[132:135], a[100:103], a[44:47], v[132:135]
    s_waitcnt lgkmcnt(4)
    v_mfma_f32_16x16x32_bf16 v[136:139], a[0:3], a[104:107], v[136:139]
    ds_read_b128 a[96:99], v16 offset:8192
    v_mfma_f32_16x16x32_bf16 v[136:139], a[4:7], a[108:111], v[136:139]
    ds_read_b128 a[100:103], v17 offset:8192
    v_mfma_f32_16x16x32_bf16 v[140:143], a[8:11], a[104:107], v[140:143]
    buffer_load_dwordx4 v11, s[20:23], s44 offen offset:1024 lds
    v_mfma_f32_16x16x32_bf16 v[140:143], a[12:15], a[108:111], v[140:143]
    ds_read_b64_tr_b16 a[72:73], v21 offset:8192
    v_mfma_f32_16x16x32_bf16 v[144:147], a[104:107], a[16:19], v[144:147]
    v_mfma_f32_16x16x32_bf16 v[144:147], a[108:111], a[20:23], v[144:147]
    buffer_load_dwordx4 v12, s[20:23], s44 offen offset:2048 lds
    v_mfma_f32_16x16x32_bf16 v[148:151], a[104:107], a[24:27], v[148:151]
    ds_read_b64_tr_b16 a[74:75], v21 offset:8704
    v_mfma_f32_16x16x32_bf16 v[148:151], a[108:111], a[28:31], v[148:151]
    ds_read_b64_tr_b16 a[186:187], v46 offset:2048
    v_mfma_f32_16x16x32_bf16 v[152:155], a[104:107], a[32:35], v[152:155]
    ds_read_b64_tr_b16 a[76:77], v21 offset:12288
    v_mfma_f32_16x16x32_bf16 v[152:155], a[108:111], a[36:39], v[152:155]
    v_mfma_f32_16x16x32_bf16 v[156:159], a[104:107], a[40:43], v[156:159]
    buffer_load_dwordx4 v13, s[20:23], s44 offen offset:3072 lds
    v_mfma_f32_16x16x32_bf16 v[156:159], a[108:111], a[44:47], v[156:159]
    ds_read_b64_tr_b16 a[78:79], v21 offset:12800
    s_waitcnt lgkmcnt(5)
    v_mfma_f32_16x16x32_bf16 v[160:163], a[0:3], a[96:99], v[160:163]
    ds_read_b128 a[104:107], v16 offset:10240
    v_mfma_f32_16x16x32_bf16 v[160:163], a[4:7], a[100:103], v[160:163]
    ds_read_b128 a[108:111], v17 offset:10240
    v_mfma_f32_16x16x32_bf16 v[164:167], a[8:11], a[96:99], v[164:167]
    s_add_u32 m0, s49, 69632
    ds_read_b64_tr_b16 a[80:81], v20 offset:16384
    v_mfma_f32_16x16x32_bf16 v[164:167], a[12:15], a[100:103], v[164:167]
    buffer_load_dwordx4 v14, s[20:23], s44 offen lds
    v_mfma_f32_16x16x32_bf16 v[168:171], a[96:99], a[16:19], v[168:171]
    v_mfma_f32_16x16x32_bf16 v[168:171], a[100:103], a[20:23], v[168:171]
    ds_read_b64_tr_b16 a[82:83], v20 offset:16896
    v_mfma_f32_16x16x32_bf16 v[172:175], a[96:99], a[24:27], v[172:175]
    v_mfma_f32_16x16x32_bf16 v[172:175], a[100:103], a[28:31], v[172:175]
    v_mfma_f32_16x16x32_bf16 v[176:179], a[96:99], a[32:35], v[176:179]
    v_mfma_f32_16x16x32_bf16 v[176:179], a[100:103], a[36:39], v[176:179]
    buffer_load_dwordx4 v15, s[20:23], s44 offen offset:1024 lds
    v_mfma_f32_16x16x32_bf16 v[180:183], a[96:99], a[40:43], v[180:183]
    s_add_u32 s44, s44, 393216
    ds_read_b64_tr_b16 a[84:85], v20 offset:20480
    v_mfma_f32_16x16x32_bf16 v[180:183], a[100:103], a[44:47], v[180:183]
    s_waitcnt lgkmcnt(3)
    v_mfma_f32_16x16x32_bf16 v[184:187], a[0:3], a[104:107], v[184:187]
    ds_read_b128 a[96:99], v16 offset:12288
    ds_read_b64_tr_b16 a[86:87], v20 offset:20992
    v_mfma_f32_16x16x32_bf16 v[184:187], a[4:7], a[108:111], v[184:187]
    ds_read_b128 a[100:103], v17 offset:12288
    ds_read_b64_tr_b16 a[190:191], v47 offset:2048
    v_mfma_f32_16x16x32_bf16 v[188:191], a[8:11], a[104:107], v[188:191]
    s_mov_b64 exec, 0x3f
    buffer_load_dword v39, v38, s[84:87], s73 offen
    s_mov_b64 exec, -1
    s_add_u32 s73, s73, 393216
    v_mfma_f32_16x16x32_bf16 v[188:191], a[12:15], a[108:111], v[188:191]
    ds_read_b64_tr_b16 a[88:89], v21 offset:16384
    v_mfma_f32_16x16x32_bf16 v[192:195], a[104:107], a[16:19], v[192:195]
    v_mfma_f32_16x16x32_bf16 v[192:195], a[108:111], a[20:23], v[192:195]
    v_mfma_f32_16x16x32_bf16 v[196:199], a[104:107], a[24:27], v[196:199]
    ds_read_b64_tr_b16 a[90:91], v21 offset:16896
    v_mfma_f32_16x16x32_bf16 v[196:199], a[108:111], a[28:31], v[196:199]
    buffer_store_dwordx4 v[32:35], v26, s[24:27], s62 offen offset:1024 sc1
    v_mfma_f32_16x16x32_bf16 v[200:203], a[104:107], a[32:35], v[200:203]
    v_mfma_f32_16x16x32_bf16 v[200:203], a[108:111], a[36:39], v[200:203]
    ds_read_b64_tr_b16 a[92:93], v21 offset:20480
    v_mfma_f32_16x16x32_bf16 v[204:207], a[104:107], a[40:43], v[204:207]
    v_mfma_f32_16x16x32_bf16 v[204:207], a[108:111], a[44:47], v[204:207]
    s_add_u32 m0, s64, -2048
    s_waitcnt lgkmcnt(4)
    v_mfma_f32_16x16x32_bf16 v[208:211], a[0:3], a[96:99], v[208:211]
    ds_read_b128 a[104:107], v16 offset:14336
    ds_read_b64_tr_b16 a[94:95], v21 offset:20992
    v_mfma_f32_16x16x32_bf16 v[208:211], a[4:7], a[100:103], v[208:211]
    ds_read_b128 a[108:111], v17 offset:14336
    v_mfma_f32_16x16x32_bf16 v[212:215], a[8:11], a[96:99], v[212:215]
    buffer_load_dwordx4 v42, s[80:83], s52 offen offset:2048 lds
    v_mfma_f32_16x16x32_bf16 v[212:215], a[12:15], a[100:103], v[212:215]
    v_mfma_f32_16x16x32_bf16 v[216:219], a[96:99], a[16:19], v[216:219]
    v_mfma_f32_16x16x32_bf16 v[216:219], a[100:103], a[20:23], v[216:219]
    buffer_load_dwordx4 v43, s[80:83], s52 offen offset:3072 lds
    v_mfma_f32_16x16x32_bf16 v[220:223], a[96:99], a[24:27], v[220:223]
    s_add_u32 s52, s52, 65536
    v_mfma_f32_16x16x32_bf16 v[220:223], a[100:103], a[28:31], v[220:223]
    v_mfma_f32_16x16x32_bf16 v[224:227], a[96:99], a[32:35], v[224:227]
    v_mfma_f32_16x16x32_bf16 v[224:227], a[100:103], a[36:39], v[224:227]
    v_mfma_f32_16x16x32_bf16 v[228:231], a[96:99], a[40:43], v[228:231]
    v_mfma_f32_16x16x32_bf16 v[228:231], a[100:103], a[44:47], v[228:231]
K_W6:
    s_waitcnt vmcnt(10) lgkmcnt(0)
    s_barrier
    v_mfma_f32_16x16x32_bf16 v[232:235], a[0:3], a[104:107], v[232:235]
    ds_read_b128 a[96:99], v16 offset:32768
    v_mfma_f32_16x16x32_bf16 v[232:235], a[4:7], a[108:111], v[232:235]
    ds_read_b128 a[100:103], v17 offset:32768
    s_add_u32 m0, s45, 0
    v_mfma_f32_16x16x32_bf16 v[236:239], a[8:11], a[104:107], v[236:239]
    buffer_load_dwordx4 v2, s[16:19], s43 offen lds
    v_mfma_f32_16x16x32_bf16 v[236:239], a[12:15], a[108:111], v[236:239]
    v_mfma_f32_16x16x32_bf16 v[240:243], a[104:107], a[16:19], v[240:243]
    v_mfma_f32_16x16x32_bf16 v[240:243], a[108:111], a[20:23], v[240:243]
    v_mfma_f32_16x16x32_bf16 v[244:247], a[104:107], a[24:27], v[244:247]
    buffer_load_dwordx4 v3, s[16:19], s43 offen offset:1024 lds
    v_mfma_f32_16x16x32_bf16 v[244:247], a[108:111], a[28:31], v[244:247]
    v_mfma_f32_16x16x32_bf16 v[248:251], a[104:107], a[32:35], v[248:251]
    v_mfma_f32_16x16x32_bf16 v[248:251], a[108:111], a[36:39], v[248:251]
    v_mfma_f32_16x16x32_bf16 v[252:255], a[104:107], a[40:43], v[252:255]
    v_mfma_f32_16x16x32_bf16 v[252:255], a[108:111], a[44:47], v[252:255]
    s_waitcnt lgkmcnt(0)
    v_mfma_f32_16x16x32_bf16 v[64:67], a[48:51], a[96:99], v[64:67]
    ds_read_b128 a[104:107], v16 offset:34816
    ds_read_b64_tr_b16 a[0:1], v22 offset:0
    v_mfma_f32_16x16x32_bf16 v[64:67], a[52:55], a[100:103], v[64:67]
    ds_read_b128 a[108:111], v17 offset:34816
    v_mfma_f32_16x16x32_bf16 v[68:71], a[56:59], a[96:99], v[68:71]
    buffer_load_dwordx4 v4, s[16:19], s43 offen offset:2048 lds
    v_mfma_f32_16x16x32_bf16 v[68:71], a[60:63], a[100:103], v[68:71]
    ds_read_b64_tr_b16 a[2:3], v22 offset:512
    v_mfma_f32_16x16x32_bf16 v[72:75], a[96:99], a[64:67], v[72:75]
    buffer_load_dwordx4 v5, s[16:19], s43 offen offset:3072 lds
    v_mfma_f32_16x16x32_bf16 v[72:75], a[100:103], a[68:71], v[72:75]
    s_add_u32 s43, s43, 128
    v_mfma_f32_16x16x32_bf16 v[76:79], a[96:99], a[72:75], v[76:79]
    ds_read_b64_tr_b16 a[4:5], v22 offset:4096
    ds_read_b64_tr_b16 a[192:193], v44 offset:4096
    v_mfma_f32_16x16x32_bf16 v[76:79], a[100:103], a[76:79], v[76:79]
    v_mfma_f32_16x16x32_bf16 v[80:83], a[96:99], a[80:83], v[80:83]
    s_add_u32 m0, s45, 8192
    v_mfma_f32_16x16x32_bf16 v[80:83], a[100:103], a[84:87], v[80:83]
    buffer_load_dwordx4 v6, s[16:19], s72 offen lds
    v_mfma_f32_16x16x32_bf16 v[84:87], a[96:99], a[88:91], v[84:87]
    ds_read_b64_tr_b16 a[6:7], v22 offset:4608
    v_mfma_f32_16x16x32_bf16 v[84:87], a[100:103], a[92:95], v[84:87]
    s_waitcnt lgkmcnt(4)
    v_mfma_f32_16x16x32_bf16 v[88:91], a[48:51], a[104:107], v[88:91]
    ds_read_b128 a[96:99], v16 offset:36864
    ds_read_b64_tr_b16 a[8:9], v23 offset:0
    v_mfma_f32_16x16x32_bf16 v[88:91], a[52:55], a[108:111], v[88:91]
    ds_read_b128 a[100:103], v17 offset:36864
    v_mfma_f32_16x16x32_bf16 v[92:95], a[56:59], a[104:107], v[92:95]
    buffer_load_dwordx4 v7, s[16:19], s72 offen offset:1024 lds
    v_mfma_f32_16x16x32_bf16 v[92:95], a[60:63], a[108:111], v[92:95]
    ds_read_b64_tr_b16 a[10:11], v23 offset:512
    v_mfma_f32_16x16x32_bf16 v[96:99], a[104:107], a[64:67], v[96:99]
    v_mfma_f32_16x16x32_bf16 v[96:99], a[108:111], a[68:71], v[96:99]
    v_mfma_f32_16x16x32_bf16 v[100:103], a[104:107], a[72:75], v[100:103]
    v_mfma_f32_16x16x32_bf16 v[100:103], a[108:111], a[76:79], v[100:103]
    buffer_load_dwordx4 v8, s[16:19], s72 offen offset:2048 lds
    v_mfma_f32_16x16x32_bf16 v[104:107], a[104:107], a[80:83], v[104:107]
    ds_read_b64_tr_b16 a[12:13], v23 offset:4096
    v_mfma_f32_16x16x32_bf16 v[104:107], a[108:111], a[84:87], v[104:107]
    v_mfma_f32_16x16x32_bf16 v[108:111], a[104:107], a[88:91], v[108:111]
    ds_read_b64_tr_b16 a[14:15], v23 offset:4608
    v_mfma_f32_16x16x32_bf16 v[108:111], a[108:111], a[92:95], v[108:111]
    s_waitcnt lgkmcnt(3)
    v_mfma_f32_16x16x32_bf16 v[112:115], a[48:51], a[96:99], v[112:115]
    ds_read_b128 a[104:107], v16 offset:38912
    ds_read_b64_tr_b16 a[196:197], v45 offset:4096
    v_mfma_f32_16x16x32_bf16 v[112:115], a[52:55], a[100:103], v[112:115]
    ds_read_b128 a[108:111], v17 offset:38912
    ds_read_b64_tr_b16 a[16:17], v22 offset:8192
    v_mfma_f32_16x16x32_bf16 v[116:119], a[56:59], a[96:99], v[116:119]
    buffer_load_dwordx4 v9, s[16:19], s72 offen offset:3072 lds
    v_mfma_f32_16x16x32_bf16 v[116:119], a[60:63], a[100:103], v[116:119]
    s_add_u32 s72, s72, 128
    v_mfma_f32_16x16x32_bf16 v[120:123], a[96:99], a[64:67], v[120:123]
    s_add_u32 m0, s49, 90112
    ds_read_b64_tr_b16 a[18:19], v22 offset:8704
    v_mfma_f32_16x16x32_bf16 v[120:123], a[100:103], a[68:71], v[120:123]
    buffer_load_dwordx4 v10, s[20:23], s44 offen lds
    v_mfma_f32_16x16x32_bf16 v[124:127], a[96:99], a[72:75], v[124:127]
    v_mfma_f32_16x16x32_bf16 v[124:127], a[100:103], a[76:79], v[124:127]
    ds_read_b64_tr_b16 a[20:21], v22 offset:12288
    v_mfma_f32_16x16x32_bf16 v[128:131], a[96:99], a[80:83], v[128:131]
    v_mfma_f32_16x16x32_bf16 v[128:131], a[100:103], a[84:87], v[128:131]
    v_mfma_f32_16x16x32_bf16 v[132:135], a[96:99], a[88:91], v[132:135]
    buffer_load_dwordx4 v11, s[20:23], s44 offen offset:1024 lds
    v_mfma_f32_16x16x32_bf16 v[132:135], a[100:103], a[92:95], v[132:135]
    ds_read_b64_tr_b16 a[22:23], v22 offset:12800
    s_waitcnt lgkmcnt(4)
    v_mfma_f32_16x16x32_bf16 v[136:139], a[48:51], a[104:107], v[136:139]
    ds_read_b128 a[96:99], v16 offset:40960
    v_mfma_f32_16x16x32_bf16 v[136:139], a[52:55], a[108:111], v[136:139]
    ds_read_b128 a[100:103], v17 offset:40960
    v_mfma_f32_16x16x32_bf16 v[140:143], a[56:59], a[104:107], v[140:143]
    buffer_load_dwordx4 v12, s[20:23], s44 offen offset:2048 lds
    v_mfma_f32_16x16x32_bf16 v[140:143], a[60:63], a[108:111], v[140:143]
    ds_read_b64_tr_b16 a[24:25], v23 offset:8192
    v_mfma_f32_16x16x32_bf16 v[144:147], a[104:107], a[64:67], v[144:147]
    v_mfma_f32_16x16x32_bf16 v[144:147], a[108:111], a[68:71], v[144:147]
    ds_read_b64_tr_b16 a[26:27], v23 offset:8704
    v_mfma_f32_16x16x32_bf16 v[148:151], a[104:107], a[72:75], v[148:151]
    v_mfma_f32_16x16x32_bf16 v[148:151], a[108:111], a[76:79], v[148:151]
    buffer_load_dwordx4 v13, s[20:23], s44 offen offset:3072 lds
    v_mfma_f32_16x16x32_bf16 v[152:155], a[104:107], a[80:83], v[152:155]
    ds_read_b64_tr_b16 a[28:29], v23 offset:12288
    ds_read_b64_tr_b16 a[200:201], v46 offset:4096
    v_mfma_f32_16x16x32_bf16 v[152:155], a[108:111], a[84:87], v[152:155]
    v_mfma_f32_16x16x32_bf16 v[156:159], a[104:107], a[88:91], v[156:159]
    v_mfma_f32_16x16x32_bf16 v[156:159], a[108:111], a[92:95], v[156:159]
    s_add_u32 m0, s49, 94208
    s_waitcnt lgkmcnt(4)
    v_mfma_f32_16x16x32_bf16 v[160:163], a[48:51], a[96:99], v[160:163]
    ds_read_b128 a[104:107], v16 offset:43008
    ds_read_b64_tr_b16 a[30:31], v23 offset:12800
    v_mfma_f32_16x16x32_bf16 v[160:163], a[52:55], a[100:103], v[160:163]
    ds_read_b128 a[108:111], v17 offset:43008
    v_mfma_f32_16x16x32_bf16 v[164:167], a[56:59], a[96:99], v[164:167]
    buffer_load_dwordx4 v14, s[20:23], s44 offen lds
    v_mfma_f32_16x16x32_bf16 v[164:167], a[60:63], a[100:103], v[164:167]
    ds_read_b64_tr_b16 a[32:33], v22 offset:16384
    v_mfma_f32_16x16x32_bf16 v[168:171], a[96:99], a[64:67], v[168:171]
    v_mfma_f32_16x16x32_bf16 v[168:171], a[100:103], a[68:71], v[168:171]
    buffer_load_dwordx4 v15, s[20:23], s44 offen offset:1024 lds
    v_mfma_f32_16x16x32_bf16 v[172:175], a[96:99], a[72:75], v[172:175]
    s_add_u32 s44, s44, 393216
    ds_read_b64_tr_b16 a[34:35], v22 offset:16896
    v_mfma_f32_16x16x32_bf16 v[172:175], a[100:103], a[76:79], v[172:175]
    v_mfma_f32_16x16x32_bf16 v[176:179], a[96:99], a[80:83], v[176:179]
    v_mfma_f32_16x16x32_bf16 v[176:179], a[100:103], a[84:87], v[176:179]
    ds_read_b64_tr_b16 a[36:37], v22 offset:20480
    v_mfma_f32_16x16x32_bf16 v[180:183], a[96:99], a[88:91], v[180:183]
    s_mov_b64 exec, 0x3f
    buffer_load_dword v39, v38, s[84:87], s73 offen
    s_mov_b64 exec, -1
    s_add_u32 s73, s73, 393216
    v_mfma_f32_16x16x32_bf16 v[180:183], a[100:103], a[92:95], v[180:183]
    s_waitcnt lgkmcnt(3)
    v_mfma_f32_16x16x32_bf16 v[184:187], a[48:51], a[104:107], v[184:187]
    ds_read_b128 a[96:99], v16 offset:45056
    ds_read_b64_tr_b16 a[38:39], v22 offset:20992
    v_mfma_f32_16x16x32_bf16 v[184:187], a[52:55], a[108:111], v[184:187]
    ds_read_b128 a[100:103], v17 offset:45056
    ds_read_b64_tr_b16 a[204:205], v47 offset:4096
    v_mfma_f32_16x16x32_bf16 v[188:191], a[56:59], a[104:107], v[188:191]
    v_mfma_f32_16x16x32_bf16 v[188:191], a[60:63], a[108:111], v[188:191]
    buffer_store_dwordx4 v[32:35], v27, s[24:27], s62 offen offset:2048 sc1
    v_mfma_f32_16x16x32_bf16 v[192:195], a[104:107], a[64:67], v[192:195]
    ds_read_b64_tr_b16 a[40:41], v23 offset:16384
    v_mfma_f32_16x16x32_bf16 v[192:195], a[108:111], a[68:71], v[192:195]
    v_mfma_f32_16x16x32_bf16 v[196:199], a[104:107], a[72:75], v[196:199]
    ds_read_b64_tr_b16 a[42:43], v23 offset:16896
    v_mfma_f32_16x16x32_bf16 v[196:199], a[108:111], a[76:79], v[196:199]
    v_mfma_f32_16x16x32_bf16 v[200:203], a[104:107], a[80:83], v[200:203]
    buffer_store_dwordx2 v[32:33], v29, s[24:27], s55 offen sc1
    v_mfma_f32_16x16x32_bf16 v[200:203], a[108:111], a[84:87], v[200:203]
    ds_read_b64_tr_b16 a[44:45], v23 offset:20480
    v_mfma_f32_16x16x32_bf16 v[204:207], a[104:107], a[88:91], v[204:207]
    v_mfma_f32_16x16x32_bf16 v[204:207], a[108:111], a[92:95], v[204:207]
    s_waitcnt lgkmcnt(4)
    v_mfma_f32_16x16x32_bf16 v[208:211], a[48:51], a[96:99], v[208:211]
    ds_read_b128 a[104:107], v16 offset:47104
    s_add_u32 m0, s64, 2048
    v_mfma_f32_16x16x32_bf16 v[208:211], a[52:55], a[100:103], v[208:211]
    ds_read_b128 a[108:111], v17 offset:47104
    ds_read_b64_tr_b16 a[46:47], v23 offset:20992
    v_mfma_f32_16x16x32_bf16 v[212:215], a[56:59], a[96:99], v[212:215]
    buffer_load_dwordx4 v40, s[80:83], s52 offen lds
    v_mfma_f32_16x16x32_bf16 v[212:215], a[60:63], a[100:103], v[212:215]
    v_mfma_f32_16x16x32_bf16 v[216:219], a[96:99], a[64:67], v[216:219]
    v_mfma_f32_16x16x32_bf16 v[216:219], a[100:103], a[68:71], v[216:219]
    v_mfma_f32_16x16x32_bf16 v[220:223], a[96:99], a[72:75], v[220:223]
    buffer_load_dwordx4 v41, s[80:83], s52 offen offset:1024 lds
    v_mfma_f32_16x16x32_bf16 v[220:223], a[100:103], a[76:79], v[220:223]
    v_mfma_f32_16x16x32_bf16 v[224:227], a[96:99], a[80:83], v[224:227]
    v_mfma_f32_16x16x32_bf16 v[224:227], a[100:103], a[84:87], v[224:227]
    v_mfma_f32_16x16x32_bf16 v[228:231], a[96:99], a[88:91], v[228:231]
    v_mfma_f32_16x16x32_bf16 v[228:231], a[100:103], a[92:95], v[228:231]
K_W7:
    s_waitcnt vmcnt(11) lgkmcnt(0)
    s_barrier
    v_mfma_f32_16x16x32_bf16 v[232:235], a[48:51], a[104:107], v[232:235]
    ds_read_b128 a[96:99], v16 offset:0
    v_mfma_f32_16x16x32_bf16 v[232:235], a[52:55], a[108:111], v[232:235]
    ds_read_b128 a[100:103], v17 offset:0
    s_add_u32 m0, s45, 32768
    v_mfma_f32_16x16x32_bf16 v[236:239], a[56:59], a[104:107], v[236:239]
    buffer_load_dwordx4 v2, s[16:19], s43 offen lds
    v_mfma_f32_16x16x32_bf16 v[236:239], a[60:63], a[108:111], v[236:239]
    v_mfma_f32_16x16x32_bf16 v[240:243], a[104:107], a[64:67], v[240:243]
    v_mfma_f32_16x16x32_bf16 v[240:243], a[108:111], a[68:71], v[240:243]
    v_mfma_f32_16x16x32_bf16 v[244:247], a[104:107], a[72:75], v[244:247]
    v_mfma_f32_16x16x32_bf16 v[244:247], a[108:111], a[76:79], v[244:247]
    buffer_load_dwordx4 v3, s[16:19], s43 offen offset:1024 lds
    v_mfma_f32_16x16x32_bf16 v[248:251], a[104:107], a[80:83], v[248:251]
    v_mfma_f32_16x16x32_bf16 v[248:251], a[108:111], a[84:87], v[248:251]
    v_mfma_f32_16x16x32_bf16 v[252:255], a[104:107], a[88:91], v[252:255]
    v_mfma_f32_16x16x32_bf16 v[252:255], a[108:111], a[92:95], v[252:255]
    s_waitcnt lgkmcnt(0)
    v_mfma_f32_16x16x32_bf16 v[64:67], a[0:3], a[96:99], v[64:67]
    ds_read_b128 a[104:107], v16 offset:2048
    ds_read_b64_tr_b16 a[48:49], v18 offset:0
    v_mfma_f32_16x16x32_bf16 v[64:67], a[4:7], a[100:103], v[64:67]
    ds_read_b128 a[108:111], v17 offset:2048
    v_mfma_f32_16x16x32_bf16 v[68:71], a[8:11], a[96:99], v[68:71]
    buffer_load_dwordx4 v4, s[16:19], s43 offen offset:2048 lds
    v_mfma_f32_16x16x32_bf16 v[68:71], a[12:15], a[100:103], v[68:71]
    ds_read_b64_tr_b16 a[50:51], v18 offset:512
    v_mfma_f32_16x16x32_bf16 v[72:75], a[96:99], a[16:19], v[72:75]
    v_mfma_f32_16x16x32_bf16 v[72:75], a[100:103], a[20:23], v[72:75]
    v_mfma_f32_16x16x32_bf16 v[76:79], a[96:99], a[24:27], v[76:79]
    buffer_load_dwordx4 v5, s[16:19], s43 offen offset:3072 lds
    v_mfma_f32_16x16x32_bf16 v[76:79], a[100:103], a[28:31], v[76:79]
    s_add_u32 s43, s43, 128
    ds_read_b64_tr_b16 a[52:53], v18 offset:4096
    v_mfma_f32_16x16x32_bf16 v[80:83], a[96:99], a[32:35], v[80:83]
    ds_read_b64_tr_b16 a[194:195], v44 offset:0
    v_mfma_f32_16x16x32_bf16 v[80:83], a[100:103], a[36:39], v[80:83]
    ds_read_b64_tr_b16 a[54:55], v18 offset:4608
    v_mfma_f32_16x16x32_bf16 v[84:87], a[96:99], a[40:43], v[84:87]
    s_add_u32 m0, s45, 40960
    v_mfma_f32_16x16x32_bf16 v[84:87], a[100:103], a[44:47], v[84:87]
    s_waitcnt lgkmcnt(4)
    v_mfma_f32_16x16x32_bf16 v[88:91], a[0:3], a[104:107], v[88:91]
    ds_read_b128 a[96:99], v16 offset:4096
    ds_read_b64_tr_b16 a[56:57], v19 offset:0
    v_mfma_f32_16x16x32_bf16 v[88:91], a[4:7], a[108:111], v[88:91]
    ds_read_b128 a[100:103], v17 offset:4096
    v_mfma_f32_16x16x32_bf16 v[92:95], a[8:11], a[104:107], v[92:95]
    buffer_load_dwordx4 v6, s[16:19], s72 offen lds
    v_mfma_f32_16x16x32_bf16 v[92:95], a[12:15], a[108:111], v[92:95]
    ds_read_b64_tr_b16 a[58:59], v19 offset:512
    v_mfma_f32_16x16x32_bf16 v[96:99], a[104:107], a[16:19], v[96:99]
    v_mfma_f32_16x16x32_bf16 v[96:99], a[108:111], a[20:23], v[96:99]
    buffer_load_dwordx4 v7, s[16:19], s72 offen offset:1024 lds
    v_mfma_f32_16x16x32_bf16 v[100:103], a[104:107], a[24:27], v[100:103]
    v_mfma_f32_16x16x32_bf16 v[100:103], a[108:111], a[28:31], v[100:103]
    ds_read_b64_tr_b16 a[60:61], v19 offset:4096
    v_mfma_f32_16x16x32_bf16 v[104:107], a[104:107], a[32:35], v[104:107]
    v_mfma_f32_16x16x32_bf16 v[104:107], a[108:111], a[36:39], v[104:107]
    v_mfma_f32_16x16x32_bf16 v[108:111], a[104:107], a[40:43], v[108:111]
    buffer_load_dwordx4 v8, s[16:19], s72 offen offset:2048 lds
    v_mfma_f32_16x16x32_bf16 v[108:111], a[108:111], a[44:47], v[108:111]
    ds_read_b64_tr_b16 a[62:63], v19 offset:4608
    s_waitcnt lgkmcnt(3)
    v_mfma_f32_16x16x32_bf16 v[112:115], a[0:3], a[96:99], v[112:115]
    ds_read_b128 a[104:107], v16 offset:6144
    ds_read_b64_tr_b16 a[198:199], v45 offset:0
    v_mfma_f32_16x16x32_bf16 v[112:115], a[4:7], a[100:103], v[112:115]
    ds_read_b128 a[108:111], v17 offset:6144
    ds_read_b64_tr_b16 a[64:65], v18 offset:8192
    v_mfma_f32_16x16x32_bf16 v[116:119], a[8:11], a[96:99], v[116:119]
    v_mfma_f32_16x16x32_bf16 v[116:119], a[12:15], a[100:103], v[116:119]
    v_mfma_f32_16x16x32_bf16 v[120:123], a[96:99], a[16:19], v[120:123]
    buffer_load_dwordx4 v9, s[16:19], s72 offen offset:3072 lds
    v_mfma_f32_16x16x32_bf16 v[120:123], a[100:103], a[20:23], v[120:123]
    s_add_u32 s72, s72, 128
    ds_read_b64_tr_b16 a[66:67], v18 offset:8704
    v_mfma_f32_16x16x32_bf16 v[124:127], a[96:99], a[24:27], v[124:127]
    v_mfma_f32_16x16x32_bf16 v[124:127], a[100:103], a[28:31], v[124:127]
    ds_read_b64_tr_b16 a[68:69], v18 offset:12288
    v_mfma_f32_16x16x32_bf16 v[128:131], a[96:99], a[32:35], v[128:131]
    s_add_u32 m0, s49, 114688
    v_mfma_f32_16x16x32_bf16 v[128:131], a[100:103], a[36:39], v[128:131]
    buffer_load_dwordx4 v10, s[20:23], s44 offen lds
    v_mfma_f32_16x16x32_bf16 v[132:135], a[96:99], a[40:43], v[132:135]
    ds_read_b64_tr_b16 a[70:71], v18 offset:12800
    v_mfma_f32_16x16x32_bf16 v[132:135], a[100:103], a[44:47], v[132:135]
    s_waitcnt lgkmcnt(4)
    v_mfma_f32_16x16x32_bf16 v[136:139], a[0:3], a[104:107], v[136:139]
    ds_read_b128 a[96:99], v16 offset:8192
    v_mfma_f32_16x16x32_bf16 v[136:139], a[4:7], a[108:111], v[136:139]
    ds_read_b128 a[100:103], v17 offset:8192
    v_mfma_f32_16x16x32_bf16 v[140:143], a[8:11], a[104:107], v[140:143]
    ds_read_b64_tr_b16 a[72:73], v19 offset:8192
    v_mfma_f32_16x16x32_bf16 v[140:143], a[12:15], a[108:111], v[140:143]
    buffer_load_dwordx4 v11, s[20:23], s44 offen offset:1024 lds
    v_mfma_f32_16x16x32_bf16 v[144:147], a[104:107], a[16:19], v[144:147]
    v_mfma_f32_16x16x32_bf16 v[144:147], a[108:111], a[20:23], v[144:147]
    ds_read_b64_tr_b16 a[74:75], v19 offset:8704
    v_mfma_f32_16x16x32_bf16 v[148:151], a[104:107], a[24:27], v[148:151]
    v_mfma_f32_16x16x32_bf16 v[148:151], a[108:111], a[28:31], v[148:151]
    ds_read_b64_tr_b16 a[202:203], v46 offset:0
    v_mfma_f32_16x16x32_bf16 v[152:155], a[104:107], a[32:35], v[152:155]
    buffer_load_dwordx4 v12, s[20:23], s44 offen offset:2048 lds
    v_mfma_f32_16x16x32_bf16 v[152:155], a[108:111], a[36:39], v[152:155]
    ds_read_b64_tr_b16 a[76:77], v19 offset:12288
    v_mfma_f32_16x16x32_bf16 v[156:159], a[104:107], a[40:43], v[156:159]
    v_mfma_f32_16x16x32_bf16 v[156:159], a[108:111], a[44:47], v[156:159]
    ds_read_b64_tr_b16 a[78:79], v19 offset:12800
    s_waitcnt lgkmcnt(5)
    v_mfma_f32_16x16x32_bf16 v[160:163], a[0:3], a[96:99], v[160:163]
    ds_read_b128 a[104:107], v16 offset:10240
    v_mfma_f32_16x16x32_bf16 v[160:163], a[4:7], a[100:103], v[160:163]
    ds_read_b128 a[108:111], v17 offset:10240
    v_mfma_f32_16x16x32_bf16 v[164:167], a[8:11], a[96:99], v[164:167]
    buffer_load_dwordx4 v13, s[20:23], s44 offen offset:3072 lds
    v_mfma_f32_16x16x32_bf16 v[164:167], a[12:15], a[100:103], v[164:167]
    ds_read_b64_tr_b16 a[80:81], v18 offset:16384
    v_mfma_f32_16x16x32_bf16 v[168:171], a[96:99], a[16:19], v[168:171]
    v_mfma_f32_16x16x32_bf16 v[168:171], a[100:103], a[20:23], v[168:171]
    ds_read_b64_tr_b16 a[82:83], v18 offset:16896
    v_mfma_f32_16x16x32_bf16 v[172:175], a[96:99], a[24:27], v[172:175]
    s_add_u32 m0, s49, 118784
    v_mfma_f32_16x16x32_bf16 v[172:175], a[100:103], a[28:31], v[172:175]
    buffer_load_dwordx4 v14, s[20:23], s44 offen lds
    v_mfma_f32_16x16x32_bf16 v[176:179], a[96:99], a[32:35], v[176:179]
    v_mfma_f32_16x16x32_bf16 v[176:179], a[100:103], a[36:39], v[176:179]
    ds_read_b64_tr_b16 a[84:85], v18 offset:20480
    v_mfma_f32_16x16x32_bf16 v[180:183], a[96:99], a[40:43], v[180:183]
    v_mfma_f32_16x16x32_bf16 v[180:183], a[100:103], a[44:47], v[180:183]
    s_waitcnt lgkmcnt(3)
    v_mfma_f32_16x16x32_bf16 v[184:187], a[0:3], a[104:107], v[184:187]
    ds_read_b128 a[96:99], v16 offset:12288
    ds_read_b64_tr_b16 a[86:87], v18 offset:20992
    v_mfma_f32_16x16x32_bf16 v[184:187], a[4:7], a[108:111], v[184:187]
    ds_read_b128 a[100:103], v17 offset:12288
    ds_read_b64_tr_b16 a[206:207], v47 offset:0
    v_mfma_f32_16x16x32_bf16 v[188:191], a[8:11], a[104:107], v[188:191]
    buffer_load_dwordx4 v15, s[20:23], s44 offen offset:1024 lds
    v_mfma_f32_16x16x32_bf16 v[188:191], a[12:15], a[108:111], v[188:191]
    s_add_u32 s44, s44, 393216
    ds_read_b64_tr_b16 a[88:89], v19 offset:16384
    v_mfma_f32_16x16x32_bf16 v[192:195], a[104:107], a[16:19], v[192:195]
    v_mfma_f32_16x16x32_bf16 v[192:195], a[108:111], a[20:23], v[192:195]
    v_mfma_f32_16x16x32_bf16 v[196:199], a[104:107], a[24:27], v[196:199]
    s_mov_b64 exec, 0x3f
    buffer_load_dword v39, v38, s[84:87], s73 offen
    s_mov_b64 exec, -1
    s_add_u32 s73, s73, 393216
    v_mfma_f32_16x16x32_bf16 v[196:199], a[108:111], a[28:31], v[196:199]
    ds_read_b64_tr_b16 a[90:91], v19 offset:16896
    v_mfma_f32_16x16x32_bf16 v[200:203], a[104:107], a[32:35], v[200:203]
    v_mfma_f32_16x16x32_bf16 v[200:203], a[108:111], a[36:39], v[200:203]
    ds_read_b64_tr_b16 a[92:93], v19 offset:20480
    v_mfma_f32_16x16x32_bf16 v[204:207], a[104:107], a[40:43], v[204:207]
    v_mfma_f32_16x16x32_bf16 v[204:207], a[108:111], a[44:47], v[204:207]
    s_add_u32 m0, s64, 2048
    s_waitcnt lgkmcnt(4)
    v_mfma_f32_16x16x32_bf16 v[208:211], a[0:3], a[96:99], v[208:211]
    ds_read_b128 a[104:107], v16 offset:14336
    ds_read_b64_tr_b16 a[94:95], v19 offset:20992
    v_mfma_f32_16x16x32_bf16 v[208:211], a[4:7], a[100:103], v[208:211]
    ds_read_b128 a[108:111], v17 offset:14336
    v_mfma_f32_16x16x32_bf16 v[212:215], a[8:11], a[96:99], v[212:215]
    buffer_load_dwordx4 v42, s[80:83], s52 offen offset:2048 lds
    v_mfma_f32_16x16x32_bf16 v[212:215], a[12:15], a[100:103], v[212:215]
    v_mfma_f32_16x16x32_bf16 v[216:219], a[96:99], a[16:19], v[216:219]
    v_mfma_f32_16x16x32_bf16 v[216:219], a[100:103], a[20:23], v[216:219]
    buffer_load_dwordx4 v43, s[80:83], s52 offen offset:3072 lds
    v_mfma_f32_16x16x32_bf16 v[220:223], a[96:99], a[24:27], v[220:223]
    s_add_u32 s52, s52, 65536
    v_mfma_f32_16x16x32_bf16 v[220:223], a[100:103], a[28:31], v[220:223]
    v_mfma_f32_16x16x32_bf16 v[224:227], a[96:99], a[32:35], v[224:227]
    v_mfma_f32_16x16x32_bf16 v[224:227], a[100:103], a[36:39], v[224:227]
    v_mfma_f32_16x16x32_bf16 v[228:231], a[96:99], a[40:43], v[228:231]
    v_mfma_f32_16x16x32_bf16 v[228:231], a[100:103], a[44:47], v[228:231]
K_W8:
    s_waitcnt vmcnt(9) lgkmcnt(0)
    s_barrier
    v_mfma_f32_16x16x32_bf16 v[232:235], a[0:3], a[104:107], v[232:235]
    ds_read_b128 a[96:99], v16 offset:32768
    v_mfma_f32_16x16x32_bf16 v[232:235], a[4:7], a[108:111], v[232:235]
    ds_read_b128 a[100:103], v17 offset:32768
    s_add_u32 m0, s45, 0
    v_mfma_f32_16x16x32_bf16 v[236:239], a[8:11], a[104:107], v[236:239]
    buffer_load_dwordx4 v2, s[16:19], s43 offen lds
    v_mfma_f32_16x16x32_bf16 v[236:239], a[12:15], a[108:111], v[236:239]
    s_bitcmp1_b32 s38, 0
    s_cselect_b32 s92, s76, s74
    s_cselect_b32 s93, s77, s75
    v_mfma_f32_16x16x32_bf16 v[240:243], a[104:107], a[16:19], v[240:243]
    v_mfma_f32_16x16x32_bf16 v[240:243], a[108:111], a[20:23], v[240:243]
    v_mfma_f32_16x16x32_bf16 v[244:247], a[104:107], a[24:27], v[244:247]
    v_mfma_f32_16x16x32_bf16 v[244:247], a[108:111], a[28:31], v[244:247]
    buffer_load_dwordx4 v3, s[16:19], s43 offen offset:1024 lds
    v_mfma_f32_16x16x32_bf16 v[248:251], a[104:107], a[32:35], v[248:251]
    s_and_b32 s93, s93, 0xffff
    v_mfma_f32_16x16x32_bf16 v[248:251], a[108:111], a[36:39], v[248:251]
    v_mfma_f32_16x16x32_bf16 v[252:255], a[104:107], a[40:43], v[252:255]
    v_mfma_f32_16x16x32_bf16 v[252:255], a[108:111], a[44:47], v[252:255]
    s_waitcnt lgkmcnt(0)
    v_mfma_f32_16x16x32_bf16 v[64:67], a[48:51], a[96:99], v[64:67]
    ds_read_b128 a[104:107], v16 offset:34816
    ds_read_b64_tr_b16 a[0:1], v20 offset:0
    v_mfma_f32_16x16x32_bf16 v[64:67], a[52:55], a[100:103], v[64:67]
    ds_read_b128 a[108:111], v17 offset:34816
    v_mfma_f32_16x16x32_bf16 v[68:71], a[56:59], a[96:99], v[68:71]
    buffer_load_dwordx4 v4, s[16:19], s43 offen offset:2048 lds
    v_mfma_f32_16x16x32_bf16 v[68:71], a[60:63], a[100:103], v[68:71]
    ds_read_b64_tr_b16 a[2:3], v20 offset:512
    s_mov_b32 s94, 2097152
    v_mfma_f32_16x16x32_bf16 v[72:75], a[96:99], a[64:67], v[72:75]
    v_mfma_f32_16x16x32_bf16 v[72:75], a[100:103], a[68:71], v[72:75]
    buffer_load_dwordx4 v5, s[16:19], s43 offen offset:3072 lds
    v_mfma_f32_16x16x32_bf16 v[76:79], a[96:99], a[72:75], v[76:79]
    s_add_u32 s43, s43, 128
    ds_read_b64_tr_b16 a[4:5], v20 offset:4096
    v_mfma_f32_16x16x32_bf16 v[76:79], a[100:103], a[76:79], v[76:79]
    v_mfma_f32_16x16x32_bf16 v[80:83], a[96:99], a[80:83], v[80:83]
    v_mfma_f32_16x16x32_bf16 v[80:83], a[100:103], a[84:87], v[80:83]
    s_add_u32 m0, s45, 8192
    ds_read_b64_tr_b16 a[6:7], v20 offset:4608
    v_mfma_f32_16x16x32_bf16 v[84:87], a[96:99], a[88:91], v[84:87]
    buffer_load_dwordx4 v6, s[16:19], s72 offen lds
    v_mfma_f32_16x16x32_bf16 v[84:87], a[100:103], a[92:95], v[84:87]
    s_mov_b32 s95, 0x00020000
    s_waitcnt lgkmcnt(3)
    v_mfma_f32_16x16x32_bf16 v[88:91], a[48:51], a[104:107], v[88:91]
    ds_read_b128 a[96:99], v16 offset:36864
    ds_read_b64_tr_b16 a[8:9], v21 offset:0
    v_mfma_f32_16x16x32_bf16 v[88:91], a[52:55], a[108:111], v[88:91]
    ds_read_b128 a[100:103], v17 offset:36864
    v_mfma_f32_16x16x32_bf16 v[92:95], a[56:59], a[104:107], v[92:95]
    v_mfma_f32_16x16x32_bf16 v[92:95], a[60:63], a[108:111], v[92:95]
    buffer_load_dwordx4 v7, s[16:19], s72 offen offset:1024 lds
    v_mfma_f32_16x16x32_bf16 v[96:99], a[104:107], a[64:67], v[96:99]
    ds_read_b64_tr_b16 a[10:11], v21 offset:512
    v_mfma_f32_16x16x32_bf16 v[96:99], a[108:111], a[68:71], v[96:99]
    v_mfma_f32_16x16x32_bf16 v[100:103], a[104:107], a[72:75], v[100:103]
    s_lshl_b32 s78, s2, 1
    v_mfma_f32_16x16x32_bf16 v[100:103], a[108:111], a[76:79], v[100:103]
    ds_read_b64_tr_b16 a[12:13], v21 offset:4096
    v_mfma_f32_16x16x32_bf16 v[104:107], a[104:107], a[80:83], v[104:107]
    v_mfma_f32_16x16x32_bf16 v[104:107], a[108:111], a[84:87], v[104:107]
    buffer_load_dwordx4 v8, s[16:19], s72 offen offset:2048 lds
    v_mfma_f32_16x16x32_bf16 v[108:111], a[104:107], a[88:91], v[108:111]
    ds_read_b64_tr_b16 a[14:15], v21 offset:4608
    v_mfma_f32_16x16x32_bf16 v[108:111], a[108:111], a[92:95], v[108:111]
    s_waitcnt lgkmcnt(3)
    v_mfma_f32_16x16x32_bf16 v[112:115], a[48:51], a[96:99], v[112:115]
    ds_read_b128 a[104:107], v16 offset:38912
    v_mfma_f32_16x16x32_bf16 v[112:115], a[52:55], a[100:103], v[112:115]
    ds_read_b128 a[108:111], v17 offset:38912
    ds_read_b64_tr_b16 a[16:17], v20 offset:8192
    v_mfma_f32_16x16x32_bf16 v[116:119], a[56:59], a[96:99], v[116:119]
    buffer_load_dwordx4 v9, s[16:19], s72 offen offset:3072 lds
    v_mfma_f32_16x16x32_bf16 v[116:119], a[60:63], a[100:103], v[116:119]
    s_add_u32 s72, s72, 128
    s_add_u32 s78, s78, s40
    v_mfma_f32_16x16x32_bf16 v[120:123], a[96:99], a[64:67], v[120:123]
    ds_read_b64_tr_b16 a[18:19], v20 offset:8704
    v_mfma_f32_16x16x32_bf16 v[120:123], a[100:103], a[68:71], v[120:123]
    v_mfma_f32_16x16x32_bf16 v[124:127], a[96:99], a[72:75], v[124:127]
    s_add_u32 m0, s49, 65536
    v_mfma_f32_16x16x32_bf16 v[124:127], a[100:103], a[76:79], v[124:127]
    buffer_load_dwordx4 v10, s[20:23], s44 offen lds
    v_mfma_f32_16x16x32_bf16 v[128:131], a[96:99], a[80:83], v[128:131]
    ds_read_b64_tr_b16 a[20:21], v20 offset:12288
    v_mfma_f32_16x16x32_bf16 v[128:131], a[100:103], a[84:87], v[128:131]
    v_mfma_f32_16x16x32_bf16 v[132:135], a[96:99], a[88:91], v[132:135]
    ds_read_b64_tr_b16 a[22:23], v20 offset:12800
    s_lshl_b32 s78, s78, 12
    v_mfma_f32_16x16x32_bf16 v[132:135], a[100:103], a[92:95], v[132:135]
    s_waitcnt lgkmcnt(4)
    v_mfma_f32_16x16x32_bf16 v[136:139], a[48:51], a[104:107], v[136:139]
    ds_read_b128 a[96:99], v16 offset:40960
    v_mfma_f32_16x16x32_bf16 v[136:139], a[52:55], a[108:111], v[136:139]
    ds_read_b128 a[100:103], v17 offset:40960
    v_mfma_f32_16x16x32_bf16 v[140:143], a[56:59], a[104:107], v[140:143]
    buffer_load_dwordx4 v11, s[20:23], s44 offen offset:1024 lds
    v_mfma_f32_16x16x32_bf16 v[140:143], a[60:63], a[108:111], v[140:143]
    ds_read_b64_tr_b16 a[24:25], v21 offset:8192
    v_mfma_f32_16x16x32_bf16 v[144:147], a[104:107], a[64:67], v[144:147]
    v_mfma_f32_16x16x32_bf16 v[144:147], a[108:111], a[68:71], v[144:147]
    buffer_load_dwordx4 v12, s[20:23], s44 offen offset:2048 lds
    v_mfma_f32_16x16x32_bf16 v[148:151], a[104:107], a[72:75], v[148:151]
    ds_read_b64_tr_b16 a[26:27], v21 offset:8704
    v_mfma_f32_16x16x32_bf16 v[148:151], a[108:111], a[76:79], v[148:151]
    v_mfma_f32_16x16x32_bf16 v[152:155], a[104:107], a[80:83], v[152:155]
    ds_read_b64_tr_b16 a[28:29], v21 offset:12288
    v_mfma_f32_16x16x32_bf16 v[152:155], a[108:111], a[84:87], v[152:155]
    v_mfma_f32_16x16x32_bf16 v[156:159], a[104:107], a[88:91], v[156:159]
    buffer_load_dwordx4 v13, s[20:23], s44 offen offset:3072 lds
    v_mfma_f32_16x16x32_bf16 v[156:159], a[108:111], a[92:95], v[156:159]
    ds_read_b64_tr_b16 a[30:31], v21 offset:12800
    s_waitcnt lgkmcnt(4)
    v_mfma_f32_16x16x32_bf16 v[160:163], a[48:51], a[96:99], v[160:163]
    ds_read_b128 a[104:107], v16 offset:43008
    v_mfma_f32_16x16x32_bf16 v[160:163], a[52:55], a[100:103], v[160:163]
    ds_read_b128 a[108:111], v17 offset:43008
    ds_read_b64_tr_b16 a[208:209], v44 offset:2048
    v_mfma_f32_16x16x32_bf16 v[164:167], a[56:59], a[96:99], v[164:167]
    s_add_u32 m0, s49, 69632
    ds_read_b64_tr_b16 a[32:33], v20 offset:16384
    v_mfma_f32_16x16x32_bf16 v[164:167], a[60:63], a[100:103], v[164:167]
    buffer_load_dwordx4 v14, s[20:23], s44 offen lds
    v_mfma_f32_16x16x32_bf16 v[168:171], a[96:99], a[64:67], v[168:171]
    v_mfma_f32_16x16x32_bf16 v[168:171], a[100:103], a[68:71], v[168:171]
    ds_read_b64_tr_b16 a[34:35], v20 offset:16896
    v_mfma_f32_16x16x32_bf16 v[172:175], a[96:99], a[72:75], v[172:175]
    v_mfma_f32_16x16x32_bf16 v[172:175], a[100:103], a[76:79], v[172:175]
    v_mfma_f32_16x16x32_bf16 v[176:179], a[96:99], a[80:83], v[176:179]
    v_mfma_f32_16x16x32_bf16 v[176:179], a[100:103], a[84:87], v[176:179]
    buffer_load_dwordx4 v15, s[20:23], s44 offen offset:1024 lds
    v_mfma_f32_16x16x32_bf16 v[180:183], a[96:99], a[88:91], v[180:183]
    s_add_u32 s44, s44, 393216
    ds_read_b64_tr_b16 a[36:37], v20 offset:20480
    v_mfma_f32_16x16x32_bf16 v[180:183], a[100:103], a[92:95], v[180:183]
    ds_read_b64_tr_b16 a[212:213], v45 offset:2048
    s_waitcnt lgkmcnt(5)
    v_mfma_f32_16x16x32_bf16 v[184:187], a[48:51], a[104:107], v[184:187]
    ds_read_b128 a[96:99], v16 offset:45056
    ds_read_b64_tr_b16 a[38:39], v20 offset:20992
    v_mfma_f32_16x16x32_bf16 v[184:187], a[52:55], a[108:111], v[184:187]
    ds_read_b128 a[100:103], v17 offset:45056
    v_mfma_f32_16x16x32_bf16 v[188:191], a[56:59], a[104:107], v[188:191]
    s_mov_b64 exec, 0x3f
    buffer_load_dword v39, v38, s[84:87], s73 offen
    s_mov_b64 exec, -1
    s_add_u32 s73, s73, 393216
    v_mfma_f32_16x16x32_bf16 v[188:191], a[60:63], a[108:111], v[188:191]
    ds_read_b64_tr_b16 a[40:41], v21 offset:16384
    v_mfma_f32_16x16x32_bf16 v[192:195], a[104:107], a[64:67], v[192:195]
    ds_read_b64_tr_b16 a[216:217], v46 offset:2048
    v_mfma_f32_16x16x32_bf16 v[192:195], a[108:111], a[68:71], v[192:195]
    v_mfma_f32_16x16x32_bf16 v[196:199], a[104:107], a[72:75], v[196:199]
    ds_read_b64_tr_b16 a[42:43], v21 offset:16896
    v_mfma_f32_16x16x32_bf16 v[196:199], a[108:111], a[76:79], v[196:199]
    s_cmp_lg_u32 s38, 0
    s_cbranch_scc1 K_NOATOM
    s_mov_b64 exec, 1
    buffer_atomic_add v28, v29, s[28:31], s63 offen sc1
    s_mov_b64 exec, -1
K_NOATOM:
    v_mfma_f32_16x16x32_bf16 v[200:203], a[104:107], a[80:83], v[200:203]
    v_mfma_f32_16x16x32_bf16 v[200:203], a[108:111], a[84:87], v[200:203]
    ds_read_b64_tr_b16 a[44:45], v21 offset:20480
    v_mfma_f32_16x16x32_bf16 v[204:207], a[104:107], a[88:91], v[204:207]
    v_mfma_f32_16x16x32_bf16 v[204:207], a[108:111], a[92:95], v[204:207]
    s_add_u32 m0, s64, 0
    s_waitcnt lgkmcnt(4)
    v_mfma_f32_16x16x32_bf16 v[208:211], a[48:51], a[96:99], v[208:211]
    ds_read_b128 a[104:107], v16 offset:47104
    ds_read_b64_tr_b16 a[46:47], v21 offset:20992
    v_mfma_f32_16x16x32_bf16 v[208:211], a[52:55], a[100:103], v[208:211]
    ds_read_b128 a[108:111], v17 offset:47104
    ds_read_b64_tr_b16 a[220:221], v47 offset:2048
    v_mfma_f32_16x16x32_bf16 v[212:215], a[56:59], a[96:99], v[212:215]
    buffer_load_dwordx4 v40, s[80:83], s52 offen lds
    v_mfma_f32_16x16x32_bf16 v[212:215], a[60:63], a[100:103], v[212:215]
    v_mfma_f32_16x16x32_bf16 v[216:219], a[96:99], a[64:67], v[216:219]
    v_mfma_f32_16x16x32_bf16 v[216:219], a[100:103], a[68:71], v[216:219]
    buffer_load_dwordx4 v41, s[80:83], s52 offen offset:1024 lds
    v_mfma_f32_16x16x32_bf16 v[220:223], a[96:99], a[72:75], v[220:223]
    v_mfma_f32_16x16x32_bf16 v[220:223], a[100:103], a[76:79], v[220:223]
    v_mfma_f32_16x16x32_bf16 v[224:227], a[96:99], a[80:83], v[224:227]
    v_mfma_f32_16x16x32_bf16 v[224:227], a[100:103], a[84:87], v[224:227]
    v_mfma_f32_16x16x32_bf16 v[228:231], a[96:99], a[88:91], v[228:231]
    v_mfma_f32_16x16x32_bf16 v[228:231], a[100:103], a[92:95], v[228:231]
K_W9:
    s_waitcnt vmcnt(9) lgkmcnt(0)
    s_barrier
    v_mfma_f32_16x16x32_bf16 v[232:235], a[48:51], a[104:107], v[232:235]
    ds_read_b128 a[96:99], v16 offset:0
    v_mfma_f32_16x16x32_bf16 v[232:235], a[52:55], a[108:111], v[232:235]
    ds_read_b128 a[100:103], v17 offset:0
    s_add_u32 m0, s45, 32768
    v_mfma_f32_16x16x32_bf16 v[236:239], a[56:59], a[104:107], v[236:239]
    buffer_load_dwordx4 v2, s[16:19], s43 offen lds
    v_mfma_f32_16x16x32_bf16 v[236:239], a[60:63], a[108:111], v[236:239]
    v_mfma_f32_16x16x32_bf16 v[240:243], a[104:107], a[64:67], v[240:243]
    v_mfma_f32_16x16x32_bf16 v[240:243], a[108:111], a[68:71], v[240:243]
    v_mfma_f32_16x16x32_bf16 v[244:247], a[104:107], a[72:75], v[244:247]
    v_mfma_f32_16x16x32_bf16 v[244:247], a[108:111], a[76:79], v[244:247]
    buffer_load_dwordx4 v3, s[16:19], s43 offen offset:1024 lds
    v_mfma_f32_16x16x32_bf16 v[248:251], a[104:107], a[80:83], v[248:251]
    v_mfma_f32_16x16x32_bf16 v[248:251], a[108:111], a[84:87], v[248:251]
    v_mfma_f32_16x16x32_bf16 v[252:255], a[104:107], a[88:91], v[252:255]
    v_mfma_f32_16x16x32_bf16 v[252:255], a[108:111], a[92:95], v[252:255]
    s_waitcnt lgkmcnt(0)
    v_mfma_f32_16x16x32_bf16 v[64:67], a[0:3], a[96:99], v[64:67]
    ds_read_b128 a[104:107], v16 offset:2048
    ds_read_b64_tr_b16 a[48:49], v22 offset:0
    v_mfma_f32_16x16x32_bf16 v[64:67], a[4:7], a[100:103], v[64:67]
    ds_read_b128 a[108:111], v17 offset:2048
    v_mfma_f32_16x16x32_bf16 v[68:71], a[8:11], a[96:99], v[68:71]
    buffer_load_dwordx4 v4, s[16:19], s43 offen offset:2048 lds
    v_mfma_f32_16x16x32_bf16 v[68:71], a[12:15], a[100:103], v[68:71]
    ds_read_b64_tr_b16 a[50:51], v22 offset:512
    v_mfma_f32_16x16x32_bf16 v[72:75], a[96:99], a[16:19], v[72:75]
    v_mfma_f32_16x16x32_bf16 v[72:75], a[100:103], a[20:23], v[72:75]
    buffer_load_dwordx4 v5, s[16:19], s43 offen offset:3072 lds
    v_mfma_f32_16x16x32_bf16 v[76:79], a[96:99], a[24:27], v[76:79]
    s_add_u32 s43, s43, 128
    ds_read_b64_tr_b16 a[52:53], v22 offset:4096
    v_mfma_f32_16x16x32_bf16 v[76:79], a[100:103], a[28:31], v[76:79]
    ds_read_b64_tr_b16 a[210:211], v44 offset:4096
    v_mfma_f32_16x16x32_bf16 v[80:83], a[96:99], a[32:35], v[80:83]
    v_mfma_f32_16x16x32_bf16 v[80:83], a[100:103], a[36:39], v[80:83]
    s_add_u32 m0, s45, 40960
    ds_read_b64_tr_b16 a[54:55], v22 offset:4608
    v_mfma_f32_16x16x32_bf16 v[84:87], a[96:99], a[40:43], v[84:87]
    buffer_load_dwordx4 v6, s[16:19], s72 offen lds
    v_mfma_f32_16x16x32_bf16 v[84:87], a[100:103], a[44:47], v[84:87]
    s_waitcnt lgkmcnt(4)
    v_mfma_f32_16x16x32_bf16 v[88:91], a[0:3], a[104:107], v[88:91]
    ds_read_b128 a[96:99], v16 offset:4096
    ds_read_b64_tr_b16 a[56:57], v23 offset:0
    v_mfma_f32_16x16x32_bf16 v[88:91], a[4:7], a[108:111], v[88:91]
    ds_read_b128 a[100:103], v17 offset:4096
    v_mfma_f32_16x16x32_bf16 v[92:95], a[8:11], a[104:107], v[92:95]
    v_mfma_f32_16x16x32_bf16 v[92:95], a[12:15], a[108:111], v[92:95]
    buffer_load_dwordx4 v7, s[16:19], s72 offen offset:1024 lds
    v_mfma_f32_16x16x32_bf16 v[96:99], a[104:107], a[16:19], v[96:99]
    ds_read_b64_tr_b16 a[58:59], v23 offset:512
    v_mfma_f32_16x16x32_bf16 v[96:99], a[108:111], a[20:23], v[96:99]
    v_mfma_f32_16x16x32_bf16 v[100:103], a[104:107], a[24:27], v[100:103]
    v_mfma_f32_16x16x32_bf16 v[100:103], a[108:111], a[28:31], v[100:103]
    ds_read_b64_tr_b16 a[60:61], v23 offset:4096
    v_mfma_f32_16x16x32_bf16 v[104:107], a[104:107], a[32:35], v[104:107]
    v_mfma_f32_16x16x32_bf16 v[104:107], a[108:111], a[36:39], v[104:107]
    buffer_load_dwordx4 v8, s[16:19], s72 offen offset:2048 lds
    v_mfma_f32_16x16x32_bf16 v[108:111], a[104:107], a[40:43], v[108:111]
    ds_read_b64_tr_b16 a[62:63], v23 offset:4608
    v_mfma_f32_16x16x32_bf16 v[108:111], a[108:111], a[44:47], v[108:111]
    s_waitcnt lgkmcnt(3)
    v_mfma_f32_16x16x32_bf16 v[112:115], a[0:3], a[96:99], v[112:115]
    ds_read_b128 a[104:107], v16 offset:6144
    ds_read_b64_tr_b16 a[214:215], v45 offset:4096
    v_mfma_f32_16x16x32_bf16 v[112:115], a[4:7], a[100:103], v[112:115]
    ds_read_b128 a[108:111], v17 offset:6144
    ds_read_b64_tr_b16 a[64:65], v22 offset:8192
    v_mfma_f32_16x16x32_bf16 v[116:119], a[8:11], a[96:99], v[116:119]
    buffer_load_dwordx4 v9, s[16:19], s72 offen offset:3072 lds
    v_mfma_f32_16x16x32_bf16 v[116:119], a[12:15], a[100:103], v[116:119]
    s_add_u32 s72, s72, 128
    v_mfma_f32_16x16x32_bf16 v[120:123], a[96:99], a[16:19], v[120:123]
    ds_read_b64_tr_b16 a[66:67], v22 offset:8704
    v_mfma_f32_16x16x32_bf16 v[120:123], a[100:103], a[20:23], v[120:123]
    v_mfma_f32_16x16x32_bf16 v[124:127], a[96:99], a[24:27], v[124:127]
    s_add_u32 m0, s49, 90112
    v_mfma_f32_16x16x32_bf16 v[124:127], a[100:103], a[28:31], v[124:127]
    buffer_load_dwordx4 v10, s[20:23], s44 offen lds
    v_mfma_f32_16x16x32_bf16 v[128:131], a[96:99], a[32:35], v[128:131]
    ds_read_b64_tr_b16 a[68:69], v22 offset:12288
    v_mfma_f32_16x16x32_bf16 v[128:131], a[100:103], a[36:39], v[128:131]
    v_mfma_f32_16x16x32_bf16 v[132:135], a[96:99], a[40:43], v[132:135]
    ds_read_b64_tr_b16 a[70:71], v22 offset:12800
    v_mfma_f32_16x16x32_bf16 v[132:135], a[100:103], a[44:47], v[132:135]
    s_waitcnt lgkmcnt(4)
    v_mfma_f32_16x16x32_bf16 v[136:139], a[0:3], a[104:107], v[136:139]
    ds_read_b128 a[96:99], v16 offset:8192
    v_mfma_f32_16x16x32_bf16 v[136:139], a[4:7], a[108:111], v[136:139]
    ds_read_b128 a[100:103], v17 offset:8192
    v_mfma_f32_16x16x32_bf16 v[140:143], a[8:11], a[104:107], v[140:143]
    buffer_load_dwordx4 v11, s[20:23], s44 offen offset:1024 lds
    v_mfma_f32_16x16x32_bf16 v[140:143], a[12:15], a[108:111], v[140:143]
    ds_read_b64_tr_b16 a[72:73], v23 offset:8192
    v_mfma_f32_16x16x32_bf16 v[144:147], a[104:107], a[16:19], v[144:147]
    v_mfma_f32_16x16x32_bf16 v[144:147], a[108:111], a[20:23], v[144:147]
    buffer_load_dwordx4 v12, s[20:23], s44 offen offset:2048 lds
    v_mfma_f32_16x16x32_bf16 v[148:151], a[104:107], a[24:27], v[148:151]
    ds_read_b64_tr_b16 a[74:75], v23 offset:8704
    v_mfma_f32_16x16x32_bf16 v[148:151], a[108:111], a[28:31], v[148:151]
    ds_read_b64_tr_b16 a[218:219], v46 offset:4096
    v_mfma_f32_16x16x32_bf16 v[152:155], a[104:107], a[32:35], v[152:155]
    ds_read_b64_tr_b16 a[76:77], v23 offset:12288
    v_mfma_f32_16x16x32_bf16 v[152:155], a[108:111], a[36:39], v[152:155]
    v_mfma_f32_16x16x32_bf16 v[156:159], a[104:107], a[40:43], v[156:159]
    buffer_load_dwordx4 v13, s[20:23], s44 offen offset:3072 lds
    v_mfma_f32_16x16x32_bf16 v[156:159], a[108:111], a[44:47], v[156:159]
    ds_read_b64_tr_b16 a[78:79], v23 offset:12800
    s_waitcnt lgkmcnt(5)
    v_mfma_f32_16x16x32_bf16 v[160:163], a[0:3], a[96:99], v[160:163]
    ds_read_b128 a[104:107], v16 offset:10240
    v_mfma_f32_16x16x32_bf16 v[160:163], a[4:7], a[100:103], v[160:163]
    ds_read_b128 a[108:111], v17 offset:10240
    v_mfma_f32_16x16x32_bf16 v[164:167], a[8:11], a[96:99], v[164:167]
    s_add_u32 m0, s49, 94208
    ds_read_b64_tr_b16 a[80:81], v22 offset:16384
    v_mfma_f32_16x16x32_bf16 v[164:167], a[12:15], a[100:103], v[164:167]
    buffer_load_dwordx4 v14, s[20:23], s44 offen lds
    v_mfma_f32_16x16x32_bf16 v[168:171], a[96:99], a[16:19], v[168:171]
    v_mfma_f32_16x16x32_bf16 v[168:171], a[100:103], a[20:23], v[168:171]
    ds_read_b64_tr_b16 a[82:83], v22 offset:16896
    v_mfma_f32_16x16x32_bf16 v[172:175], a[96:99], a[24:27], v[172:175]
    v_mfma_f32_16x16x32_bf16 v[172:175], a[100:103], a[28:31], v[172:175]
    v_mfma_f32_16x16x32_bf16 v[176:179], a[96:99], a[32:35], v[176:179]
    v_mfma_f32_16x16x32_bf16 v[176:179], a[100:103], a[36:39], v[176:179]
    buffer_load_dwordx4 v15, s[20:23], s44 offen offset:1024 lds
    v_mfma_f32_16x16x32_bf16 v[180:183], a[96:99], a[40:43], v[180:183]
    s_add_u32 s44, s44, 393216
    ds_read_b64_tr_b16 a[84:85], v22 offset:20480
    v_mfma_f32_16x16x32_bf16 v[180:183], a[100:103], a[44:47], v[180:183]
    s_waitcnt lgkmcnt(3)
    v_mfma_f32_16x16x32_bf16 v[184:187], a[0:3], a[104:107], v[184:187]
    ds_read_b128 a[96:99], v16 offset:12288
    ds_read_b64_tr_b16 a[86:87], v22 offset:20992
    v_mfma_f32_16x16x32_bf16 v[184:187], a[4:7], a[108:111], v[184:187]
    ds_read_b128 a[100:103], v17 offset:12288
    ds_read_b64_tr_b16 a[222:223], v47 offset:4096
    v_mfma_f32_16x16x32_bf16 v[188:191], a[8:11], a[104:107], v[188:191]
    s_mov_b64 exec, 0x3f
    buffer_load_dword v39, v38, s[84:87], s73 offen
    s_mov_b64 exec, -1
    s_add_u32 s73, s73, 393216
    v_mfma_f32_16x16x32_bf16 v[188:191], a[12:15], a[108:111], v[188:191]
    ds_read_b64_tr_b16 a[88:89], v23 offset:16384
    v_mfma_f32_16x16x32_bf16 v[192:195], a[104:107], a[16:19], v[192:195]
    v_mfma_f32_16x16x32_bf16 v[192:195], a[108:111], a[20:23], v[192:195]
    v_mfma_f32_16x16x32_bf16 v[196:199], a[104:107], a[24:27], v[196:199]
    ds_read_b64_tr_b16 a[90:91], v23 offset:16896
    v_mfma_f32_16x16x32_bf16 v[196:199], a[108:111], a[28:31], v[196:199]
    s_mov_b64 exec, 0xff
    buffer_load_dword v39, v38, s[92:95], s78 offen offset:0
    s_mov_b64 exec, -1
    v_mfma_f32_16x16x32_bf16 v[200:203], a[104:107], a[32:35], v[200:203]
    v_mfma_f32_16x16x32_bf16 v[200:203], a[108:111], a[36:39], v[200:203]
    ds_read_b64_tr_b16 a[92:93], v23 offset:20480
    v_mfma_f32_16x16x32_bf16 v[204:207], a[104:107], a[40:43], v[204:207]
    v_mfma_f32_16x16x32_bf16 v[204:207], a[108:111], a[44:47], v[204:207]
    s_add_u32 m0, s64, 0
    s_waitcnt lgkmcnt(4)
    v_mfma_f32_16x16x32_bf16 v[208:211], a[0:3], a[96:99], v[208:211]
    ds_read_b128 a[104:107], v16 offset:14336
    ds_read_b64_tr_b16 a[94:95], v23 offset:20992
    v_mfma_f32_16x16x32_bf16 v[208:211], a[4:7], a[100:103], v[208:211]
    ds_read_b128 a[108:111], v17 offset:14336
    v_mfma_f32_16x16x32_bf16 v[212:215], a[8:11], a[96:99], v[212:215]
    buffer_load_dwordx4 v42, s[80:83], s52 offen offset:2048 lds
    v_mfma_f32_16x16x32_bf16 v[212:215], a[12:15], a[100:103], v[212:215]
    v_mfma_f32_16x16x32_bf16 v[216:219], a[96:99], a[16:19], v[216:219]
    v_mfma_f32_16x16x32_bf16 v[216:219], a[100:103], a[20:23], v[216:219]
    buffer_load_dwordx4 v43, s[80:83], s52 offen offset:3072 lds
    v_mfma_f32_16x16x32_bf16 v[220:223], a[96:99], a[24:27], v[220:223]
    s_add_u32 s52, s52, 65536
    v_mfma_f32_16x16x32_bf16 v[220:223], a[100:103], a[28:31], v[220:223]
    v_mfma_f32_16x16x32_bf16 v[224:227], a[96:99], a[32:35], v[224:227]
    v_mfma_f32_16x16x32_bf16 v[224:227], a[100:103], a[36:39], v[224:227]
    v_mfma_f32_16x16x32_bf16 v[228:231], a[96:99], a[40:43], v[228:231]
    v_mfma_f32_16x16x32_bf16 v[228:231], a[100:103], a[44:47], v[228:231]
K_W10:
    s_waitcnt vmcnt(10) lgkmcnt(0)
    s_barrier
    v_mfma_f32_16x16x32_bf16 v[232:235], a[0:3], a[104:107], v[232:235]
    ds_read_b128 a[96:99], v16 offset:32768
    v_mfma_f32_16x16x32_bf16 v[232:235], a[4:7], a[108:111], v[232:235]
    ds_read_b128 a[100:103], v17 offset:32768
    s_add_u32 m0, s45, 0
    v_mfma_f32_16x16x32_bf16 v[236:239], a[8:11], a[104:107], v[236:239]
    buffer_load_dwordx4 v2, s[16:19], s43 offen lds
    v_mfma_f32_16x16x32_bf16 v[236:239], a[12:15], a[108:111], v[236:239]
    v_mfma_f32_16x16x32_bf16 v[240:243], a[104:107], a[16:19], v[240:243]
    v_mfma_f32_16x16x32_bf16 v[240:243], a[108:111], a[20:23], v[240:243]
    v_mfma_f32_16x16x32_bf16 v[244:247], a[104:107], a[24:27], v[244:247]
    v_mfma_f32_16x16x32_bf16 v[244:247], a[108:111], a[28:31], v[244:247]
    buffer_load_dwordx4 v3, s[16:19], s43 offen offset:1024 lds
    v_mfma_f32_16x16x32_bf16 v[248:251], a[104:107], a[32:35], v[248:251]
    v_mfma_f32_16x16x32_bf16 v[248:251], a[108:111], a[36:39], v[248:251]
    v_mfma_f32_16x16x32_bf16 v[252:255], a[104:107], a[40:43], v[252:255]
    v_mfma_f32_16x16x32_bf16 v[252:255], a[108:111], a[44:47], v[252:255]
    s_waitcnt lgkmcnt(0)
    v_mfma_f32_16x16x32_bf16 v[64:67], a[48:51], a[96:99], v[64:67]
    ds_read_b128 a[104:107], v16 offset:34816
    ds_read_b64_tr_b16 a[0:1], v18 offset:0
    v_mfma_f32_16x16x32_bf16 v[64:67], a[52:55], a[100:103], v[64:67]
    ds_read_b128 a[108:111], v17 offset:34816
    v_mfma_f32_16x16x32_bf16 v[68:71], a[56:59], a[96:99], v[68:71]
    buffer_load_dwordx4 v4, s[16:19], s43 offen offset:2048 lds
    v_mfma_f32_16x16x32_bf16 v[68:71], a[60:63], a[100:103], v[68:71]
    ds_read_b64_tr_b16 a[2:3], v18 offset:512
    v_mfma_f32_16x16x32_bf16 v[72:75], a[96:99], a[64:67], v[72:75]
    v_mfma_f32_16x16x32_bf16 v[72:75], a[100:103], a[68:71], v[72:75]
    v_mfma_f32_16x16x32_bf16 v[76:79], a[96:99], a[72:75], v[76:79]
    buffer_load_dwordx4 v5, s[16:19], s43 offen offset:3072 lds
    v_mfma_f32_16x16x32_bf16 v[76:79], a[100:103], a[76:79], v[76:79]
    s_add_u32 s43, s43, 128
    ds_read_b64_tr_b16 a[4:5], v18 offset:4096
    v_mfma_f32_16x16x32_bf16 v[80:83], a[96:99], a[80:83], v[80:83]
    ds_read_b64_tr_b16 a[224:225], v44 offset:0
    v_mfma_f32_16x16x32_bf16 v[80:83], a[100:103], a[84:87], v[80:83]
    ds_read_b64_tr_b16 a[6:7], v18 offset:4608
    v_mfma_f32_16x16x32_bf16 v[84:87], a[96:99], a[88:91], v[84:87]
    s_add_u32 m0, s45, 8192
    v_mfma_f32_16x16x32_bf16 v[84:87], a[100:103], a[92:95], v[84:87]
    s_waitcnt lgkmcnt(4)
    v_mfma_f32_16x16x32_bf16 v[88:91], a[48:51], a[104:107], v[88:91]
    ds_read_b128 a[96:99], v16 offset:36864
    ds_read_b64_tr_b16 a[8:9], v19 offset:0
    v_mfma_f32_16x16x32_bf16 v[88:91], a[52:55], a[108:111], v[88:91]
    ds_read_b128 a[100:103], v17 offset:36864
    v_mfma_f32_16x16x32_bf16 v[92:95], a[56:59], a[104:107], v[92:95]
    buffer_load_dwordx4 v6, s[16:19], s72 offen lds
    v_mfma_f32_16x16x32_bf16 v[92:95], a[60:63], a[108:111], v[92:95]
    ds_read_b64_tr_b16 a[10:11], v19 offset:512
    v_mfma_f32_16x16x32_bf16 v[96:99], a[104:107], a[64:67], v[96:99]
    v_mfma_f32_16x16x32_bf16 v[96:99], a[108:111], a[68:71], v[96:99]
    buffer_load_dwordx4 v7, s[16:19], s72 offen offset:1024 lds
    v_mfma_f32_16x16x32_bf16 v[100:103], a[104:107], a[72:75], v[100:103]
    v_mfma_f32_16x16x32_bf16 v[100:103], a[108:111], a[76:79], v[100:103]
    ds_read_b64_tr_b16 a[12:13], v19 offset:4096
    v_mfma_f32_16x16x32_bf16 v[104:107], a[104:107], a[80:83], v[104:107]
    v_mfma_f32_16x16x32_bf16 v[104:107], a[108:111], a[84:87], v[104:107]
    v_mfma_f32_16x16x32_bf16 v[108:111], a[104:107], a[88:91], v[108:111]
    buffer_load_dwordx4 v8, s[16:19], s72 offen offset:2048 lds
    v_mfma_f32_16x16x32_bf16 v[108:111], a[108:111], a[92:95], v[108:111]
    ds_read_b64_tr_b16 a[14:15], v19 offset:4608
    s_waitcnt lgkmcnt(3)
    v_mfma_f32_16x16x32_bf16 v[112:115], a[48:51], a[96:99], v[112:115]
    ds_read_b128 a[104:107], v16 offset:38912
    ds_read_b64_tr_b16 a[228:229], v45 offset:0
    v_mfma_f32_16x16x32_bf16 v[112:115], a[52:55], a[100:103], v[112:115]
    ds_read_b128 a[108:111], v17 offset:38912
    ds_read_b64_tr_b16 a[16:17], v18 offset:8192
    v_mfma_f32_16x16x32_bf16 v[116:119], a[56:59], a[96:99], v[116:119]
    v_mfma_f32_16x16x32_bf16 v[116:119], a[60:63], a[100:103], v[116:119]
    v_mfma_f32_16x16x32_bf16 v[120:123], a[96:99], a[64:67], v[120:123]
    buffer_load_dwordx4 v9, s[16:19], s72 offen offset:3072 lds
    v_mfma_f32_16x16x32_bf16 v[120:123], a[100:103], a[68:71], v[120:123]
    s_add_u32 s72, s72, 128
    ds_read_b64_tr_b16 a[18:19], v18 offset:8704
    v_mfma_f32_16x16x32_bf16 v[124:127], a[96:99], a[72:75], v[124:127]
    v_mfma_f32_16x16x32_bf16 v[124:127], a[100:103], a[76:79], v[124:127]
    ds_read_b64_tr_b16 a[20:21], v18 offset:12288
    v_mfma_f32_16x16x32_bf16 v[128:131], a[96:99], a[80:83], v[128:131]
    s_add_u32 m0, s49, 114688
    v_mfma_f32_16x16x32_bf16 v[128:131], a[100:103], a[84:87], v[128:131]
    buffer_load_dwordx4 v10, s[20:23], s44 offen lds
    v_mfma_f32_16x16x32_bf16 v[132:135], a[96:99], a[88:91], v[132:135]
    ds_read_b64_tr_b16 a[22:23], v18 offset:12800
    v_mfma_f32_16x16x32_bf16 v[132:135], a[100:103], a[92:95], v[132:135]
    s_waitcnt lgkmcnt(4)
    v_mfma_f32_16x16x32_bf16 v[136:139], a[48:51], a[104:107], v[136:139]
    ds_read_b128 a[96:99], v16 offset:40960
    v_mfma_f32_16x16x32_bf16 v[136:139], a[52:55], a[108:111], v[136:139]
    ds_read_b128 a[100:103], v17 offset:40960
    v_mfma_f32_16x16x32_bf16 v[140:143], a[56:59], a[104:107], v[140:143]
    ds_read_b64_tr_b16 a[24:25], v19 offset:8192
    v_mfma_f32_16x16x32_bf16 v[140:143], a[60:63], a[108:111], v[140:143]
    buffer_load_dwordx4 v11, s[20:23], s44 offen offset:1024 lds
    v_mfma_f32_16x16x32_bf16 v[144:147], a[104:107], a[64:67], v[144:147]
    v_mfma_f32_16x16x32_bf16 v[144:147], a[108:111], a[68:71], v[144:147]
    ds_read_b64_tr_b16 a[26:27], v19 offset:8704
    v_mfma_f32_16x16x32_bf16 v[148:151], a[104:107], a[72:75], v[148:151]
    v_mfma_f32_16x16x32_bf16 v[148:151], a[108:111], a[76:79], v[148:151]
    ds_read_b64_tr_b16 a[232:233], v46 offset:0
    v_mfma_f32_16x16x32_bf16 v[152:155], a[104:107], a[80:83], v[152:155]
    buffer_load_dwordx4 v12, s[20:23], s44 offen offset:2048 lds
    v_mfma_f32_16x16x32_bf16 v[152:155], a[108:111], a[84:87], v[152:155]
    ds_read_b64_tr_b16 a[28:29], v19 offset:12288
    v_mfma_f32_16x16x32_bf16 v[156:159], a[104:107], a[88:91], v[156:159]
    v_mfma_f32_16x16x32_bf16 v[156:159], a[108:111], a[92:95], v[156:159]
    ds_read_b64_tr_b16 a[30:31], v19 offset:12800
    s_waitcnt lgkmcnt(5)
    v_mfma_f32_16x16x32_bf16 v[160:163], a[48:51], a[96:99], v[160:163]
    ds_read_b128 a[104:107], v16 offset:43008
    v_mfma_f32_16x16x32_bf16 v[160:163], a[52:55], a[100:103], v[160:163]
    ds_read_b128 a[108:111], v17 offset:43008
    v_mfma_f32_16x16x32_bf16 v[164:167], a[56:59], a[96:99], v[164:167]
    buffer_load_dwordx4 v13, s[20:23], s44 offen offset:3072 lds
    v_mfma_f32_16x16x32_bf16 v[164:167], a[60:63], a[100:103], v[164:167]
    ds_read_b64_tr_b16 a[32:33], v18 offset:16384
    v_mfma_f32_16x16x32_bf16 v[168:171], a[96:99], a[64:67], v[168:171]
    v_mfma_f32_16x16x32_bf16 v[168:171], a[100:103], a[68:71], v[168:171]
    ds_read_b64_tr_b16 a[34:35], v18 offset:16896
    v_mfma_f32_16x16x32_bf16 v[172:175], a[96:99], a[72:75], v[172:175]
    s_add_u32 m0, s49, 118784
    v_mfma_f32_16x16x32_bf16 v[172:175], a[100:103], a[76:79], v[172:175]
    buffer_load_dwordx4 v14, s[20:23], s44 offen lds
    v_mfma_f32_16x16x32_bf16 v[176:179], a[96:99], a[80:83], v[176:179]
    v_mfma_f32_16x16x32_bf16 v[176:179], a[100:103], a[84:87], v[176:179]
    ds_read_b64_tr_b16 a[36:37], v18 offset:20480
    v_mfma_f32_16x16x32_bf16 v[180:183], a[96:99], a[88:91], v[180:183]
    v_mfma_f32_16x16x32_bf16 v[180:183], a[100:103], a[92:95], v[180:183]
    s_waitcnt lgkmcnt(3)
    v_mfma_f32_16x16x32_bf16 v[184:187], a[48:51], a[104:107], v[184:187]
    ds_read_b128 a[96:99], v16 offset:45056
    ds_read_b64_tr_b16 a[38:39], v18 offset:20992
    v_mfma_f32_16x16x32_bf16 v[184:187], a[52:55], a[108:111], v[184:187]
    ds_read_b128 a[100:103], v17 offset:45056
    ds_read_b64_tr_b16 a[236:237], v47 offset:0
    v_mfma_f32_16x16x32_bf16 v[188:191], a[56:59], a[104:107], v[188:191]
    buffer_load_dwordx4 v15, s[20:23], s44 offen offset:1024 lds
    v_mfma_f32_16x16x32_bf16 v[188:191], a[60:63], a[108:111], v[188:191]
    s_add_u32 s44, s44, 393216
    ds_read_b64_tr_b16 a[40:41], v19 offset:16384
    v_mfma_f32_16x16x32_bf16 v[192:195], a[104:107], a[64:67], v[192:195]
    v_mfma_f32_16x16x32_bf16 v[192:195], a[108:111], a[68:71], v[192:195]
    v_mfma_f32_16x16x32_bf16 v[196:199], a[104:107], a[72:75], v[196:199]
    s_mov_b64 exec, 0xff
    buffer_load_dword v39, v38, s[92:95], s78 offen offset:1024
    s_mov_b64 exec, -1
    v_mfma_f32_16x16x32_bf16 v[196:199], a[108:111], a[76:79], v[196:199]
    ds_read_b64_tr_b16 a[42:43], v19 offset:16896
    v_mfma_f32_16x16x32_bf16 v[200:203], a[104:107], a[80:83], v[200:203]
    v_mfma_f32_16x16x32_bf16 v[200:203], a[108:111], a[84:87], v[200:203]
    ds_read_b64_tr_b16 a[44:45], v19 offset:20480
    v_mfma_f32_16x16x32_bf16 v[204:207], a[104:107], a[88:91], v[204:207]
    v_mfma_f32_16x16x32_bf16 v[204:207], a[108:111], a[92:95], v[204:207]
    s_add_u32 m0, s64, 4096
    s_waitcnt lgkmcnt(4)
    v_mfma_f32_16x16x32_bf16 v[208:211], a[48:51], a[96:99], v[208:211]
    ds_read_b128 a[104:107], v16 offset:47104
    ds_read_b64_tr_b16 a[46:47], v19 offset:20992
    v_mfma_f32_16x16x32_bf16 v[208:211], a[52:55], a[100:103], v[208:211]
    ds_read_b128 a[108:111], v17 offset:47104
    v_mfma_f32_16x16x32_bf16 v[212:215], a[56:59], a[96:99], v[212:215]
    buffer_load_dwordx4 v40, s[80:83], s52 offen lds
    v_mfma_f32_16x16x32_bf16 v[212:215], a[60:63], a[100:103], v[212:215]
    v_mfma_f32_16x16x32_bf16 v[216:219], a[96:99], a[64:67], v[216:219]
    v_mfma_f32_16x16x32_bf16 v[216:219], a[100:103], a[68:71], v[216:219]
    buffer_load_dwordx4 v41, s[80:83], s52 offen offset:1024 lds
    v_mfma_f32_16x16x32_bf16 v[220:223], a[96:99], a[72:75], v[220:223]
    v_mfma_f32_16x16x32_bf16 v[220:223], a[100:103], a[76:79], v[220:223]
    v_mfma_f32_16x16x32_bf16 v[224:227], a[96:99], a[80:83], v[224:227]
    v_mfma_f32_16x16x32_bf16 v[224:227], a[100:103], a[84:87], v[224:227]
    v_mfma_f32_16x16x32_bf16 v[228:231], a[96:99], a[88:91], v[228:231]
    v_mfma_f32_16x16x32_bf16 v[228:231], a[100:103], a[92:95], v[228:231]
K_W11:
    s_waitcnt vmcnt(9) lgkmcnt(0)
    s_barrier
    v_mfma_f32_16x16x32_bf16 v[232:235], a[48:51], a[104:107], v[232:235]
    ds_read_b128 a[96:99], v16 offset:0
    v_mfma_f32_16x16x32_bf16 v[232:235], a[52:55], a[108:111], v[232:235]
    ds_read_b128 a[100:103], v17 offset:0
    s_add_u32 m0, s45, 32768
    v_mfma_f32_16x16x32_bf16 v[236:239], a[56:59], a[104:107], v[236:239]
    buffer_load_dwordx4 v2, s[16:19], s43 offen lds
    v_mfma_f32_16x16x32_bf16 v[236:239], a[60:63], a[108:111], v[236:239]
    v_mfma_f32_16x16x32_bf16 v[240:243], a[104:107], a[64:67], v[240:243]
    v_mfma_f32_16x16x32_bf16 v[240:243], a[108:111], a[68:71], v[240:243]
    v_mfma_f32_16x16x32_bf16 v[244:247], a[104:107], a[72:75], v[244:247]
    v_mfma_f32_16x16x32_bf16 v[244:247], a[108:111], a[76:79], v[244:247]
    buffer_load_dwordx4 v3, s[16:19], s43 offen offset:1024 lds
    v_mfma_f32_16x16x32_bf16 v[248:251], a[104:107], a[80:83], v[248:251]
    v_mfma_f32_16x16x32_bf16 v[248:251], a[108:111], a[84:87], v[248:251]
    v_mfma_f32_16x16x32_bf16 v[252:255], a[104:107], a[88:91], v[252:255]
    v_mfma_f32_16x16x32_bf16 v[252:255], a[108:111], a[92:95], v[252:255]
    s_waitcnt lgkmcnt(0)
    v_mfma_f32_16x16x32_bf16 v[64:67], a[0:3], a[96:99], v[64:67]
    ds_read_b128 a[104:107], v16 offset:2048
    ds_read_b64_tr_b16 a[48:49], v20 offset:0
    v_mfma_f32_16x16x32_bf16 v[64:67], a[4:7], a[100:103], v[64:67]
    ds_read_b128 a[108:111], v17 offset:2048
    v_mfma_f32_16x16x32_bf16 v[68:71], a[8:11], a[96:99], v[68:71]
    buffer_load_dwordx4 v4, s[16:19], s43 offen offset:2048 lds
    v_mfma_f32_16x16x32_bf16 v[68:71], a[12:15], a[100:103], v[68:71]
    ds_read_b64_tr_b16 a[50:51], v20 offset:512
    v_mfma_f32_16x16x32_bf16 v[72:75], a[96:99], a[16:19], v[72:75]
    v_mfma_f32_16x16x32_bf16 v[72:75], a[100:103], a[20:23], v[72:75]
    v_mfma_f32_16x16x32_bf16 v[76:79], a[96:99], a[24:27], v[76:79]
    buffer_load_dwordx4 v5, s[16:19], s43 offen offset:3072 lds
    v_mfma_f32_16x16x32_bf16 v[76:79], a[100:103], a[28:31], v[76:79]
    s_add_u32 s43, s43, 128
    ds_read_b64_tr_b16 a[52:53], v20 offset:4096
    v_mfma_f32_16x16x32_bf16 v[80:83], a[96:99], a[32:35], v[80:83]
    ds_read_b64_tr_b16 a[226:227], v44 offset:2048
    v_mfma_f32_16x16x32_bf16 v[80:83], a[100:103], a[36:39], v[80:83]
    ds_read_b64_tr_b16 a[54:55], v20 offset:4608
    v_mfma_f32_16x16x32_bf16 v[84:87], a[96:99], a[40:43], v[84:87]
    s_add_u32 m0, s45, 40960
    v_mfma_f32_16x16x32_bf16 v[84:87], a[100:103], a[44:47], v[84:87]
    s_waitcnt lgkmcnt(4)
    v_mfma_f32_16x16x32_bf16 v[88:91], a[0:3], a[104:107], v[88:91]
    ds_read_b128 a[96:99], v16 offset:4096
    ds_read_b64_tr_b16 a[56:57], v21 offset:0
    v_mfma_f32_16x16x32_bf16 v[88:91], a[4:7], a[108:111], v[88:91]
    ds_read_b128 a[100:103], v17 offset:4096
    v_mfma_f32_16x16x32_bf16 v[92:95], a[8:11], a[104:107], v[92:95]
    buffer_load_dwordx4 v6, s[16:19], s72 offen lds
    v_mfma_f32_16x16x32_bf16 v[92:95], a[12:15], a[108:111], v[92:95]
    ds_read_b64_tr_b16 a[58:59], v21 offset:512
    v_mfma_f32_16x16x32_bf16 v[96:99], a[104:107], a[16:19], v[96:99]
    v_mfma_f32_16x16x32_bf16 v[96:99], a[108:111], a[20:23], v[96:99]
    buffer_load_dwordx4 v7, s[16:19], s72 offen offset:1024 lds
    v_mfma_f32_16x16x32_bf16 v[100:103], a[104:107], a[24:27], v[100:103]
    v_mfma_f32_16x16x32_bf16 v[100:103], a[108:111], a[28:31], v[100:103]
    ds_read_b64_tr_b16 a[60:61], v21 offset:4096
    v_mfma_f32_16x16x32_bf16 v[104:107], a[104:107], a[32:35], v[104:107]
    v_mfma_f32_16x16x32_bf16 v[104:107], a[108:111], a[36:39], v[104:107]
    v_mfma_f32_16x16x32_bf16 v[108:111], a[104:107], a[40:43], v[108:111]
    buffer_load_dwordx4 v8, s[16:19], s72 offen offset:2048 lds
    v_mfma_f32_16x16x32_bf16 v[108:111], a[108:111], a[44:47], v[108:111]
    ds_read_b64_tr_b16 a[62:63], v21 offset:4608
    s_waitcnt lgkmcnt(3)
    v_mfma_f32_16x16x32_bf16 v[112:115], a[0:3], a[96:99], v[112:115]
    ds_read_b128 a[104:107], v16 offset:6144
    ds_read_b64_tr_b16 a[230:231], v45 offset:2048
    v_mfma_f32_16x16x32_bf16 v[112:115], a[4:7], a[100:103], v[112:115]
    ds_read_b128 a[108:111], v17 offset:6144
    ds_read_b64_tr_b16 a[64:65], v20 offset:8192
    v_mfma_f32_16x16x32_bf16 v[116:119], a[8:11], a[96:99], v[116:119]
    v_mfma_f32_16x16x32_bf16 v[116:119], a[12:15], a[100:103], v[116:119]
    v_mfma_f32_16x16x32_bf16 v[120:123], a[96:99], a[16:19], v[120:123]
    buffer_load_dwordx4 v9, s[16:19], s72 offen offset:3072 lds
    v_mfma_f32_16x16x32_bf16 v[120:123], a[100:103], a[20:23], v[120:123]
    s_add_u32 s72, s72, 128
    ds_read_b64_tr_b16 a[66:67], v20 offset:8704
    v_mfma_f32_16x16x32_bf16 v[124:127], a[96:99], a[24:27], v[124:127]
    v_mfma_f32_16x16x32_bf16 v[124:127], a[100:103], a[28:31], v[124:127]
    ds_read_b64_tr_b16 a[68:69], v20 offset:12288
    v_mfma_f32_16x16x32_bf16 v[128:131], a[96:99], a[32:35], v[128:131]
    s_add_u32 m0, s49, 65536
    v_mfma_f32_16x16x32_bf16 v[128:131], a[100:103], a[36:39], v[128:131]
    buffer_load_dwordx4 v10, s[20:23], s44 offen lds
    v_mfma_f32_16x16x32_bf16 v[132:135], a[96:99], a[40:43], v[132:135]
    ds_read_b64_tr_b16 a[70:71], v20 offset:12800
    v_mfma_f32_16x16x32_bf16 v[132:135], a[100:103], a[44:47], v[132:135]
    s_waitcnt lgkmcnt(4)
    v_mfma_f32_16x16x32_bf16 v[136:139], a[0:3], a[104:107], v[136:139]
    ds_read_b128 a[96:99], v16 offset:8192
    v_mfma_f32_16x16x32_bf16 v[136:139], a[4:7], a[108:111], v[136:139]
    ds_read_b128 a[100:103], v17 offset:8192
    v_mfma_f32_16x16x32_bf16 v[140:143], a[8:11], a[104:107], v[140:143]
    ds_read_b64_tr_b16 a[72:73], v21 offset:8192
    v_mfma_f32_16x16x32_bf16 v[140:143], a[12:15], a[108:111], v[140:143]
    buffer_load_dwordx4 v11, s[20:23], s44 offen offset:1024 lds
    v_mfma_f32_16x16x32_bf16 v[144:147], a[104:107], a[16:19], v[144:147]
    v_mfma_f32_16x16x32_bf16 v[144:147], a[108:111], a[20:23], v[144:147]
    ds_read_b64_tr_b16 a[74:75], v21 offset:8704
    v_mfma_f32_16x16x32_bf16 v[148:151], a[104:107], a[24:27], v[148:151]
    v_mfma_f32_16x16x32_bf16 v[148:151], a[108:111], a[28:31], v[148:151]
    ds_read_b64_tr_b16 a[234:235], v46 offset:2048
    v_mfma_f32_16x16x32_bf16 v[152:155], a[104:107], a[32:35], v[152:155]
    buffer_load_dwordx4 v12, s[20:23], s44 offen offset:2048 lds
    v_mfma_f32_16x16x32_bf16 v[152:155], a[108:111], a[36:39], v[152:155]
    ds_read_b64_tr_b16 a[76:77], v21 offset:12288
    v_mfma_f32_16x16x32_bf16 v[156:159], a[104:107], a[40:43], v[156:159]
    v_mfma_f32_16x16x32_bf16 v[156:159], a[108:111], a[44:47], v[156:159]
    ds_read_b64_tr_b16 a[78:79], v21 offset:12800
    s_waitcnt lgkmcnt(5)
    v_mfma_f32_16x16x32_bf16 v[160:163], a[0:3], a[96:99], v[160:163]
    ds_read_b128 a[104:107], v16 offset:10240
    v_mfma_f32_16x16x32_bf16 v[160:163], a[4:7], a[100:103], v[160:163]
    ds_read_b128 a[108:111], v17 offset:10240
    v_mfma_f32_16x16x32_bf16 v[164:167], a[8:11], a[96:99], v[164:167]
    buffer_load_dwordx4 v13, s[20:23], s44 offen offset:3072 lds
    v_mfma_f32_16x16x32_bf16 v[164:167], a[12:15], a[100:103], v[164:167]
    ds_read_b64_tr_b16 a[80:81], v20 offset:16384
    v_mfma_f32_16x16x32_bf16 v[168:171], a[96:99], a[16:19], v[168:171]
    v_mfma_f32_16x16x32_bf16 v[168:171], a[100:103], a[20:23], v[168:171]
    ds_read_b64_tr_b16 a[82:83], v20 offset:16896
    v_mfma_f32_16x16x32_bf16 v[172:175], a[96:99], a[24:27], v[172:175]
    s_add_u32 m0, s49, 69632
    v_mfma_f32_16x16x32_bf16 v[172:175], a[100:103], a[28:31], v[172:175]
    buffer_load_dwordx4 v14, s[20:23], s44 offen lds
    v_mfma_f32_16x16x32_bf16 v[176:179], a[96:99], a[32:35], v[176:179]
    v_mfma_f32_16x16x32_bf16 v[176:179], a[100:103], a[36:39], v[176:179]
    ds_read_b64_tr_b16 a[84:85], v20 offset:20480
    v_mfma_f32_16x16x32_bf16 v[180:183], a[96:99], a[40:43], v[180:183]
    v_mfma_f32_16x16x32_bf16 v[180:183], a[100:103], a[44:47], v[180:183]
    s_waitcnt lgkmcnt(3)
    v_mfma_f32_16x16x32_bf16 v[184:187], a[0:3], a[104:107], v[184:187]
    ds_read_b128 a[96:99], v16 offset:12288
    ds_read_b64_tr_b16 a[86:87], v20 offset:20992
    v_mfma_f32_16x16x32_bf16 v[184:187], a[4:7], a[108:111], v[184:187]
    ds_read_b128 a[100:103], v17 offset:12288
    ds_read_b64_tr_b16 a[238:239], v47 offset:2048
    v_mfma_f32_16x16x32_bf16 v[188:191], a[8:11], a[104:107], v[188:191]
    buffer_load_dwordx4 v15, s[20:23], s44 offen offset:1024 lds
    v_mfma_f32_16x16x32_bf16 v[188:191], a[12:15], a[108:111], v[188:191]
    s_add_u32 s44, s44, 393216
    ds_read_b64_tr_b16 a[88:89], v21 offset:16384
    v_mfma_f32_16x16x32_bf16 v[192:195], a[104:107], a[16:19], v[192:195]
    v_mfma_f32_16x16x32_bf16 v[192:195], a[108:111], a[20:23], v[192:195]
    v_mfma_f32_16x16x32_bf16 v[196:199], a[104:107], a[24:27], v[196:199]
    s_mov_b64 exec, 0xff
    buffer_load_dword v39, v38, s[92:95], s78 offen offset:2048
    s_mov_b64 exec, -1
    v_mfma_f32_16x16x32_bf16 v[196:199], a[108:111], a[28:31], v[196:199]
    ds_read_b64_tr_b16 a[90:91], v21 offset:16896
    v_mfma_f32_16x16x32_bf16 v[200:203], a[104:107], a[32:35], v[200:203]
    v_mfma_f32_16x16x32_bf16 v[200:203], a[108:111], a[36:39], v[200:203]
    ds_read_b64_tr_b16 a[92:93], v21 offset:20480
    v_mfma_f32_16x16x32_bf16 v[204:207], a[104:107], a[40:43], v[204:207]
    v_mfma_f32_16x16x32_bf16 v[204:207], a[108:111], a[44:47], v[204:207]
    s_add_u32 m0, s64, -2048
    s_waitcnt lgkmcnt(4)
    v_mfma_f32_16x16x32_bf16 v[208:211], a[0:3], a[96:99], v[208:211]
    ds_read_b128 a[104:107], v16 offset:14336
    ds_read_b64_tr_b16 a[94:95], v21 offset:20992
    v_mfma_f32_16x16x32_bf16 v[208:211], a[4:7], a[100:103], v[208:211]
    ds_read_b128 a[108:111], v17 offset:14336
    v_mfma_f32_16x16x32_bf16 v[212:215], a[8:11], a[96:99], v[212:215]
    buffer_load_dwordx4 v42, s[80:83], s52 offen offset:2048 lds
    v_mfma_f32_16x16x32_bf16 v[212:215], a[12:15], a[100:103], v[212:215]
    v_mfma_f32_16x16x32_bf16 v[216:219], a[96:99], a[16:19], v[216:219]
    v_mfma_f32_16x16x32_bf16 v[216:219], a[100:103], a[20:23], v[216:219]
    buffer_load_dwordx4 v43, s[80:83], s52 offen offset:3072 lds
    v_mfma_f32_16x16x32_bf16 v[220:223], a[96:99], a[24:27], v[220:223]
    s_add_u32 s52, s52, 65536
    v_mfma_f32_16x16x32_bf16 v[220:223], a[100:103], a[28:31], v[220:223]
    v_mfma_f32_16x16x32_bf16 v[224:227], a[96:99], a[32:35], v[224:227]
    v_mfma_f32_16x16x32_bf16 v[224:227], a[100:103], a[36:39], v[224:227]
    v_mfma_f32_16x16x32_bf16 v[228:231], a[96:99], a[40:43], v[228:231]
    v_mfma_f32_16x16x32_bf16 v[228:231], a[100:103], a[44:47], v[228:231]
K_W12:
    s_waitcnt vmcnt(9) lgkmcnt(0)
    s_barrier
    v_mfma_f32_16x16x32_bf16 v[232:235], a[0:3], a[104:107], v[232:235]
    ds_read_b128 a[96:99], v16 offset:32768
    v_mfma_f32_16x16x32_bf16 v[232:235], a[4:7], a[108:111], v[232:235]
    ds_read_b128 a[100:103], v17 offset:32768
    s_add_u32 m0, s45, 0
    v_mfma_f32_16x16x32_bf16 v[236:239], a[8:11], a[104:107], v[236:239]
    buffer_load_dwordx4 v2, s[16:19], s43 offen lds
    v_mfma_f32_16x16x32_bf16 v[236:239], a[12:15], a[108:111], v[236:239]
    v_mfma_f32_16x16x32_bf16 v[240:243], a[104:107], a[16:19], v[240:243]
    v_mfma_f32_16x16x32_bf16 v[240:243], a[108:111], a[20:23], v[240:243]
    v_mfma_f32_16x16x32_bf16 v[244:247], a[104:107], a[24:27], v[244:247]
    v_mfma_f32_16x16x32_bf16 v[244:247], a[108:111], a[28:31], v[244:247]
    v_mfma_f32_16x16x32_bf16 v[248:251], a[104:107], a[32:35], v[248:251]
    buffer_load_dwordx4 v3, s[16:19], s43 offen offset:1024 lds
    v_mfma_f32_16x16x32_bf16 v[248:251], a[108:111], a[36:39], v[248:251]
    v_mfma_f32_16x16x32_bf16 v[252:255], a[104:107], a[40:43], v[252:255]
    v_mfma_f32_16x16x32_bf16 v[252:255], a[108:111], a[44:47], v[252:255]
    s_waitcnt lgkmcnt(0)
    v_mfma_f32_16x16x32_bf16 v[64:67], a[48:51], a[96:99], v[64:67]
    ds_read_b128 a[104:107], v16 offset:34816
    ds_read_b64_tr_b16 a[0:1], v22 offset:0
    v_mfma_f32_16x16x32_bf16 v[64:67], a[52:55], a[100:103], v[64:67]
    ds_read_b128 a[108:111], v17 offset:34816
    v_mfma_f32_16x16x32_bf16 v[68:71], a[56:59], a[96:99], v[68:71]
    buffer_load_dwordx4 v4, s[16:19], s43 offen offset:2048 lds
    v_mfma_f32_16x16x32_bf16 v[68:71], a[60:63], a[100:103], v[68:71]
    ds_read_b64_tr_b16 a[2:3], v22 offset:512
    v_mfma_f32_16x16x32_bf16 v[72:75], a[96:99], a[64:67], v[72:75]
    v_mfma_f32_16x16x32_bf16 v[72:75], a[100:103], a[68:71], v[72:75]
    v_mfma_f32_16x16x32_bf16 v[76:79], a[96:99], a[72:75], v[76:79]
    ds_read_b64_tr_b16 a[4:5], v22 offset:4096
    ds_read_b64_tr_b16 a[240:241], v44 offset:4096
    v_mfma_f32_16x16x32_bf16 v[76:79], a[100:103], a[76:79], v[76:79]
    v_mfma_f32_16x16x32_bf16 v[80:83], a[96:99], a[80:83], v[80:83]
    buffer_load_dwordx4 v5, s[16:19], s43 offen offset:3072 lds
    v_mfma_f32_16x16x32_bf16 v[80:83], a[100:103], a[84:87], v[80:83]
    s_add_u32 s43, s43, 128
    ds_read_b64_tr_b16 a[6:7], v22 offset:4608
    v_mfma_f32_16x16x32_bf16 v[84:87], a[96:99], a[88:91], v[84:87]
    v_mfma_f32_16x16x32_bf16 v[84:87], a[100:103], a[92:95], v[84:87]
    s_waitcnt lgkmcnt(4)
    v_mfma_f32_16x16x32_bf16 v[88:91], a[48:51], a[104:107], v[88:91]
    ds_read_b128 a[96:99], v16 offset:36864
    ds_read_b64_tr_b16 a[8:9], v23 offset:0
    v_mfma_f32_16x16x32_bf16 v[88:91], a[52:55], a[108:111], v[88:91]
    ds_read_b128 a[100:103], v17 offset:36864
    s_add_u32 m0, s45, 8192
    v_mfma_f32_16x16x32_bf16 v[92:95], a[56:59], a[104:107], v[92:95]
    buffer_load_dwordx4 v6, s[16:19], s72 offen lds
    v_mfma_f32_16x16x32_bf16 v[92:95], a[60:63], a[108:111], v[92:95]
    ds_read_b64_tr_b16 a[10:11], v23 offset:512
    v_mfma_f32_16x16x32_bf16 v[96:99], a[104:107], a[64:67], v[96:99]
    v_mfma_f32_16x16x32_bf16 v[96:99], a[108:111], a[68:71], v[96:99]
    v_mfma_f32_16x16x32_bf16 v[100:103], a[104:107], a[72:75], v[100:103]
    v_mfma_f32_16x16x32_bf16 v[100:103], a[108:111], a[76:79], v[100:103]
    ds_read_b64_tr_b16 a[12:13], v23 offset:4096
    v_mfma_f32_16x16x32_bf16 v[104:107], a[104:107], a[80:83], v[104:107]
    buffer_load_dwordx4 v7, s[16:19], s72 offen offset:1024 lds
    v_mfma_f32_16x16x32_bf16 v[104:107], a[108:111], a[84:87], v[104:107]
    v_mfma_f32_16x16x32_bf16 v[108:111], a[104:107], a[88:91], v[108:111]
    ds_read_b64_tr_b16 a[14:15], v23 offset:4608
    v_mfma_f32_16x16x32_bf16 v[108:111], a[108:111], a[92:95], v[108:111]
    s_waitcnt lgkmcnt(3)
    v_mfma_f32_16x16x32_bf16 v[112:115], a[48:51], a[96:99], v[112:115]
    ds_read_b128 a[104:107], v16 offset:38912
    ds_read_b64_tr_b16 a[244:245], v45 offset:4096
    v_mfma_f32_16x16x32_bf16 v[112:115], a[52:55], a[100:103], v[112:115]
    ds_read_b128 a[108:111], v17 offset:38912
    ds_read_b64_tr_b16 a[16:17], v22 offset:8192
    v_mfma_f32_16x16x32_bf16 v[116:119], a[56:59], a[96:99], v[116:119]
    buffer_load_dwordx4 v8, s[16:19], s72 offen offset:2048 lds
    v_mfma_f32_16x16x32_bf16 v[116:119], a[60:63], a[100:103], v[116:119]
    v_mfma_f32_16x16x32_bf16 v[120:123], a[96:99], a[64:67], v[120:123]
    ds_read_b64_tr_b16 a[18:19], v22 offset:8704
    v_mfma_f32_16x16x32_bf16 v[120:123], a[100:103], a[68:71], v[120:123]
    v_mfma_f32_16x16x32_bf16 v[124:127], a[96:99], a[72:75], v[124:127]
    v_mfma_f32_16x16x32_bf16 v[124:127], a[100:103], a[76:79], v[124:127]
    ds_read_b64_tr_b16 a[20:21], v22 offset:12288
    v_mfma_f32_16x16x32_bf16 v[128:131], a[96:99], a[80:83], v[128:131]
    buffer_load_dwordx4 v9, s[16:19], s72 offen offset:3072 lds
    v_mfma_f32_16x16x32_bf16 v[128:131], a[100:103], a[84:87], v[128:131]
    s_add_u32 s72, s72, 128
    s_add_u32 s59, s79, K_TAIL-gated_mix__linear_attn_block__linear_attn_block__prompt_kernel
    v_mfma_f32_16x16x32_bf16 v[132:135], a[96:99], a[88:91], v[132:135]
    v_lshlrev_b32 v54, 14, v1
    v_add_u32 v54, s59, v54
    v_mfma_f32_16x16x32_bf16 v[132:135], a[100:103], a[92:95], v[132:135]
    v_min_u32 v54, K_LAST-gated_mix__linear_attn_block__linear_attn_block__prompt_kernel, v54
    s_waitcnt lgkmcnt(3)
    v_mfma_f32_16x16x32_bf16 v[136:139], a[48:51], a[104:107], v[136:139]
    ds_read_b128 a[96:99], v16 offset:40960
    v_mov_b32 v55, s89
    v_mfma_f32_16x16x32_bf16 v[136:139], a[52:55], a[108:111], v[136:139]
    ds_read_b128 a[100:103], v17 offset:40960
    ds_read_b64_tr_b16 a[22:23], v22 offset:12800
    v_mfma_f32_16x16x32_bf16 v[140:143], a[56:59], a[104:107], v[140:143]
    v_add_co_u32 v54, vcc, s88, v54
    s_nop 1
    v_addc_co_u32 v55, vcc, 0, v55, vcc
    s_mov_b64 exec, 3
    global_load_dword v39, v[54:55], off
    s_mov_b64 exec, -1
    v_mfma_f32_16x16x32_bf16 v[140:143], a[60:63], a[108:111], v[140:143]
    ds_read_b64_tr_b16 a[24:25], v23 offset:8192
    v_mfma_f32_16x16x32_bf16 v[144:147], a[104:107], a[64:67], v[144:147]
    v_mfma_f32_16x16x32_bf16 v[144:147], a[108:111], a[68:71], v[144:147]
    ds_read_b64_tr_b16 a[26:27], v23 offset:8704
    v_mfma_f32_16x16x32_bf16 v[148:151], a[104:107], a[72:75], v[148:151]
    v_mfma_f32_16x16x32_bf16 v[148:151], a[108:111], a[76:79], v[148:151]
    ds_read_b64_tr_b16 a[248:249], v46 offset:4096
    v_mfma_f32_16x16x32_bf16 v[152:155], a[104:107], a[80:83], v[152:155]
    s_mov_b64 exec, 0xff
    buffer_load_dword v39, v38, s[92:95], s78 offen offset:3072
    s_mov_b64 exec, -1
    v_mfma_f32_16x16x32_bf16 v[152:155], a[108:111], a[84:87], v[152:155]
    ds_read_b64_tr_b16 a[28:29], v23 offset:12288
    v_mfma_f32_16x16x32_bf16 v[156:159], a[104:107], a[88:91], v[156:159]
    v_mfma_f32_16x16x32_bf16 v[156:159], a[108:111], a[92:95], v[156:159]
    ds_read_b64_tr_b16 a[30:31], v23 offset:12800
    s_waitcnt lgkmcnt(6)
    v_mfma_f32_16x16x32_bf16 v[160:163], a[48:51], a[96:99], v[160:163]
    ds_read_b128 a[104:107], v16 offset:43008
    v_mfma_f32_16x16x32_bf16 v[160:163], a[52:55], a[100:103], v[160:163]
    ds_read_b128 a[108:111], v17 offset:43008
    v_mfma_f32_16x16x32_bf16 v[164:167], a[56:59], a[96:99], v[164:167]
    ds_read_b64_tr_b16 a[32:33], v22 offset:16384
    v_mfma_f32_16x16x32_bf16 v[164:167], a[60:63], a[100:103], v[164:167]
    v_mfma_f32_16x16x32_bf16 v[168:171], a[96:99], a[64:67], v[168:171]
    v_mfma_f32_16x16x32_bf16 v[168:171], a[100:103], a[68:71], v[168:171]
    ds_read_b64_tr_b16 a[34:35], v22 offset:16896
    v_mfma_f32_16x16x32_bf16 v[172:175], a[96:99], a[72:75], v[172:175]
    v_mfma_f32_16x16x32_bf16 v[172:175], a[100:103], a[76:79], v[172:175]
    v_mfma_f32_16x16x32_bf16 v[176:179], a[96:99], a[80:83], v[176:179]
    v_mfma_f32_16x16x32_bf16 v[176:179], a[100:103], a[84:87], v[176:179]
    ds_read_b64_tr_b16 a[36:37], v22 offset:20480
    v_mfma_f32_16x16x32_bf16 v[180:183], a[96:99], a[88:91], v[180:183]
    v_mfma_f32_16x16x32_bf16 v[180:183], a[100:103], a[92:95], v[180:183]
    s_waitcnt lgkmcnt(3)
    v_mfma_f32_16x16x32_bf16 v[184:187], a[48:51], a[104:107], v[184:187]
    ds_read_b128 a[96:99], v16 offset:45056
    ds_read_b64_tr_b16 a[38:39], v22 offset:20992
    v_mfma_f32_16x16x32_bf16 v[184:187], a[52:55], a[108:111], v[184:187]
    ds_read_b128 a[100:103], v17 offset:45056
    ds_read_b64_tr_b16 a[252:253], v47 offset:4096
    v_mfma_f32_16x16x32_bf16 v[188:191], a[56:59], a[104:107], v[188:191]
    v_mfma_f32_16x16x32_bf16 v[188:191], a[60:63], a[108:111], v[188:191]
    ds_read_b64_tr_b16 a[40:41], v23 offset:16384
    v_mfma_f32_16x16x32_bf16 v[192:195], a[104:107], a[64:67], v[192:195]
    v_mfma_f32_16x16x32_bf16 v[192:195], a[108:111], a[68:71], v[192:195]
    v_mfma_f32_16x16x32_bf16 v[196:199], a[104:107], a[72:75], v[196:199]
    ds_read_b64_tr_b16 a[42:43], v23 offset:16896
    v_mfma_f32_16x16x32_bf16 v[196:199], a[108:111], a[76:79], v[196:199]
    v_mfma_f32_16x16x32_bf16 v[200:203], a[104:107], a[80:83], v[200:203]
    v_mfma_f32_16x16x32_bf16 v[200:203], a[108:111], a[84:87], v[200:203]
    ds_read_b64_tr_b16 a[44:45], v23 offset:20480
    v_mfma_f32_16x16x32_bf16 v[204:207], a[104:107], a[88:91], v[204:207]
    v_mfma_f32_16x16x32_bf16 v[204:207], a[108:111], a[92:95], v[204:207]
    s_waitcnt lgkmcnt(4)
    v_mfma_f32_16x16x32_bf16 v[208:211], a[48:51], a[96:99], v[208:211]
    ds_read_b128 a[104:107], v16 offset:47104
    ds_read_b64_tr_b16 a[46:47], v23 offset:20992
    v_mfma_f32_16x16x32_bf16 v[208:211], a[52:55], a[100:103], v[208:211]
    ds_read_b128 a[108:111], v17 offset:47104
    v_mfma_f32_16x16x32_bf16 v[212:215], a[56:59], a[96:99], v[212:215]
    v_mfma_f32_16x16x32_bf16 v[212:215], a[60:63], a[100:103], v[212:215]
    v_mfma_f32_16x16x32_bf16 v[216:219], a[96:99], a[64:67], v[216:219]
    v_mfma_f32_16x16x32_bf16 v[216:219], a[100:103], a[68:71], v[216:219]
    v_mfma_f32_16x16x32_bf16 v[220:223], a[96:99], a[72:75], v[220:223]
    v_mfma_f32_16x16x32_bf16 v[220:223], a[100:103], a[76:79], v[220:223]
    v_mfma_f32_16x16x32_bf16 v[224:227], a[96:99], a[80:83], v[224:227]
    v_mfma_f32_16x16x32_bf16 v[224:227], a[100:103], a[84:87], v[224:227]
    v_mfma_f32_16x16x32_bf16 v[228:231], a[96:99], a[88:91], v[228:231]
    v_mfma_f32_16x16x32_bf16 v[228:231], a[100:103], a[92:95], v[228:231]
K_W13:
    s_waitcnt vmcnt(2) lgkmcnt(0)
    s_barrier
    v_mfma_f32_16x16x32_bf16 v[232:235], a[48:51], a[104:107], v[232:235]
    ds_read_b128 a[96:99], v16 offset:0
    v_mfma_f32_16x16x32_bf16 v[232:235], a[52:55], a[108:111], v[232:235]
    ds_read_b128 a[100:103], v17 offset:0
    s_add_u32 m0, s45, 32768
    v_mfma_f32_16x16x32_bf16 v[236:239], a[56:59], a[104:107], v[236:239]
    buffer_load_dwordx4 v2, s[16:19], s43 offen lds
    v_mfma_f32_16x16x32_bf16 v[236:239], a[60:63], a[108:111], v[236:239]
    v_mfma_f32_16x16x32_bf16 v[240:243], a[104:107], a[64:67], v[240:243]
    ds_read_b64_tr_b16 a[242:243], v44 offset:0
    v_mfma_f32_16x16x32_bf16 v[240:243], a[108:111], a[68:71], v[240:243]
    v_mfma_f32_16x16x32_bf16 v[244:247], a[104:107], a[72:75], v[244:247]
    v_mfma_f32_16x16x32_bf16 v[244:247], a[108:111], a[76:79], v[244:247]
    v_mfma_f32_16x16x32_bf16 v[248:251], a[104:107], a[80:83], v[248:251]
    buffer_load_dwordx4 v3, s[16:19], s43 offen offset:1024 lds
    v_mfma_f32_16x16x32_bf16 v[248:251], a[108:111], a[84:87], v[248:251]
    ds_read_b64_tr_b16 a[246:247], v45 offset:0
    v_mfma_f32_16x16x32_bf16 v[252:255], a[104:107], a[88:91], v[252:255]
    v_mfma_f32_16x16x32_bf16 v[252:255], a[108:111], a[92:95], v[252:255]
    s_waitcnt lgkmcnt(2)
    v_mfma_f32_16x16x32_bf16 v[72:75], a[96:99], a[16:19], v[72:75]
    ds_read_b128 a[104:107], v16 offset:2048
    ds_read_b64_tr_b16 a[48:49], v18 offset:0
    v_mfma_f32_16x16x32_bf16 v[72:75], a[100:103], a[20:23], v[72:75]
    ds_read_b128 a[108:111], v17 offset:2048
    ds_read_b64_tr_b16 a[250:251], v46 offset:0
    v_mfma_f32_16x16x32_bf16 v[76:79], a[96:99], a[24:27], v[76:79]
    buffer_load_dwordx4 v4, s[16:19], s43 offen offset:2048 lds
    v_mfma_f32_16x16x32_bf16 v[76:79], a[100:103], a[28:31], v[76:79]
    ds_read_b64_tr_b16 a[50:51], v18 offset:512
    v_mfma_f32_16x16x32_bf16 v[80:83], a[96:99], a[32:35], v[80:83]
    ds_read_b64_tr_b16 a[52:53], v18 offset:4096
    v_mfma_f32_16x16x32_bf16 v[80:83], a[100:103], a[36:39], v[80:83]
    v_mfma_f32_16x16x32_bf16 v[84:87], a[96:99], a[40:43], v[84:87]
    ds_read_b64_tr_b16 a[54:55], v18 offset:4608
    ds_read_b64_tr_b16 a[254:255], v47 offset:0
    v_mfma_f32_16x16x32_bf16 v[84:87], a[100:103], a[44:47], v[84:87]
    s_waitcnt lgkmcnt(5)
    v_mfma_f32_16x16x32_bf16 v[96:99], a[104:107], a[16:19], v[96:99]
    ds_read_b128 a[96:99], v16 offset:4096
    ds_read_b64_tr_b16 a[56:57], v19 offset:0
    v_mfma_f32_16x16x32_bf16 v[96:99], a[108:111], a[20:23], v[96:99]
    ds_read_b128 a[100:103], v17 offset:4096
    v_mfma_f32_16x16x32_bf16 v[100:103], a[104:107], a[24:27], v[100:103]
    buffer_load_dwordx4 v5, s[16:19], s43 offen offset:3072 lds
    v_mfma_f32_16x16x32_bf16 v[100:103], a[108:111], a[28:31], v[100:103]
    s_add_u32 s43, s43, 128
    ds_read_b64_tr_b16 a[58:59], v19 offset:512
    v_mfma_f32_16x16x32_bf16 v[104:107], a[104:107], a[32:35], v[104:107]
    ds_read_b64_tr_b16 a[60:61], v19 offset:4096
    v_mov_b32 v12, v40
    v_mfma_f32_16x16x32_bf16 v[104:107], a[108:111], a[36:39], v[104:107]
    s_add_u32 m0, s45, 40960
    v_mfma_f32_16x16x32_bf16 v[108:111], a[104:107], a[40:43], v[108:111]
    buffer_load_dwordx4 v6, s[16:19], s72 offen lds
    v_mfma_f32_16x16x32_bf16 v[108:111], a[108:111], a[44:47], v[108:111]
    ds_read_b64_tr_b16 a[62:63], v19 offset:4608
    s_waitcnt lgkmcnt(3)
    v_mfma_f32_16x16x32_bf16 v[120:123], a[96:99], a[16:19], v[120:123]
    ds_read_b128 a[104:107], v16 offset:6144
    ds_read_b64_tr_b16 a[64:65], v18 offset:8192
    v_mfma_f32_16x16x32_bf16 v[120:123], a[100:103], a[20:23], v[120:123]
    ds_read_b128 a[108:111], v17 offset:6144
    v_mov_b32 v13, v41
    v_mfma_f32_16x16x32_bf16 v[124:127], a[96:99], a[24:27], v[124:127]
    ds_read_b64_tr_b16 a[66:67], v18 offset:8704
    v_mfma_f32_16x16x32_bf16 v[124:127], a[100:103], a[28:31], v[124:127]
    v_mfma_f32_16x16x32_bf16 v[128:131], a[96:99], a[32:35], v[128:131]
    buffer_load_dwordx4 v7, s[16:19], s72 offen offset:1024 lds
    v_mfma_f32_16x16x32_bf16 v[128:131], a[100:103], a[36:39], v[128:131]
    ds_read_b64_tr_b16 a[68:69], v18 offset:12288
    v_mov_b32 v14, v42
    v_mfma_f32_16x16x32_bf16 v[132:135], a[96:99], a[40:43], v[132:135]
    ds_read_b64_tr_b16 a[70:71], v18 offset:12800
    v_mfma_f32_16x16x32_bf16 v[132:135], a[100:103], a[44:47], v[132:135]
    s_waitcnt lgkmcnt(3)
    v_mfma_f32_16x16x32_bf16 v[144:147], a[104:107], a[16:19], v[144:147]
    ds_read_b128 a[96:99], v16 offset:8192
    ds_read_b64_tr_b16 a[72:73], v19 offset:8192
    v_mfma_f32_16x16x32_bf16 v[144:147], a[108:111], a[20:23], v[144:147]
    ds_read_b128 a[100:103], v17 offset:8192
    v_mov_b32 v15, v43
    v_mfma_f32_16x16x32_bf16 v[148:151], a[104:107], a[24:27], v[148:151]
    buffer_load_dwordx4 v8, s[16:19], s72 offen offset:2048 lds
    v_mfma_f32_16x16x32_bf16 v[148:151], a[108:111], a[28:31], v[148:151]
    ds_read_b64_tr_b16 a[74:75], v19 offset:8704
    v_mfma_f32_16x16x32_bf16 v[152:155], a[104:107], a[32:35], v[152:155]
    ds_read_b64_tr_b16 a[76:77], v19 offset:12288
    v_mfma_f32_16x16x32_bf16 v[152:155], a[108:111], a[36:39], v[152:155]
    s_add_u32 s56, s48, 0x10000
    v_mfma_f32_16x16x32_bf16 v[156:159], a[104:107], a[40:43], v[156:159]
    ds_read_b64_tr_b16 a[78:79], v19 offset:12800
    v_mfma_f32_16x16x32_bf16 v[156:159], a[108:111], a[44:47], v[156:159]
    s_waitcnt lgkmcnt(3)
    v_mfma_f32_16x16x32_bf16 v[168:171], a[96:99], a[16:19], v[168:171]
    ds_read_b128 a[104:107], v16 offset:10240
    ds_read_b64_tr_b16 a[80:81], v18 offset:16384
    v_mfma_f32_16x16x32_bf16 v[168:171], a[100:103], a[20:23], v[168:171]
    ds_read_b128 a[108:111], v17 offset:10240
    v_add_u32 v32, s56, v50
    v_mfma_f32_16x16x32_bf16 v[172:175], a[96:99], a[24:27], v[172:175]
    buffer_load_dwordx4 v9, s[16:19], s72 offen offset:3072 lds
    v_mfma_f32_16x16x32_bf16 v[172:175], a[100:103], a[28:31], v[172:175]
    s_add_u32 s72, s72, 128
    ds_read_b64_tr_b16 a[82:83], v18 offset:16896
    v_mfma_f32_16x16x32_bf16 v[176:179], a[96:99], a[32:35], v[176:179]
    ds_read_b64_tr_b16 a[84:85], v18 offset:20480
    v_mfma_f32_16x16x32_bf16 v[176:179], a[100:103], a[36:39], v[176:179]
    v_mfma_f32_16x16x32_bf16 v[180:183], a[96:99], a[40:43], v[180:183]
    buffer_load_dword v28, v53, s[28:31], 0 offen sc1
    v_mfma_f32_16x16x32_bf16 v[180:183], a[100:103], a[44:47], v[180:183]
    ds_read_b64_tr_b16 a[86:87], v18 offset:20992
    s_waitcnt lgkmcnt(3)
    v_mfma_f32_16x16x32_bf16 v[192:195], a[104:107], a[16:19], v[192:195]
    ds_read_b128 a[96:99], v16 offset:12288
    ds_read_b64_tr_b16 a[88:89], v19 offset:16384
    v_mfma_f32_16x16x32_bf16 v[192:195], a[108:111], a[20:23], v[192:195]
    ds_read_b128 a[100:103], v17 offset:12288
    v_xor_b32 v33, 32, v32
    v_mfma_f32_16x16x32_bf16 v[196:199], a[104:107], a[24:27], v[196:199]
    ds_read_b64_tr_b16 a[90:91], v19 offset:16896
    v_xor_b32 v34, 64, v32
    v_mfma_f32_16x16x32_bf16 v[196:199], a[108:111], a[28:31], v[196:199]
    v_mfma_f32_16x16x32_bf16 v[200:203], a[104:107], a[32:35], v[200:203]
    ds_read_b64_tr_b16 a[92:93], v19 offset:20480
    v_mfma_f32_16x16x32_bf16 v[200:203], a[108:111], a[36:39], v[200:203]
    v_mfma_f32_16x16x32_bf16 v[204:207], a[104:107], a[40:43], v[204:207]
    ds_read_b64_tr_b16 a[94:95], v19 offset:20992
    v_mfma_f32_16x16x32_bf16 v[204:207], a[108:111], a[44:47], v[204:207]
    v_xor_b32 v35, 96, v32
    s_waitcnt lgkmcnt(3)
    v_mfma_f32_16x16x32_bf16 v[216:219], a[96:99], a[16:19], v[216:219]
    ds_read_b128 a[104:107], v16 offset:14336
    v_mfma_f32_16x16x32_bf16 v[216:219], a[100:103], a[20:23], v[216:219]
    ds_read_b128 a[108:111], v17 offset:14336
    v_mfma_f32_16x16x32_bf16 v[220:223], a[96:99], a[24:27], v[220:223]
    v_mfma_f32_16x16x32_bf16 v[220:223], a[100:103], a[28:31], v[220:223]
    v_mfma_f32_16x16x32_bf16 v[224:227], a[96:99], a[32:35], v[224:227]
    v_mfma_f32_16x16x32_bf16 v[224:227], a[100:103], a[36:39], v[224:227]
    v_mfma_f32_16x16x32_bf16 v[228:231], a[96:99], a[40:43], v[228:231]
    v_mfma_f32_16x16x32_bf16 v[228:231], a[100:103], a[44:47], v[228:231]
K_W14:
    s_waitcnt vmcnt(1) lgkmcnt(0)
    s_barrier
    v_mfma_f32_16x16x32_bf16 v[240:243], a[104:107], a[16:19], v[240:243]
    ds_read_b128 a[112:115], v16 offset:32768
    s_mov_b32 s66, 0x3fb8aa3b
    v_mfma_f32_16x16x32_bf16 v[240:243], a[108:111], a[20:23], v[240:243]
    ds_read_b128 a[116:119], v17 offset:32768
    s_add_u32 m0, s48, 65536
    v_mfma_f32_16x16x32_bf16 v[244:247], a[104:107], a[24:27], v[244:247]
    buffer_load_dwordx4 v12, s[80:83], s52 offen lds
    v_mfma_f32_16x16x32_bf16 v[244:247], a[108:111], a[28:31], v[244:247]
    s_mov_b32 s67, 0x3fb8aa3b
    v_mfma_f32_16x16x32_bf16 v[248:251], a[104:107], a[32:35], v[248:251]
    v_mfma_f32_16x16x32_bf16 v[248:251], a[108:111], a[36:39], v[248:251]
    buffer_load_dwordx4 v13, s[80:83], s52 offen offset:1024 lds
    v_mfma_f32_16x16x32_bf16 v[252:255], a[104:107], a[40:43], v[252:255]
    v_mfma_f32_16x16x32_bf16 v[252:255], a[108:111], a[44:47], v[252:255]
    v_mov_b32 v20, 0xb5c1a2a0
    s_waitcnt lgkmcnt(0)
    v_mfma_f32_16x16x32_bf16 v[72:75], a[112:115], a[64:67], v[72:75]
    ds_read_b128 a[120:123], v16 offset:34816
    v_mfma_f32_16x16x32_bf16 v[72:75], a[116:119], a[68:71], v[72:75]
    ds_read_b128 a[124:127], v17 offset:34816
    v_mfma_f32_16x16x32_bf16 v[76:79], a[112:115], a[72:75], v[76:79]
    buffer_load_dwordx4 v14, s[80:83], s52 offen offset:2048 lds
    v_mfma_f32_16x16x32_bf16 v[76:79], a[116:119], a[76:79], v[76:79]
    v_mov_b32 v21, v20
    s_waitcnt lgkmcnt(0)
    v_mfma_f32_16x16x32_bf16 v[96:99], a[120:123], a[64:67], v[96:99]
    ds_read_b128 a[128:131], v16 offset:36864
    v_mfma_f32_16x16x32_bf16 v[96:99], a[124:127], a[68:71], v[96:99]
    ds_read_b128 a[132:135], v17 offset:36864
    v_mfma_f32_16x16x32_bf16 v[100:103], a[120:123], a[72:75], v[100:103]
    buffer_load_dwordx4 v15, s[80:83], s52 offen offset:3072 lds
    v_mfma_f32_16x16x32_bf16 v[100:103], a[124:127], a[76:79], v[100:103]
    s_add_u32 s52, s52, 65536
    s_waitcnt lgkmcnt(0)
    v_mfma_f32_16x16x32_bf16 v[120:123], a[128:131], a[64:67], v[120:123]
    ds_read_b128 a[136:139], v16 offset:38912
    s_add_u32 m0, s48, 69632
    v_mfma_f32_16x16x32_bf16 v[120:123], a[132:135], a[68:71], v[120:123]
    ds_read_b128 a[140:143], v17 offset:38912
    v_mov_b32 v22, 0x3f803f80
    v_mfma_f32_16x16x32_bf16 v[124:127], a[128:131], a[72:75], v[124:127]
    buffer_load_dwordx4 v12, s[80:83], s52 offen lds
    v_mfma_f32_16x16x32_bf16 v[124:127], a[132:135], a[76:79], v[124:127]
    v_mov_b32 v23, 0x3f803f80
    s_waitcnt lgkmcnt(0)
    v_mfma_f32_16x16x32_bf16 v[144:147], a[136:139], a[64:67], v[144:147]
    ds_read_b128 a[144:147], v16 offset:40960
    v_mfma_f32_16x16x32_bf16 v[144:147], a[140:143], a[68:71], v[144:147]
    ds_read_b128 a[148:151], v17 offset:40960
    v_mov_b32 v24, 0x3f803f80
    v_mfma_f32_16x16x32_bf16 v[148:151], a[136:139], a[72:75], v[148:151]
    buffer_load_dwordx4 v13, s[80:83], s52 offen offset:1024 lds
    v_mfma_f32_16x16x32_bf16 v[148:151], a[140:143], a[76:79], v[148:151]
    s_waitcnt lgkmcnt(0)
    v_mfma_f32_16x16x32_bf16 v[168:171], a[144:147], a[64:67], v[168:171]
    ds_read_b128 a[152:155], v16 offset:43008
    v_mfma_f32_16x16x32_bf16 v[168:171], a[148:151], a[68:71], v[168:171]
    ds_read_b128 a[156:159], v17 offset:43008
    v_mov_b32 v25, 0x3f803f80
    v_mfma_f32_16x16x32_bf16 v[172:175], a[144:147], a[72:75], v[172:175]
    buffer_load_dwordx4 v14, s[80:83], s52 offen offset:2048 lds
    v_mfma_f32_16x16x32_bf16 v[172:175], a[148:151], a[76:79], v[172:175]
    s_waitcnt lgkmcnt(0)
    v_mfma_f32_16x16x32_bf16 v[192:195], a[152:155], a[64:67], v[192:195]
    ds_read_b128 a[160:163], v16 offset:45056
    v_mfma_f32_16x16x32_bf16 v[192:195], a[156:159], a[68:71], v[192:195]
    ds_read_b128 a[164:167], v17 offset:45056
    v_mfma_f32_16x16x32_bf16 v[196:199], a[152:155], a[72:75], v[196:199]
    buffer_load_dwordx4 v15, s[80:83], s52 offen offset:3072 lds
    v_mfma_f32_16x16x32_bf16 v[196:199], a[156:159], a[76:79], v[196:199]
    s_add_u32 s52, s52, 65536
    s_waitcnt lgkmcnt(0)
    v_mfma_f32_16x16x32_bf16 v[216:219], a[160:163], a[64:67], v[216:219]
    ds_read_b128 a[168:171], v16 offset:47104
    s_add_u32 m0, s48, 98304
    v_mfma_f32_16x16x32_bf16 v[216:219], a[164:167], a[68:71], v[216:219]
    ds_read_b128 a[172:175], v17 offset:47104
    v_mfma_f32_16x16x32_bf16 v[220:223], a[160:163], a[72:75], v[220:223]
    buffer_load_dwordx4 v12, s[80:83], s52 offen lds
    v_mfma_f32_16x16x32_bf16 v[220:223], a[164:167], a[76:79], v[220:223]
    s_waitcnt lgkmcnt(0)
    v_mfma_f32_16x16x32_bf16 v[240:243], a[168:171], a[64:67], v[240:243]
    buffer_load_dwordx4 v13, s[80:83], s52 offen offset:1024 lds
    v_mfma_f32_16x16x32_bf16 v[240:243], a[172:175], a[68:71], v[240:243]
    s_lshl_b32 s56, s38, 12
    s_add_u32 s56, s56, 139264
    v_add_u32 v10, s56, v26
    v_mfma_f32_16x16x32_bf16 v[244:247], a[168:171], a[72:75], v[244:247]
    v_xor_b32 v11, 4096, v10
    v_mfma_f32_16x16x32_bf16 v[244:247], a[172:175], a[76:79], v[244:247]
K_TAIL:
    buffer_load_dwordx4 v14, s[80:83], s52 offen offset:2048 lds
    v_pk_fma_f32 v[2:3], v[76:77], s[66:67], v[20:21]
    v_pk_fma_f32 v[4:5], v[78:79], s[66:67], v[20:21]
    v_pk_fma_f32 v[6:7], v[100:101], s[66:67], v[20:21]
    v_pk_fma_f32 v[8:9], v[102:103], s[66:67], v[20:21]
    v_mfma_f32_16x16x32_bf16 v[80:83], a[112:115], a[80:83], v[80:83]
    v_exp_f32_e64 v2, v2 clamp
    v_exp_f32_e64 v3, v3 clamp
    v_mfma_f32_16x16x32_bf16 v[80:83], a[116:119], a[84:87], v[80:83]
    v_exp_f32_e64 v4, v4 clamp
    v_exp_f32_e64 v5, v5 clamp
    buffer_load_dwordx4 v15, s[80:83], s52 offen offset:3072 lds
    s_add_u32 s52, s52, 65536
    v_mfma_f32_16x16x32_bf16 v[84:87], a[112:115], a[88:91], v[84:87]
    v_exp_f32_e64 v6, v6 clamp
    v_exp_f32_e64 v7, v7 clamp
    v_mfma_f32_16x16x32_bf16 v[84:87], a[116:119], a[92:95], v[84:87]
    v_exp_f32_e64 v8, v8 clamp
    v_exp_f32_e64 v9, v9 clamp
    v_mfma_f32_16x16x32_bf16 v[104:107], a[120:123], a[80:83], v[104:107]
    v_max_f32 v76, v36, v76
    v_max_f32 v77, v36, v77
    v_mfma_f32_16x16x32_bf16 v[104:107], a[124:127], a[84:87], v[104:107]
    v_max_f32 v78, v36, v78
    v_max_f32 v79, v36, v79
    v_max_f32 v100, v36, v100
    v_mfma_f32_16x16x32_bf16 v[108:111], a[120:123], a[88:91], v[108:111]
    v_max_f32 v101, v36, v101
    s_add_u32 m0, s48, 102400
    s_nop 0
    buffer_load_dwordx4 v12, s[80:83], s52 offen lds
    v_max_f32 v102, v36, v102
    v_max_f32 v103, v36, v103
    v_pk_add_f32 v[2:3], v[76:77], v[2:3]
    v_pk_add_f32 v[4:5], v[78:79], v[4:5]
    v_pk_add_f32 v[6:7], v[100:101], v[6:7]
    v_pk_add_f32 v[8:9], v[102:103], v[8:9]
    v_mfma_f32_16x16x32_bf16 v[108:111], a[124:127], a[92:95], v[108:111]
    v_cvt_pk_bf16_f32 v76, v2, v3
    v_cvt_pk_bf16_f32 v77, v4, v5
    v_cvt_pk_bf16_f32 v78, v6, v7
    v_cvt_pk_bf16_f32 v79, v8, v9
    buffer_load_dwordx4 v13, s[80:83], s52 offen offset:1024 lds
    v_pk_fma_f32 v[2:3], v[124:125], s[66:67], v[20:21]
    v_pk_fma_f32 v[4:5], v[126:127], s[66:67], v[20:21]
    v_pk_fma_f32 v[6:7], v[148:149], s[66:67], v[20:21]
    v_pk_fma_f32 v[8:9], v[150:151], s[66:67], v[20:21]
    v_mfma_f32_16x16x32_bf16 v[128:131], a[128:131], a[80:83], v[128:131]
    v_exp_f32_e64 v2, v2 clamp
    v_exp_f32_e64 v3, v3 clamp
    v_mfma_f32_16x16x32_bf16 v[128:131], a[132:135], a[84:87], v[128:131]
    v_exp_f32_e64 v4, v4 clamp
    v_exp_f32_e64 v5, v5 clamp
    buffer_load_dwordx4 v14, s[80:83], s52 offen offset:2048 lds
    v_mfma_f32_16x16x32_bf16 v[132:135], a[128:131], a[88:91], v[132:135]
    v_exp_f32_e64 v6, v6 clamp
    v_exp_f32_e64 v7, v7 clamp
    v_mfma_f32_16x16x32_bf16 v[132:135], a[132:135], a[92:95], v[132:135]
    v_exp_f32_e64 v8, v8 clamp
    v_exp_f32_e64 v9, v9 clamp
    v_mfma_f32_16x16x32_bf16 v[152:155], a[136:139], a[80:83], v[152:155]
    v_max_f32 v124, v36, v124
    v_max_f32 v125, v36, v125
    v_mfma_f32_16x16x32_bf16 v[152:155], a[140:143], a[84:87], v[152:155]
    v_max_f32 v126, v36, v126
    v_max_f32 v127, v36, v127
    v_max_f32 v148, v36, v148
    v_mfma_f32_16x16x32_bf16 v[156:159], a[136:139], a[88:91], v[156:159]
    v_max_f32 v149, v36, v149
    buffer_load_dwordx4 v15, s[80:83], s52 offen offset:3072 lds
    s_add_u32 s52, s52, 65536
    v_max_f32 v150, v36, v150
    v_max_f32 v151, v36, v151
    v_pk_add_f32 v[2:3], v[124:125], v[2:3]
    v_pk_add_f32 v[4:5], v[126:127], v[4:5]
    v_pk_add_f32 v[6:7], v[148:149], v[6:7]
    v_pk_add_f32 v[8:9], v[150:151], v[8:9]
    v_mfma_f32_16x16x32_bf16 v[156:159], a[140:143], a[92:95], v[156:159]
    v_cvt_pk_bf16_f32 v124, v2, v3
    v_cvt_pk_bf16_f32 v125, v4, v5
    v_cvt_pk_bf16_f32 v126, v6, v7
    v_cvt_pk_bf16_f32 v127, v8, v9
    v_cvt_pk_bf16_f32 v80, v80, v81
    v_cvt_pk_bf16_f32 v81, v82, v83
    v_cvt_pk_bf16_f32 v82, v104, v105
    v_cvt_pk_bf16_f32 v83, v106, v107
    v_cvt_pk_bf16_f32 v84, v84, v85
    v_cvt_pk_bf16_f32 v85, v86, v87
    v_cvt_pk_bf16_f32 v86, v108, v109
    v_cvt_pk_bf16_f32 v87, v110, v111
    v_pk_fma_f32 v[2:3], v[172:173], s[66:67], v[20:21]
    v_pk_fma_f32 v[4:5], v[174:175], s[66:67], v[20:21]
    v_pk_fma_f32 v[6:7], v[196:197], s[66:67], v[20:21]
    v_pk_fma_f32 v[8:9], v[198:199], s[66:67], v[20:21]
    v_mfma_f32_16x16x32_bf16 v[176:179], a[144:147], a[80:83], v[176:179]
    v_exp_f32_e64 v2, v2 clamp
    v_exp_f32_e64 v3, v3 clamp
    v_mfma_f32_16x16x32_bf16 v[176:179], a[148:151], a[84:87], v[176:179]
    v_exp_f32_e64 v4, v4 clamp
    v_exp_f32_e64 v5, v5 clamp
    v_mfma_f32_16x16x32_bf16 v[180:183], a[144:147], a[88:91], v[180:183]
    v_exp_f32_e64 v6, v6 clamp
    v_exp_f32_e64 v7, v7 clamp
    v_mfma_f32_16x16x32_bf16 v[180:183], a[148:151], a[92:95], v[180:183]
    v_exp_f32_e64 v8, v8 clamp
    v_exp_f32_e64 v9, v9 clamp
    v_mfma_f32_16x16x32_bf16 v[200:203], a[152:155], a[80:83], v[200:203]
    v_max_f32 v172, v36, v172
    v_max_f32 v173, v36, v173
    v_mfma_f32_16x16x32_bf16 v[200:203], a[156:159], a[84:87], v[200:203]
    v_max_f32 v174, v36, v174
    v_max_f32 v175, v36, v175
    v_max_f32 v196, v36, v196
    v_mfma_f32_16x16x32_bf16 v[204:207], a[152:155], a[88:91], v[204:207]
    v_max_f32 v197, v36, v197
    v_max_f32 v198, v36, v198
    v_max_f32 v199, v36, v199
    v_pk_add_f32 v[2:3], v[172:173], v[2:3]
    v_pk_add_f32 v[4:5], v[174:175], v[4:5]
    v_pk_add_f32 v[6:7], v[196:197], v[6:7]
    v_pk_add_f32 v[8:9], v[198:199], v[8:9]
    v_mfma_f32_16x16x32_bf16 v[204:207], a[156:159], a[92:95], v[204:207]
    v_cvt_pk_bf16_f32 v172, v2, v3
    v_cvt_pk_bf16_f32 v173, v4, v5
    v_cvt_pk_bf16_f32 v174, v6, v7
    v_cvt_pk_bf16_f32 v175, v8, v9
    v_cvt_pk_bf16_f32 v128, v128, v129
    v_cvt_pk_bf16_f32 v129, v130, v131
    v_cvt_pk_bf16_f32 v130, v152, v153
    v_cvt_pk_bf16_f32 v131, v154, v155
    v_cvt_pk_bf16_f32 v132, v132, v133
    v_cvt_pk_bf16_f32 v133, v134, v135
    v_cvt_pk_bf16_f32 v134, v156, v157
    v_cvt_pk_bf16_f32 v135, v158, v159
    s_waitcnt vmcnt(4)
    ds_read_b64_tr_b16 a[16:17], v32 offset:0
    ds_read_b64_tr_b16 a[18:19], v32 offset:2048
    ds_read_b64_tr_b16 a[20:21], v33 offset:0
    ds_read_b64_tr_b16 a[22:23], v33 offset:2048
    ds_read_b64_tr_b16 a[24:25], v34 offset:0
    ds_read_b64_tr_b16 a[26:27], v34 offset:2048
    ds_read_b64_tr_b16 a[28:29], v35 offset:0
    ds_read_b64_tr_b16 a[30:31], v35 offset:2048
    v_pk_fma_f32 v[2:3], v[220:221], s[66:67], v[20:21]
    v_pk_fma_f32 v[4:5], v[222:223], s[66:67], v[20:21]
    v_pk_fma_f32 v[6:7], v[244:245], s[66:67], v[20:21]
    v_pk_fma_f32 v[8:9], v[246:247], s[66:67], v[20:21]
    v_mfma_f32_16x16x32_bf16 v[224:227], a[160:163], a[80:83], v[224:227]
    v_exp_f32_e64 v2, v2 clamp
    v_exp_f32_e64 v3, v3 clamp
    v_mfma_f32_16x16x32_bf16 v[224:227], a[164:167], a[84:87], v[224:227]
    v_exp_f32_e64 v4, v4 clamp
    v_exp_f32_e64 v5, v5 clamp
    ds_read_b64_tr_b16 a[32:33], v32 offset:4096
    ds_read_b64_tr_b16 a[34:35], v32 offset:6144
    ds_read_b64_tr_b16 a[36:37], v33 offset:4096
    ds_read_b64_tr_b16 a[38:39], v33 offset:6144
    ds_read_b64_tr_b16 a[40:41], v34 offset:4096
    ds_read_b64_tr_b16 a[42:43], v34 offset:6144
    ds_read_b64_tr_b16 a[44:45], v35 offset:4096
    ds_read_b64_tr_b16 a[46:47], v35 offset:6144
    v_mfma_f32_16x16x32_bf16 v[228:231], a[160:163], a[88:91], v[228:231]
    v_exp_f32_e64 v6, v6 clamp
    v_exp_f32_e64 v7, v7 clamp
    v_mfma_f32_16x16x32_bf16 v[228:231], a[164:167], a[92:95], v[228:231]
    v_exp_f32_e64 v8, v8 clamp
    v_exp_f32_e64 v9, v9 clamp
    v_mfma_f32_16x16x32_bf16 v[248:251], a[168:171], a[80:83], v[248:251]
    v_max_f32 v220, v36, v220
    v_max_f32 v221, v36, v221
    v_mfma_f32_16x16x32_bf16 v[248:251], a[172:175], a[84:87], v[248:251]
    v_max_f32 v222, v36, v222
    v_max_f32 v223, v36, v223
    v_max_f32 v244, v36, v244
    v_mfma_f32_16x16x32_bf16 v[252:255], a[168:171], a[88:91], v[252:255]
    v_max_f32 v245, v36, v245
    ds_read_b64_tr_b16 a[64:65], v32 offset:32768
    ds_read_b64_tr_b16 a[66:67], v32 offset:34816
    ds_read_b64_tr_b16 a[68:69], v33 offset:32768
    ds_read_b64_tr_b16 a[70:71], v33 offset:34816
    ds_read_b64_tr_b16 a[72:73], v34 offset:32768
    ds_read_b64_tr_b16 a[74:75], v34 offset:34816
    ds_read_b64_tr_b16 a[76:77], v35 offset:32768
    ds_read_b64_tr_b16 a[78:79], v35 offset:34816
    v_max_f32 v246, v36, v246
    v_max_f32 v247, v36, v247
    v_pk_add_f32 v[2:3], v[220:221], v[2:3]
    v_pk_add_f32 v[4:5], v[222:223], v[4:5]
    v_pk_add_f32 v[6:7], v[244:245], v[6:7]
    v_pk_add_f32 v[8:9], v[246:247], v[8:9]
    v_mfma_f32_16x16x32_bf16 v[252:255], a[172:175], a[92:95], v[252:255]
    v_cvt_pk_bf16_f32 v220, v2, v3
    v_cvt_pk_bf16_f32 v221, v4, v5
    v_cvt_pk_bf16_f32 v222, v6, v7
    v_cvt_pk_bf16_f32 v223, v8, v9
    v_cvt_pk_bf16_f32 v176, v176, v177
    v_cvt_pk_bf16_f32 v177, v178, v179
    v_cvt_pk_bf16_f32 v178, v200, v201
    v_cvt_pk_bf16_f32 v179, v202, v203
    v_cvt_pk_bf16_f32 v180, v180, v181
    v_cvt_pk_bf16_f32 v181, v182, v183
    v_cvt_pk_bf16_f32 v182, v204, v205
    v_cvt_pk_bf16_f32 v183, v206, v207
    v_cvt_pk_bf16_f32 v224, v224, v225
    v_cvt_pk_bf16_f32 v225, v226, v227
    v_cvt_pk_bf16_f32 v226, v248, v249
    v_cvt_pk_bf16_f32 v227, v250, v251
    v_cvt_pk_bf16_f32 v228, v228, v229
    v_cvt_pk_bf16_f32 v229, v230, v231
    v_cvt_pk_bf16_f32 v230, v252, v253
    v_cvt_pk_bf16_f32 v231, v254, v255
    s_waitcnt lgkmcnt(0)
    s_add_u32 m0, s48, 65536
    s_nop 0
    buffer_load_dwordx4 v12, s[80:83], s52 offen lds
    v_pk_fma_f32 v[2:3], v[72:73], s[66:67], v[20:21]
    v_pk_fma_f32 v[4:5], v[74:75], s[66:67], v[20:21]
    v_pk_fma_f32 v[6:7], v[96:97], s[66:67], v[20:21]
    v_pk_fma_f32 v[8:9], v[98:99], s[66:67], v[20:21]
    v_mfma_f32_16x16x32_bf16 v[60:63], v[76:79], v[22:25], 0
    v_exp_f32_e64 v2, v2 clamp
    v_exp_f32_e64 v3, v3 clamp
    v_mfma_f32_16x16x32_bf16 v[48:51], v[76:79], v[80:83], 0
    v_exp_f32_e64 v4, v4 clamp
    v_exp_f32_e64 v5, v5 clamp
    buffer_load_dwordx4 v13, s[80:83], s52 offen offset:1024 lds
    v_mfma_f32_16x16x32_bf16 v[52:55], v[76:79], v[84:87], 0
    v_exp_f32_e64 v6, v6 clamp
    v_exp_f32_e64 v7, v7 clamp
    v_mfma_f32_16x16x32_bf16 v[60:63], v[124:127], v[22:25], v[60:63]
    v_exp_f32_e64 v8, v8 clamp
    v_exp_f32_e64 v9, v9 clamp
    v_mfma_f32_16x16x32_bf16 v[48:51], v[124:127], v[128:131], v[48:51]
    v_max_f32 v72, v36, v72
    v_max_f32 v73, v36, v73
    v_mfma_f32_16x16x32_bf16 v[52:55], v[124:127], v[132:135], v[52:55]
    v_max_f32 v74, v36, v74
    v_max_f32 v75, v36, v75
    v_max_f32 v96, v36, v96
    v_mfma_f32_16x16x32_bf16 v[60:63], v[172:175], v[22:25], v[60:63]
    v_max_f32 v97, v36, v97
    buffer_load_dwordx4 v14, s[80:83], s52 offen offset:2048 lds
    v_max_f32 v98, v36, v98
    v_max_f32 v99, v36, v99
    v_pk_add_f32 v[2:3], v[72:73], v[2:3]
    v_pk_add_f32 v[4:5], v[74:75], v[4:5]
    v_pk_add_f32 v[6:7], v[96:97], v[6:7]
    v_pk_add_f32 v[8:9], v[98:99], v[8:9]
    v_mfma_f32_16x16x32_bf16 v[48:51], v[172:175], v[176:179], v[48:51]
    v_cvt_pk_bf16_f32 v72, v2, v3
    v_cvt_pk_bf16_f32 v73, v4, v5
    v_cvt_pk_bf16_f32 v74, v6, v7
    v_cvt_pk_bf16_f32 v75, v8, v9
    buffer_load_dwordx4 v15, s[80:83], s52 offen offset:3072 lds
    s_add_u32 s52, s52, 65536
    v_pk_fma_f32 v[2:3], v[120:121], s[66:67], v[20:21]
    v_pk_fma_f32 v[4:5], v[122:123], s[66:67], v[20:21]
    v_pk_fma_f32 v[6:7], v[144:145], s[66:67], v[20:21]
    v_pk_fma_f32 v[8:9], v[146:147], s[66:67], v[20:21]
    v_mfma_f32_16x16x32_bf16 v[52:55], v[172:175], v[180:183], v[52:55]
    v_exp_f32_e64 v2, v2 clamp
    v_exp_f32_e64 v3, v3 clamp
    v_mfma_f32_16x16x32_bf16 v[60:63], v[220:223], v[22:25], v[60:63]
    v_exp_f32_e64 v4, v4 clamp
    v_exp_f32_e64 v5, v5 clamp
    s_add_u32 m0, s48, 69632
    s_nop 0
    buffer_load_dwordx4 v12, s[80:83], s52 offen lds
    v_mfma_f32_16x16x32_bf16 v[48:51], v[220:223], v[224:227], v[48:51]
    v_exp_f32_e64 v6, v6 clamp
    v_exp_f32_e64 v7, v7 clamp
    v_mfma_f32_16x16x32_bf16 v[52:55], v[220:223], v[228:231], v[52:55]
    v_exp_f32_e64 v8, v8 clamp
    v_exp_f32_e64 v9, v9 clamp
    v_mfma_f32_16x16x32_bf16 v[56:59], v[72:75], v[22:25], 0
    v_max_f32 v120, v36, v120
    v_max_f32 v121, v36, v121
    v_mfma_f32_16x16x32_bf16 v[40:43], v[72:75], v[80:83], 0
    v_max_f32 v122, v36, v122
    v_max_f32 v123, v36, v123
    v_max_f32 v144, v36, v144
    v_mfma_f32_16x16x32_bf16 v[44:47], v[72:75], v[84:87], 0
    v_max_f32 v145, v36, v145
    buffer_load_dwordx4 v13, s[80:83], s52 offen offset:1024 lds
    v_max_f32 v146, v36, v146
    v_max_f32 v147, v36, v147
    v_pk_add_f32 v[2:3], v[120:121], v[2:3]
    v_pk_add_f32 v[4:5], v[122:123], v[4:5]
    v_pk_add_f32 v[6:7], v[144:145], v[6:7]
    v_pk_add_f32 v[8:9], v[146:147], v[8:9]
    v_cvt_pk_bf16_f32 v120, v2, v3
    v_cvt_pk_bf16_f32 v121, v4, v5
    v_cvt_pk_bf16_f32 v122, v6, v7
    v_cvt_pk_bf16_f32 v123, v8, v9
    buffer_load_dwordx4 v14, s[80:83], s52 offen offset:2048 lds
    ds_write_b128 v10, v[60:63] offset:2048
    ds_write_b128 v10, v[48:51]
    ds_write_b128 v10, v[52:55] offset:1024
    v_pk_fma_f32 v[2:3], v[168:169], s[66:67], v[20:21]
    v_pk_fma_f32 v[4:5], v[170:171], s[66:67], v[20:21]
    v_pk_fma_f32 v[6:7], v[192:193], s[66:67], v[20:21]
    v_pk_fma_f32 v[8:9], v[194:195], s[66:67], v[20:21]
    v_mfma_f32_16x16x32_bf16 v[56:59], v[120:123], v[22:25], v[56:59]
    v_exp_f32_e64 v2, v2 clamp
    v_exp_f32_e64 v3, v3 clamp
    v_mfma_f32_16x16x32_bf16 v[40:43], v[120:123], v[128:131], v[40:43]
    v_exp_f32_e64 v4, v4 clamp
    v_exp_f32_e64 v5, v5 clamp
    buffer_load_dwordx4 v15, s[80:83], s52 offen offset:3072 lds
    s_add_u32 s52, s52, 65536
    v_mfma_f32_16x16x32_bf16 v[44:47], v[120:123], v[132:135], v[44:47]
    v_exp_f32_e64 v6, v6 clamp
    v_exp_f32_e64 v7, v7 clamp
    v_exp_f32_e64 v8, v8 clamp
    v_exp_f32_e64 v9, v9 clamp
    v_max_f32 v168, v36, v168
    v_max_f32 v169, v36, v169
    v_max_f32 v170, v36, v170
    v_max_f32 v171, v36, v171
    v_max_f32 v192, v36, v192
    v_max_f32 v193, v36, v193
    s_add_u32 m0, s48, 98304
    s_nop 0
    buffer_load_dwordx4 v12, s[80:83], s52 offen lds
    v_max_f32 v194, v36, v194
    v_max_f32 v195, v36, v195
    v_pk_add_f32 v[2:3], v[168:169], v[2:3]
    v_pk_add_f32 v[4:5], v[170:171], v[4:5]
    v_pk_add_f32 v[6:7], v[192:193], v[6:7]
    v_pk_add_f32 v[8:9], v[194:195], v[8:9]
    v_cvt_pk_bf16_f32 v168, v2, v3
    v_cvt_pk_bf16_f32 v169, v4, v5
    v_cvt_pk_bf16_f32 v170, v6, v7
    v_cvt_pk_bf16_f32 v171, v8, v9
    s_waitcnt lgkmcnt(0)
    s_barrier
    ds_read_b128 v[48:51], v11 offset:1024
    ds_read_b128 v[52:55], v11
    ds_read_b128 v[60:63], v11 offset:2048
    s_lshl_b32 s56, s39, 10
    s_add_u32 s58, s62, s56
    s_xor_b32 s59, s58, 1024
    s_mov_b32 s56, 0x00010001
    s_mov_b32 s57, 0x00010001
    buffer_load_dwordx4 v13, s[80:83], s52 offen offset:1024 lds
    v_pk_fma_f32 v[2:3], v[216:217], s[66:67], v[20:21]
    v_pk_fma_f32 v[4:5], v[218:219], s[66:67], v[20:21]
    v_pk_fma_f32 v[6:7], v[240:241], s[66:67], v[20:21]
    v_pk_fma_f32 v[8:9], v[242:243], s[66:67], v[20:21]
    v_mfma_f32_16x16x32_bf16 v[56:59], v[168:171], v[22:25], v[56:59]
    v_exp_f32_e64 v2, v2 clamp
    v_exp_f32_e64 v3, v3 clamp
    v_mfma_f32_16x16x32_bf16 v[40:43], v[168:171], v[176:179], v[40:43]
    v_exp_f32_e64 v4, v4 clamp
    v_exp_f32_e64 v5, v5 clamp
    buffer_load_dwordx4 v14, s[80:83], s52 offen offset:2048 lds
    v_mfma_f32_16x16x32_bf16 v[44:47], v[168:171], v[180:183], v[44:47]
    v_exp_f32_e64 v6, v6 clamp
    v_exp_f32_e64 v7, v7 clamp
    v_exp_f32_e64 v8, v8 clamp
    v_exp_f32_e64 v9, v9 clamp
    v_max_f32 v216, v36, v216
    v_max_f32 v217, v36, v217
    v_max_f32 v218, v36, v218
    v_max_f32 v219, v36, v219
    v_max_f32 v240, v36, v240
    v_max_f32 v241, v36, v241
    buffer_load_dwordx4 v15, s[80:83], s52 offen offset:3072 lds
    s_add_u32 s52, s52, 65536
    v_max_f32 v242, v36, v242
    v_max_f32 v243, v36, v243
    v_pk_add_f32 v[2:3], v[216:217], v[2:3]
    v_pk_add_f32 v[4:5], v[218:219], v[4:5]
    v_pk_add_f32 v[6:7], v[240:241], v[6:7]
    v_pk_add_f32 v[8:9], v[242:243], v[8:9]
    v_cvt_pk_bf16_f32 v216, v2, v3
    v_cvt_pk_bf16_f32 v217, v4, v5
    v_cvt_pk_bf16_f32 v218, v6, v7
    v_cvt_pk_bf16_f32 v219, v8, v9
    s_nop 1
    v_mfma_f32_16x16x32_bf16 v[40:43], v[216:219], v[224:227], v[40:43]
    v_mfma_f32_16x16x32_bf16 v[44:47], v[216:219], v[228:231], v[44:47]
    v_mfma_f32_16x16x32_bf16 v[56:59], v[216:219], v[22:25], v[56:59]
    s_waitcnt lgkmcnt(0)
    s_nop 4
    v_pk_add_f32 v[40:41], v[40:41], v[48:49]
    v_pk_add_f32 v[42:43], v[42:43], v[50:51]
    v_pk_add_f32 v[44:45], v[44:45], v[52:53]
    v_pk_add_f32 v[46:47], v[46:47], v[54:55]
    v_pk_add_f32 v[56:57], v[56:57], v[60:61]
    v_pk_add_f32 v[58:59], v[58:59], v[62:63]
    v_min_u32 v40, -2, v40
    v_min_u32 v41, -2, v41
    v_min_u32 v42, -2, v42
    v_min_u32 v43, -2, v43
    v_min_u32 v44, -2, v44
    v_min_u32 v45, -2, v45
    v_min_u32 v46, -2, v46
    v_min_u32 v47, -2, v47
    v_min_u32 v56, -2, v56
    v_min_u32 v57, -2, v57
    v_min_u32 v58, -2, v58
    v_min_u32 v59, -2, v59
    buffer_store_dwordx4 v[40:43], v26, s[24:27], s58 offen sc1
    buffer_store_dwordx4 v[44:47], v26, s[24:27], s59 offen sc1
    s_mov_b64 exec, s[56:57]
    buffer_store_dwordx4 v[56:59], v27, s[24:27], s62 offen offset:2048 sc1
    s_mov_b64 exec, -1
    s_mov_b32 s58, -1
    s_mov_b32 s59, 0
K_HS:
    v_cmp_eq_u32 vcc, 8, v28
    s_nop 1
    s_cmp_eq_u64 vcc, s[58:59]
    s_cbranch_scc1 K_HSOK
    s_sleep 2
    v_lshlrev_b32 v10, 3, v1
    buffer_load_dword v28, v10, s[28:31], 0 offen sc1
    s_waitcnt vmcnt(0)
    s_branch K_HS
K_HSOK:
    s_lshl_b32 s56, s38, 11
    s_add_u32 s56, s56, 155648
    v_lshl_add_u32 v10, v1, 3, s56
    v_xor_b32 v11, 2048, v10
    ds_read_b128 a[96:99], v16 offset:0
    ds_read_b128 a[100:103], v17 offset:0
    v_mfma_f32_16x16x32_bf16 v[64:67], a[48:51], a[112:115], v[64:67]
    v_mfma_f32_16x16x32_bf16 v[64:67], a[52:55], a[116:119], v[64:67]
    ds_read_b128 a[104:107], v16 offset:2048
    ds_read_b128 a[108:111], v17 offset:2048
    v_mfma_f32_16x16x32_bf16 v[68:71], a[56:59], a[112:115], v[68:71]
    s_add_u32 m0, s48, 32768
    s_nop 0
    buffer_load_dwordx4 v12, s[80:83], s52 offen lds
    v_mfma_f32_16x16x32_bf16 v[68:71], a[60:63], a[116:119], v[68:71]
    buffer_load_dwordx4 v13, s[80:83], s52 offen offset:1024 lds
    s_waitcnt lgkmcnt(3)
    v_mfma_f32_16x16x32_bf16 v[64:67], a[0:3], a[96:99], v[64:67]
    s_waitcnt lgkmcnt(2)
    v_mfma_f32_16x16x32_bf16 v[64:67], a[4:7], a[100:103], v[64:67]
    buffer_load_dwordx4 v14, s[80:83], s52 offen offset:2048 lds
    v_mfma_f32_16x16x32_bf16 v[68:71], a[8:11], a[96:99], v[68:71]
    buffer_load_dwordx4 v15, s[80:83], s52 offen offset:3072 lds
    s_add_u32 s52, s52, 65536
    v_mfma_f32_16x16x32_bf16 v[68:71], a[12:15], a[100:103], v[68:71]
    v_mfma_f32_16x16x32_bf16 v[88:91], a[48:51], a[120:123], v[88:91]
    v_mfma_f32_16x16x32_bf16 v[88:91], a[52:55], a[124:127], v[88:91]
    ds_read_b128 a[96:99], v16 offset:4096
    ds_read_b128 a[100:103], v17 offset:4096
    v_mfma_f32_16x16x32_bf16 v[92:95], a[56:59], a[120:123], v[92:95]
    s_add_u32 m0, s48, 36864
    s_nop 0
    buffer_load_dwordx4 v12, s[80:83], s52 offen lds
    v_mfma_f32_16x16x32_bf16 v[92:95], a[60:63], a[124:127], v[92:95]
    buffer_load_dwordx4 v13, s[80:83], s52 offen offset:1024 lds
    s_waitcnt lgkmcnt(3)
    v_mfma_f32_16x16x32_bf16 v[88:91], a[0:3], a[104:107], v[88:91]
    s_waitcnt lgkmcnt(2)
    v_mfma_f32_16x16x32_bf16 v[88:91], a[4:7], a[108:111], v[88:91]
    buffer_load_dwordx4 v14, s[80:83], s52 offen offset:2048 lds
    v_mfma_f32_16x16x32_bf16 v[92:95], a[8:11], a[104:107], v[92:95]
    buffer_load_dwordx4 v15, s[80:83], s52 offen offset:3072 lds
    s_add_u32 s52, s52, 65536
    v_mfma_f32_16x16x32_bf16 v[92:95], a[12:15], a[108:111], v[92:95]
    ds_read_b128 a[104:107], v16 offset:6144
    ds_read_b128 a[108:111], v17 offset:6144
    v_pk_fma_f32 v[2:3], v[64:65], s[66:67], v[20:21]
    v_pk_fma_f32 v[4:5], v[66:67], s[66:67], v[20:21]
    v_pk_fma_f32 v[6:7], v[68:69], s[66:67], v[20:21]
    v_pk_fma_f32 v[8:9], v[70:71], s[66:67], v[20:21]
    v_mfma_f32_16x16x32_bf16 v[112:115], a[48:51], a[128:131], v[112:115]
    v_exp_f32_e64 v2, v2 clamp
    v_exp_f32_e64 v3, v3 clamp
    v_mfma_f32_16x16x32_bf16 v[112:115], a[52:55], a[132:135], v[112:115]
    v_exp_f32_e64 v4, v4 clamp
    v_exp_f32_e64 v5, v5 clamp
    v_mfma_f32_16x16x32_bf16 v[116:119], a[56:59], a[128:131], v[116:119]
    v_exp_f32_e64 v6, v6 clamp
    v_exp_f32_e64 v7, v7 clamp
    v_mfma_f32_16x16x32_bf16 v[116:119], a[60:63], a[132:135], v[116:119]
    v_exp_f32_e64 v8, v8 clamp
    v_exp_f32_e64 v9, v9 clamp
    s_waitcnt lgkmcnt(3)
    v_mfma_f32_16x16x32_bf16 v[112:115], a[0:3], a[96:99], v[112:115]
    v_max_f32 v64, v36, v64
    v_max_f32 v65, v36, v65
    s_waitcnt lgkmcnt(2)
    v_mfma_f32_16x16x32_bf16 v[112:115], a[4:7], a[100:103], v[112:115]
    v_max_f32 v66, v36, v66
    v_max_f32 v67, v36, v67
    v_max_f32 v68, v36, v68
    v_mfma_f32_16x16x32_bf16 v[116:119], a[8:11], a[96:99], v[116:119]
    v_max_f32 v69, v36, v69
    v_max_f32 v70, v36, v70
    v_max_f32 v71, v36, v71
    v_pk_add_f32 v[2:3], v[64:65], v[2:3]
    v_pk_add_f32 v[4:5], v[66:67], v[4:5]
    v_pk_add_f32 v[6:7], v[68:69], v[6:7]
    v_pk_add_f32 v[8:9], v[70:71], v[8:9]
    v_mfma_f32_16x16x32_bf16 v[116:119], a[12:15], a[100:103], v[116:119]
    v_cvt_pk_bf16_f32 v64, v2, v3
    v_cvt_pk_bf16_f32 v65, v4, v5
    v_cvt_pk_bf16_f32 v66, v6, v7
    v_cvt_pk_bf16_f32 v67, v8, v9
    ds_read_b128 a[96:99], v16 offset:8192
    ds_read_b128 a[100:103], v17 offset:8192
    v_pk_fma_f32 v[2:3], v[88:89], s[66:67], v[20:21]
    v_pk_fma_f32 v[4:5], v[90:91], s[66:67], v[20:21]
    v_pk_fma_f32 v[6:7], v[92:93], s[66:67], v[20:21]
    v_pk_fma_f32 v[8:9], v[94:95], s[66:67], v[20:21]
    v_mfma_f32_16x16x32_bf16 v[136:139], a[48:51], a[136:139], v[136:139]
    v_exp_f32_e64 v2, v2 clamp
    v_exp_f32_e64 v3, v3 clamp
    v_mfma_f32_16x16x32_bf16 v[136:139], a[52:55], a[140:143], v[136:139]
    v_exp_f32_e64 v4, v4 clamp
    v_exp_f32_e64 v5, v5 clamp
    v_mfma_f32_16x16x32_bf16 v[140:143], a[56:59], a[136:139], v[140:143]
    v_exp_f32_e64 v6, v6 clamp
    v_exp_f32_e64 v7, v7 clamp
    v_mfma_f32_16x16x32_bf16 v[140:143], a[60:63], a[140:143], v[140:143]
    v_exp_f32_e64 v8, v8 clamp
    v_exp_f32_e64 v9, v9 clamp
    s_waitcnt lgkmcnt(3)
    v_mfma_f32_16x16x32_bf16 v[136:139], a[0:3], a[104:107], v[136:139]
    v_max_f32 v88, v36, v88
    v_max_f32 v89, v36, v89
    s_waitcnt lgkmcnt(2)
    v_mfma_f32_16x16x32_bf16 v[136:139], a[4:7], a[108:111], v[136:139]
    v_max_f32 v90, v36, v90
    v_max_f32 v91, v36, v91
    v_max_f32 v92, v36, v92
    v_mfma_f32_16x16x32_bf16 v[140:143], a[8:11], a[104:107], v[140:143]
    v_max_f32 v93, v36, v93
    v_max_f32 v94, v36, v94
    v_max_f32 v95, v36, v95
    v_pk_add_f32 v[2:3], v[88:89], v[2:3]
    v_pk_add_f32 v[4:5], v[90:91], v[4:5]
    v_pk_add_f32 v[6:7], v[92:93], v[6:7]
    v_pk_add_f32 v[8:9], v[94:95], v[8:9]
    v_mfma_f32_16x16x32_bf16 v[140:143], a[12:15], a[108:111], v[140:143]
    v_cvt_pk_bf16_f32 v88, v2, v3
    v_cvt_pk_bf16_f32 v89, v4, v5
    v_cvt_pk_bf16_f32 v90, v6, v7
    v_cvt_pk_bf16_f32 v91, v8, v9
    ds_read_b128 a[104:107], v16 offset:10240
    ds_read_b128 a[108:111], v17 offset:10240
    v_pk_fma_f32 v[2:3], v[112:113], s[66:67], v[20:21]
    v_pk_fma_f32 v[4:5], v[114:115], s[66:67], v[20:21]
    v_pk_fma_f32 v[6:7], v[116:117], s[66:67], v[20:21]
    v_pk_fma_f32 v[8:9], v[118:119], s[66:67], v[20:21]
    v_mfma_f32_16x16x32_bf16 v[160:163], a[48:51], a[144:147], v[160:163]
    v_exp_f32_e64 v2, v2 clamp
    v_exp_f32_e64 v3, v3 clamp
    v_mfma_f32_16x16x32_bf16 v[160:163], a[52:55], a[148:151], v[160:163]
    v_exp_f32_e64 v4, v4 clamp
    v_exp_f32_e64 v5, v5 clamp
    v_mfma_f32_16x16x32_bf16 v[164:167], a[56:59], a[144:147], v[164:167]
    v_exp_f32_e64 v6, v6 clamp
    v_exp_f32_e64 v7, v7 clamp
    v_mfma_f32_16x16x32_bf16 v[164:167], a[60:63], a[148:151], v[164:167]
    v_exp_f32_e64 v8, v8 clamp
    v_exp_f32_e64 v9, v9 clamp
    s_waitcnt lgkmcnt(3)
    v_mfma_f32_16x16x32_bf16 v[160:163], a[0:3], a[96:99], v[160:163]
    v_max_f32 v112, v36, v112
    v_max_f32 v113, v36, v113
    s_waitcnt lgkmcnt(2)
    v_mfma_f32_16x16x32_bf16 v[160:163], a[4:7], a[100:103], v[160:163]
    v_max_f32 v114, v36, v114
    v_max_f32 v115, v36, v115
    v_max_f32 v116, v36, v116
    v_mfma_f32_16x16x32_bf16 v[164:167], a[8:11], a[96:99], v[164:167]
    v_max_f32 v117, v36, v117
    v_max_f32 v118, v36, v118
    v_max_f32 v119, v36, v119
    v_pk_add_f32 v[2:3], v[112:113], v[2:3]
    v_pk_add_f32 v[4:5], v[114:115], v[4:5]
    v_pk_add_f32 v[6:7], v[116:117], v[6:7]
    v_pk_add_f32 v[8:9], v[118:119], v[8:9]
    v_mfma_f32_16x16x32_bf16 v[164:167], a[12:15], a[100:103], v[164:167]
    v_cvt_pk_bf16_f32 v112, v2, v3
    v_cvt_pk_bf16_f32 v113, v4, v5
    v_cvt_pk_bf16_f32 v114, v6, v7
    v_cvt_pk_bf16_f32 v115, v8, v9
    ds_read_b128 a[96:99], v16 offset:12288
    ds_read_b128 a[100:103], v17 offset:12288
    s_add_u32 s56, s61, 0
    buffer_load_dwordx4 v[72:75], v26, s[24:27], s56 offen offset:0 sc1
    v_pk_fma_f32 v[2:3], v[136:137], s[66:67], v[20:21]
    v_pk_fma_f32 v[4:5], v[138:139], s[66:67], v[20:21]
    v_pk_fma_f32 v[6:7], v[140:141], s[66:67], v[20:21]
    v_pk_fma_f32 v[8:9], v[142:143], s[66:67], v[20:21]
    v_mfma_f32_16x16x32_bf16 v[184:187], a[48:51], a[152:155], v[184:187]
    v_exp_f32_e64 v2, v2 clamp
    v_exp_f32_e64 v3, v3 clamp
    v_mfma_f32_16x16x32_bf16 v[184:187], a[52:55], a[156:159], v[184:187]
    v_exp_f32_e64 v4, v4 clamp
    v_exp_f32_e64 v5, v5 clamp
    buffer_load_dwordx4 v[76:79], v26, s[24:27], s56 offen offset:1024 sc1
    s_add_u32 s56, s61, 16384
    buffer_load_dwordx4 v[96:99], v26, s[24:27], s56 offen offset:0 sc1
    v_mfma_f32_16x16x32_bf16 v[188:191], a[56:59], a[152:155], v[188:191]
    v_exp_f32_e64 v6, v6 clamp
    v_exp_f32_e64 v7, v7 clamp
    v_mfma_f32_16x16x32_bf16 v[188:191], a[60:63], a[156:159], v[188:191]
    v_exp_f32_e64 v8, v8 clamp
    v_exp_f32_e64 v9, v9 clamp
    s_waitcnt lgkmcnt(3)
    v_mfma_f32_16x16x32_bf16 v[184:187], a[0:3], a[104:107], v[184:187]
    v_max_f32 v136, v36, v136
    v_max_f32 v137, v36, v137
    s_waitcnt lgkmcnt(2)
    v_mfma_f32_16x16x32_bf16 v[184:187], a[4:7], a[108:111], v[184:187]
    v_max_f32 v138, v36, v138
    v_max_f32 v139, v36, v139
    v_max_f32 v140, v36, v140
    v_mfma_f32_16x16x32_bf16 v[188:191], a[8:11], a[104:107], v[188:191]
    v_max_f32 v141, v36, v141
    buffer_load_dwordx4 v[100:103], v26, s[24:27], s56 offen offset:1024 sc1
    s_add_u32 s56, s61, 32768
    buffer_load_dwordx4 v[120:123], v26, s[24:27], s56 offen offset:0 sc1
    v_max_f32 v142, v36, v142
    v_max_f32 v143, v36, v143
    v_pk_add_f32 v[2:3], v[136:137], v[2:3]
    v_pk_add_f32 v[4:5], v[138:139], v[4:5]
    v_pk_add_f32 v[6:7], v[140:141], v[6:7]
    v_pk_add_f32 v[8:9], v[142:143], v[8:9]
    v_mfma_f32_16x16x32_bf16 v[188:191], a[12:15], a[108:111], v[188:191]
    v_cvt_pk_bf16_f32 v136, v2, v3
    v_cvt_pk_bf16_f32 v137, v4, v5
    v_cvt_pk_bf16_f32 v138, v6, v7
    v_cvt_pk_bf16_f32 v139, v8, v9
    ds_read_b128 a[104:107], v16 offset:14336
    ds_read_b128 a[108:111], v17 offset:14336
    buffer_load_dwordx4 v[124:127], v26, s[24:27], s56 offen offset:1024 sc1
    v_pk_fma_f32 v[2:3], v[160:161], s[66:67], v[20:21]
    v_pk_fma_f32 v[4:5], v[162:163], s[66:67], v[20:21]
    v_pk_fma_f32 v[6:7], v[164:165], s[66:67], v[20:21]
    v_pk_fma_f32 v[8:9], v[166:167], s[66:67], v[20:21]
    v_mfma_f32_16x16x32_bf16 v[208:211], a[48:51], a[160:163], v[208:211]
    v_exp_f32_e64 v2, v2 clamp
    v_exp_f32_e64 v3, v3 clamp
    v_mfma_f32_16x16x32_bf16 v[208:211], a[52:55], a[164:167], v[208:211]
    v_exp_f32_e64 v4, v4 clamp
    v_exp_f32_e64 v5, v5 clamp
    s_add_u32 s56, s61, 49152
    buffer_load_dwordx4 v[144:147], v26, s[24:27], s56 offen offset:0 sc1
    buffer_load_dwordx4 v[148:151], v26, s[24:27], s56 offen offset:1024 sc1
    v_mfma_f32_16x16x32_bf16 v[212:215], a[56:59], a[160:163], v[212:215]
    v_exp_f32_e64 v6, v6 clamp
    v_exp_f32_e64 v7, v7 clamp
    v_mfma_f32_16x16x32_bf16 v[212:215], a[60:63], a[164:167], v[212:215]
    v_exp_f32_e64 v8, v8 clamp
    v_exp_f32_e64 v9, v9 clamp
    s_waitcnt lgkmcnt(3)
    v_mfma_f32_16x16x32_bf16 v[208:211], a[0:3], a[96:99], v[208:211]
    v_max_f32 v160, v36, v160
    v_max_f32 v161, v36, v161
    s_waitcnt lgkmcnt(2)
    v_mfma_f32_16x16x32_bf16 v[208:211], a[4:7], a[100:103], v[208:211]
    v_max_f32 v162, v36, v162
    v_max_f32 v163, v36, v163
    v_max_f32 v164, v36, v164
    v_mfma_f32_16x16x32_bf16 v[212:215], a[8:11], a[96:99], v[212:215]
    v_max_f32 v165, v36, v165
    s_add_u32 s56, s61, 65536
    buffer_load_dwordx4 v[168:171], v26, s[24:27], s56 offen offset:0 sc1
    v_max_f32 v166, v36, v166
    v_max_f32 v167, v36, v167
    v_pk_add_f32 v[2:3], v[160:161], v[2:3]
    v_pk_add_f32 v[4:5], v[162:163], v[4:5]
    v_pk_add_f32 v[6:7], v[164:165], v[6:7]
    v_pk_add_f32 v[8:9], v[166:167], v[8:9]
    v_mfma_f32_16x16x32_bf16 v[212:215], a[12:15], a[100:103], v[212:215]
    v_cvt_pk_bf16_f32 v160, v2, v3
    v_cvt_pk_bf16_f32 v161, v4, v5
    v_cvt_pk_bf16_f32 v162, v6, v7
    v_cvt_pk_bf16_f32 v163, v8, v9
    buffer_load_dwordx4 v[172:175], v26, s[24:27], s56 offen offset:1024 sc1
    v_pk_fma_f32 v[2:3], v[184:185], s[66:67], v[20:21]
    v_pk_fma_f32 v[4:5], v[186:187], s[66:67], v[20:21]
    v_pk_fma_f32 v[6:7], v[188:189], s[66:67], v[20:21]
    v_pk_fma_f32 v[8:9], v[190:191], s[66:67], v[20:21]
    v_mfma_f32_16x16x32_bf16 v[232:235], a[48:51], a[168:171], v[232:235]
    v_exp_f32_e64 v2, v2 clamp
    v_exp_f32_e64 v3, v3 clamp
    v_mfma_f32_16x16x32_bf16 v[232:235], a[52:55], a[172:175], v[232:235]
    v_exp_f32_e64 v4, v4 clamp
    v_exp_f32_e64 v5, v5 clamp
    s_add_u32 s56, s61, 81920
    buffer_load_dwordx4 v[192:195], v26, s[24:27], s56 offen offset:0 sc1
    buffer_load_dwordx4 v[196:199], v26, s[24:27], s56 offen offset:1024 sc1
    v_mfma_f32_16x16x32_bf16 v[236:239], a[56:59], a[168:171], v[236:239]
    v_exp_f32_e64 v6, v6 clamp
    v_exp_f32_e64 v7, v7 clamp
    v_mfma_f32_16x16x32_bf16 v[236:239], a[60:63], a[172:175], v[236:239]
    v_exp_f32_e64 v8, v8 clamp
    v_exp_f32_e64 v9, v9 clamp
    s_waitcnt lgkmcnt(1)
    v_mfma_f32_16x16x32_bf16 v[232:235], a[0:3], a[104:107], v[232:235]
    v_max_f32 v184, v36, v184
    v_max_f32 v185, v36, v185
    s_waitcnt lgkmcnt(0)
    v_mfma_f32_16x16x32_bf16 v[232:235], a[4:7], a[108:111], v[232:235]
    v_max_f32 v186, v36, v186
    v_max_f32 v187, v36, v187
    v_max_f32 v188, v36, v188
    v_mfma_f32_16x16x32_bf16 v[236:239], a[8:11], a[104:107], v[236:239]
    v_max_f32 v189, v36, v189
    s_add_u32 s56, s61, 98304
    buffer_load_dwordx4 v[216:219], v26, s[24:27], s56 offen offset:0 sc1
    v_max_f32 v190, v36, v190
    v_max_f32 v191, v36, v191
    v_pk_add_f32 v[2:3], v[184:185], v[2:3]
    v_pk_add_f32 v[4:5], v[186:187], v[4:5]
    v_pk_add_f32 v[6:7], v[188:189], v[6:7]
    v_pk_add_f32 v[8:9], v[190:191], v[8:9]
    v_mfma_f32_16x16x32_bf16 v[236:239], a[12:15], a[108:111], v[236:239]
    v_cvt_pk_bf16_f32 v184, v2, v3
    v_cvt_pk_bf16_f32 v185, v4, v5
    v_cvt_pk_bf16_f32 v186, v6, v7
    v_cvt_pk_bf16_f32 v187, v8, v9
    buffer_load_dwordx4 v[220:223], v26, s[24:27], s56 offen offset:1024 sc1
    s_add_u32 s56, s61, 114688
    buffer_load_dwordx4 v[240:243], v26, s[24:27], s56 offen offset:0 sc1
    v_pk_fma_f32 v[2:3], v[208:209], s[66:67], v[20:21]
    v_pk_fma_f32 v[4:5], v[210:211], s[66:67], v[20:21]
    v_pk_fma_f32 v[6:7], v[212:213], s[66:67], v[20:21]
    v_pk_fma_f32 v[8:9], v[214:215], s[66:67], v[20:21]
    v_exp_f32_e64 v2, v2 clamp
    v_exp_f32_e64 v3, v3 clamp
    v_exp_f32_e64 v4, v4 clamp
    v_exp_f32_e64 v5, v5 clamp
    buffer_load_dwordx4 v[244:247], v26, s[24:27], s56 offen offset:1024 sc1
    v_exp_f32_e64 v6, v6 clamp
    v_exp_f32_e64 v7, v7 clamp
    v_exp_f32_e64 v8, v8 clamp
    v_exp_f32_e64 v9, v9 clamp
    v_max_f32 v208, v36, v208
    v_max_f32 v209, v36, v209
    v_max_f32 v210, v36, v210
    v_max_f32 v211, v36, v211
    v_max_f32 v212, v36, v212
    v_max_f32 v213, v36, v213
    buffer_load_dwordx4 v[48:51], v30, s[24:27], s61 offen offset:2048 sc1
    v_max_f32 v214, v36, v214
    v_max_f32 v215, v36, v215
    v_pk_add_f32 v[2:3], v[208:209], v[2:3]
    v_pk_add_f32 v[4:5], v[210:211], v[4:5]
    v_pk_add_f32 v[6:7], v[212:213], v[6:7]
    v_pk_add_f32 v[8:9], v[214:215], v[8:9]
    v_cvt_pk_bf16_f32 v208, v2, v3
    v_cvt_pk_bf16_f32 v209, v4, v5
    v_cvt_pk_bf16_f32 v210, v6, v7
    v_cvt_pk_bf16_f32 v211, v8, v9
    v_pk_fma_f32 v[2:3], v[232:233], s[66:67], v[20:21]
    v_pk_fma_f32 v[4:5], v[234:235], s[66:67], v[20:21]
    v_pk_fma_f32 v[6:7], v[236:237], s[66:67], v[20:21]
    v_pk_fma_f32 v[8:9], v[238:239], s[66:67], v[20:21]
    v_exp_f32_e64 v2, v2 clamp
    v_exp_f32_e64 v3, v3 clamp
    v_exp_f32_e64 v4, v4 clamp
    v_exp_f32_e64 v5, v5 clamp
    v_exp_f32_e64 v6, v6 clamp
    v_exp_f32_e64 v7, v7 clamp
    v_exp_f32_e64 v8, v8 clamp
    v_exp_f32_e64 v9, v9 clamp
    v_max_f32 v232, v36, v232
    v_max_f32 v233, v36, v233
    v_max_f32 v234, v36, v234
    v_max_f32 v235, v36, v235
    v_max_f32 v236, v36, v236
    v_max_f32 v237, v36, v237
    v_max_f32 v238, v36, v238
    v_max_f32 v239, v36, v239
    v_pk_add_f32 v[2:3], v[232:233], v[2:3]
    v_pk_add_f32 v[4:5], v[234:235], v[4:5]
    v_pk_add_f32 v[6:7], v[236:237], v[6:7]
    v_pk_add_f32 v[8:9], v[238:239], v[8:9]
    v_cvt_pk_bf16_f32 v232, v2, v3
    v_cvt_pk_bf16_f32 v233, v4, v5
    v_cvt_pk_bf16_f32 v234, v6, v7
    v_cvt_pk_bf16_f32 v235, v8, v9
    buffer_load_dwordx4 v[68:71], v26, s[16:19], s60 offen offset:0
    buffer_load_dwordx4 v[92:95], v26, s[16:19], s60 offen offset:1024
    buffer_load_dwordx4 v[116:119], v26, s[16:19], s60 offen offset:2048
    buffer_load_dwordx4 v[140:143], v26, s[16:19], s60 offen offset:3072
    buffer_load_dwordx4 v[164:167], v26, s[32:35], 0 offen offset:0
    buffer_load_dwordx4 v[188:191], v26, s[32:35], 0 offen offset:1024
    s_waitcnt vmcnt(6)
K_SUM:
    v_pk_add_f32 v[40:41], v[72:73], v[96:97]
    v_pk_add_f32 v[42:43], v[74:75], v[98:99]
    v_pk_add_f32 v[44:45], v[76:77], v[100:101]
    v_pk_add_f32 v[46:47], v[78:79], v[102:103]
    v_add_f32_dpp v52, v48, v48 quad_perm:[1,0,3,2] row_mask:0xf bank_mask:0xf
    v_add_f32_dpp v53, v49, v49 quad_perm:[1,0,3,2] row_mask:0xf bank_mask:0xf
    v_add_f32_dpp v54, v50, v50 quad_perm:[1,0,3,2] row_mask:0xf bank_mask:0xf
    v_add_f32_dpp v55, v51, v51 quad_perm:[1,0,3,2] row_mask:0xf bank_mask:0xf
    v_pk_add_f32 v[40:41], v[40:41], v[120:121]
    v_pk_add_f32 v[42:43], v[42:43], v[122:123]
    v_pk_add_f32 v[44:45], v[44:45], v[124:125]
    v_pk_add_f32 v[46:47], v[46:47], v[126:127]
    v_add_f32_dpp v52, v52, v52 quad_perm:[2,3,0,1] row_mask:0xf bank_mask:0xf
    v_add_f32_dpp v53, v53, v53 quad_perm:[2,3,0,1] row_mask:0xf bank_mask:0xf
    v_add_f32_dpp v54, v54, v54 quad_perm:[2,3,0,1] row_mask:0xf bank_mask:0xf
    v_add_f32_dpp v55, v55, v55 quad_perm:[2,3,0,1] row_mask:0xf bank_mask:0xf
    v_pk_add_f32 v[40:41], v[40:41], v[144:145]
    v_pk_add_f32 v[42:43], v[42:43], v[146:147]
    v_pk_add_f32 v[44:45], v[44:45], v[148:149]
    v_pk_add_f32 v[46:47], v[46:47], v[150:151]
    v_add_f32_dpp v52, v52, v52 row_half_mirror row_mask:0xf bank_mask:0xf
    v_add_f32_dpp v53, v53, v53 row_half_mirror row_mask:0xf bank_mask:0xf
    v_add_f32_dpp v54, v54, v54 row_half_mirror row_mask:0xf bank_mask:0xf
    v_add_f32_dpp v55, v55, v55 row_half_mirror row_mask:0xf bank_mask:0xf
    v_pk_add_f32 v[40:41], v[40:41], v[168:169]
    v_pk_add_f32 v[42:43], v[42:43], v[170:171]
    v_pk_add_f32 v[44:45], v[44:45], v[172:173]
    v_pk_add_f32 v[46:47], v[46:47], v[174:175]
    v_pk_add_f32 v[40:41], v[40:41], v[192:193]
    v_pk_add_f32 v[42:43], v[42:43], v[194:195]
    v_pk_add_f32 v[44:45], v[44:45], v[196:197]
    v_pk_add_f32 v[46:47], v[46:47], v[198:199]
    v_pk_add_f32 v[40:41], v[40:41], v[216:217]
    v_pk_add_f32 v[42:43], v[42:43], v[218:219]
    v_pk_add_f32 v[44:45], v[44:45], v[220:221]
    v_pk_add_f32 v[46:47], v[46:47], v[222:223]
    v_pk_add_f32 v[40:41], v[40:41], v[240:241]
    v_pk_add_f32 v[42:43], v[42:43], v[242:243]
    v_pk_add_f32 v[44:45], v[44:45], v[244:245]
    v_pk_add_f32 v[46:47], v[46:47], v[246:247]
    v_pk_add_f32 v[2:3], v[40:41], v[42:43]
    v_pk_add_f32 v[4:5], v[44:45], v[46:47]
    v_pk_add_f32 v[6:7], v[52:53], v[54:55]
    v_pk_add_f32 v[2:3], v[2:3], v[4:5]
    v_pk_add_f32 v[2:3], v[2:3], v[6:7]
    v_cmp_u_f32 vcc, v2, v3
    s_nop 4
    s_cbranch_vccz K_GOK
    v_max3_u32 v2, v72, v73, v74
    v_max3_u32 v2, v2, v75, v76
    v_max3_u32 v2, v2, v77, v78
    v_max3_u32 v2, v2, v79, v96
    v_max3_u32 v2, v2, v97, v98
    v_max3_u32 v2, v2, v99, v100
    v_max3_u32 v2, v2, v101, v102
    v_max3_u32 v2, v2, v103, v120
    v_max3_u32 v2, v2, v121, v122
    v_max3_u32 v2, v2, v123, v124
    v_max3_u32 v2, v2, v125, v126
    v_max3_u32 v2, v2, v127, v144
    v_max3_u32 v2, v2, v145, v146
    v_max3_u32 v2, v2, v147, v148
    v_max3_u32 v2, v2, v149, v150
    v_max3_u32 v2, v2, v151, v168
    v_max3_u32 v2, v2, v169, v170
    v_max3_u32 v2, v2, v171, v172
    v_max3_u32 v2, v2, v173, v174
    v_max3_u32 v2, v2, v175, v192
    v_max3_u32 v2, v2, v193, v194
    v_max3_u32 v2, v2, v195, v196
    v_max3_u32 v2, v2, v197, v198
    v_max3_u32 v2, v2, v199, v216
    v_max3_u32 v2, v2, v217, v218
    v_max3_u32 v2, v2, v219, v220
    v_max3_u32 v2, v2, v221, v222
    v_max3_u32 v2, v2, v223, v240
    v_max3_u32 v2, v2, v241, v242
    v_max3_u32 v2, v2, v243, v244
    v_max3_u32 v2, v2, v245, v246
    v_max3_u32 v2, v2, v247, v48
    v_max3_u32 v2, v2, v49, v50
    v_max_u32 v2, v2, v51
    v_cmp_eq_u32 vcc, -1, v2
    s_nop 4
    s_cbranch_vccz K_GOK
    s_add_u32 s56, s61, 0
    buffer_load_dwordx4 v[72:75], v26, s[24:27], s56 offen offset:0 sc1
    buffer_load_dwordx4 v[76:79], v26, s[24:27], s56 offen offset:1024 sc1
    s_add_u32 s56, s61, 16384
    buffer_load_dwordx4 v[96:99], v26, s[24:27], s56 offen offset:0 sc1
    buffer_load_dwordx4 v[100:103], v26, s[24:27], s56 offen offset:1024 sc1
    s_add_u32 s56, s61, 32768
    buffer_load_dwordx4 v[120:123], v26, s[24:27], s56 offen offset:0 sc1
    buffer_load_dwordx4 v[124:127], v26, s[24:27], s56 offen offset:1024 sc1
    s_add_u32 s56, s61, 49152
    buffer_load_dwordx4 v[144:147], v26, s[24:27], s56 offen offset:0 sc1
    buffer_load_dwordx4 v[148:151], v26, s[24:27], s56 offen offset:1024 sc1
    s_add_u32 s56, s61, 65536
    buffer_load_dwordx4 v[168:171], v26, s[24:27], s56 offen offset:0 sc1
    buffer_load_dwordx4 v[172:175], v26, s[24:27], s56 offen offset:1024 sc1
    s_add_u32 s56, s61, 81920
    buffer_load_dwordx4 v[192:195], v26, s[24:27], s56 offen offset:0 sc1
    buffer_load_dwordx4 v[196:199], v26, s[24:27], s56 offen offset:1024 sc1
    s_add_u32 s56, s61, 98304
    buffer_load_dwordx4 v[216:219], v26, s[24:27], s56 offen offset:0 sc1
    buffer_load_dwordx4 v[220:223], v26, s[24:27], s56 offen offset:1024 sc1
    s_add_u32 s56, s61, 114688
    buffer_load_dwordx4 v[240:243], v26, s[24:27], s56 offen offset:0 sc1
    buffer_load_dwordx4 v[244:247], v26, s[24:27], s56 offen offset:1024 sc1
    buffer_load_dwordx4 v[48:51], v30, s[24:27], s61 offen offset:2048 sc1
    s_waitcnt vmcnt(0)
    s_branch K_SUM
K_GOK:
    v_cvt_pk_bf16_f32 v2, v52, v53
    v_cvt_pk_bf16_f32 v3, v54, v55
    ds_write_b64 v10, v[2:3] offset:1024
    v_cvt_pk_bf16_f32 v56, v40, v41
    v_cvt_pk_bf16_f32 v57, v42, v43
    v_cvt_pk_bf16_f32 v60, v44, v45
    v_cvt_pk_bf16_f32 v61, v46, v47
    ds_write_b64 v10, v[56:57]
    ds_write_b64 v10, v[60:61] offset:512
    s_waitcnt lgkmcnt(0)
    s_barrier
    ds_read_b64 v[4:5], v11 offset:1024
    ds_read_b64 v[58:59], v11
    ds_read_b64 v[62:63], v11 offset:512
    s_waitcnt lgkmcnt(2)
    v_mfma_f32_16x16x32_bf16 v[80:83], v[2:5], v[64:67], 0
    s_add_u32 m0, s48, 0
    s_nop 0
    buffer_load_dwordx4 v12, s[80:83], s52 offen lds
    v_mfma_f32_16x16x32_bf16 v[104:107], v[2:5], v[88:91], 0
    v_mfma_f32_16x16x32_bf16 v[128:131], v[2:5], v[112:115], 0
    buffer_load_dwordx4 v13, s[80:83], s52 offen offset:1024 lds
    v_mfma_f32_16x16x32_bf16 v[152:155], v[2:5], v[136:139], 0
    v_mfma_f32_16x16x32_bf16 v[176:179], v[2:5], v[160:163], 0
    buffer_load_dwordx4 v14, s[80:83], s52 offen offset:2048 lds
    v_mfma_f32_16x16x32_bf16 v[200:203], v[2:5], v[184:187], 0
    v_mfma_f32_16x16x32_bf16 v[224:227], v[2:5], v[208:211], 0
    buffer_load_dwordx4 v15, s[80:83], s52 offen offset:3072 lds
    s_add_u32 s52, s52, 65536
    v_mfma_f32_16x16x32_bf16 v[248:251], v[2:5], v[232:235], 0
    s_waitcnt lgkmcnt(0)
    v_mfma_f32_16x16x32_bf16 v[72:75], v[56:59], v[64:67], 0
    v_mfma_f32_16x16x32_bf16 v[76:79], v[60:63], v[64:67], 0
    v_add_f32 v80, v36, v80
    v_rcp_f32 v80, v80
    s_add_u32 m0, s48, 4096
    s_nop 0
    buffer_load_dwordx4 v12, s[80:83], s52 offen lds
    v_mfma_f32_16x16x32_bf16 v[96:99], v[56:59], v[88:91], 0
    v_mfma_f32_16x16x32_bf16 v[100:103], v[60:63], v[88:91], 0
    v_add_f32 v104, v36, v104
    v_rcp_f32 v104, v104
    v_mfma_f32_16x16x32_bf16 v[120:123], v[56:59], v[112:115], 0
    v_mfma_f32_16x16x32_bf16 v[124:127], v[60:63], v[112:115], 0
    v_add_f32 v128, v36, v128
    v_rcp_f32 v128, v128
    buffer_load_dwordx4 v13, s[80:83], s52 offen offset:1024 lds
    v_mfma_f32_16x16x32_bf16 v[144:147], v[56:59], v[136:139], 0
    v_mfma_f32_16x16x32_bf16 v[148:151], v[60:63], v[136:139], 0
    v_add_f32 v152, v36, v152
    v_rcp_f32 v152, v152
    v_mfma_f32_16x16x32_bf16 v[168:171], v[56:59], v[160:163], 0
    v_mfma_f32_16x16x32_bf16 v[172:175], v[60:63], v[160:163], 0
    v_add_f32 v176, v36, v176
    v_rcp_f32 v176, v176
    buffer_load_dwordx4 v14, s[80:83], s52 offen offset:2048 lds
    v_mfma_f32_16x16x32_bf16 v[192:195], v[56:59], v[184:187], 0
    v_mfma_f32_16x16x32_bf16 v[196:199], v[60:63], v[184:187], 0
    v_add_f32 v200, v36, v200
    v_rcp_f32 v200, v200
    v_mfma_f32_16x16x32_bf16 v[216:219], v[56:59], v[208:211], 0
    v_mfma_f32_16x16x32_bf16 v[220:223], v[60:63], v[208:211], 0
    v_add_f32 v224, v36, v224
    v_rcp_f32 v224, v224
    buffer_load_dwordx4 v15, s[80:83], s52 offen offset:3072 lds
    s_add_u32 s52, s52, 65536
    v_mfma_f32_16x16x32_bf16 v[240:243], v[56:59], v[232:235], 0
    v_mfma_f32_16x16x32_bf16 v[244:247], v[60:63], v[232:235], 0
    v_add_f32 v248, v36, v248
    v_rcp_f32 v248, v248
    s_add_u32 s63, s65, 4096
    v_pk_mul_f32 v[72:73], v[72:73], v[80:81] op_sel_hi:[1,0]
    v_pk_mul_f32 v[74:75], v[74:75], v[80:81] op_sel_hi:[1,0]
    v_pk_mul_f32 v[76:77], v[76:77], v[80:81] op_sel_hi:[1,0]
    v_pk_mul_f32 v[78:79], v[78:79], v[80:81] op_sel_hi:[1,0]
    v_cvt_pk_bf16_f32 v84, v72, v73
    v_cvt_pk_bf16_f32 v85, v74, v75
    v_cvt_pk_bf16_f32 v86, v76, v77
    v_cvt_pk_bf16_f32 v87, v78, v79
    buffer_store_dwordx4 v[84:87], v26, s[24:27], s65 offen offset:0 sc1
    v_pk_mul_f32 v[96:97], v[96:97], v[104:105] op_sel_hi:[1,0]
    v_pk_mul_f32 v[98:99], v[98:99], v[104:105] op_sel_hi:[1,0]
    v_pk_mul_f32 v[100:101], v[100:101], v[104:105] op_sel_hi:[1,0]
    v_pk_mul_f32 v[102:103], v[102:103], v[104:105] op_sel_hi:[1,0]
    v_cvt_pk_bf16_f32 v108, v96, v97
    v_cvt_pk_bf16_f32 v109, v98, v99
    v_cvt_pk_bf16_f32 v110, v100, v101
    v_cvt_pk_bf16_f32 v111, v102, v103
    buffer_store_dwordx4 v[108:111], v26, s[24:27], s65 offen offset:1024 sc1
    v_pk_mul_f32 v[120:121], v[120:121], v[128:129] op_sel_hi:[1,0]
    v_pk_mul_f32 v[122:123], v[122:123], v[128:129] op_sel_hi:[1,0]
    v_pk_mul_f32 v[124:125], v[124:125], v[128:129] op_sel_hi:[1,0]
    v_pk_mul_f32 v[126:127], v[126:127], v[128:129] op_sel_hi:[1,0]
    v_cvt_pk_bf16_f32 v132, v120, v121
    v_cvt_pk_bf16_f32 v133, v122, v123
    v_cvt_pk_bf16_f32 v134, v124, v125
    v_cvt_pk_bf16_f32 v135, v126, v127
    buffer_store_dwordx4 v[132:135], v26, s[24:27], s65 offen offset:2048 sc1
    v_pk_mul_f32 v[144:145], v[144:145], v[152:153] op_sel_hi:[1,0]
    v_pk_mul_f32 v[146:147], v[146:147], v[152:153] op_sel_hi:[1,0]
    v_pk_mul_f32 v[148:149], v[148:149], v[152:153] op_sel_hi:[1,0]
    v_pk_mul_f32 v[150:151], v[150:151], v[152:153] op_sel_hi:[1,0]
    v_cvt_pk_bf16_f32 v156, v144, v145
    v_cvt_pk_bf16_f32 v157, v146, v147
    v_cvt_pk_bf16_f32 v158, v148, v149
    v_cvt_pk_bf16_f32 v159, v150, v151
    buffer_store_dwordx4 v[156:159], v26, s[24:27], s65 offen offset:3072 sc1
    v_pk_mul_f32 v[168:169], v[168:169], v[176:177] op_sel_hi:[1,0]
    v_pk_mul_f32 v[170:171], v[170:171], v[176:177] op_sel_hi:[1,0]
    v_pk_mul_f32 v[172:173], v[172:173], v[176:177] op_sel_hi:[1,0]
    v_pk_mul_f32 v[174:175], v[174:175], v[176:177] op_sel_hi:[1,0]
    v_cvt_pk_bf16_f32 v180, v168, v169
    v_cvt_pk_bf16_f32 v181, v170, v171
    v_cvt_pk_bf16_f32 v182, v172, v173
    v_cvt_pk_bf16_f32 v183, v174, v175
    buffer_store_dwordx4 v[180:183], v26, s[24:27], s63 offen offset:0 sc1
    v_pk_mul_f32 v[192:193], v[192:193], v[200:201] op_sel_hi:[1,0]
    v_pk_mul_f32 v[194:195], v[194:195], v[200:201] op_sel_hi:[1,0]
    v_pk_mul_f32 v[196:197], v[196:197], v[200:201] op_sel_hi:[1,0]
    v_pk_mul_f32 v[198:199], v[198:199], v[200:201] op_sel_hi:[1,0]
    v_cvt_pk_bf16_f32 v204, v192, v193
    v_cvt_pk_bf16_f32 v205, v194, v195
    v_cvt_pk_bf16_f32 v206, v196, v197
    v_cvt_pk_bf16_f32 v207, v198, v199
    buffer_store_dwordx4 v[204:207], v26, s[24:27], s63 offen offset:1024 sc1
    v_pk_mul_f32 v[216:217], v[216:217], v[224:225] op_sel_hi:[1,0]
    v_pk_mul_f32 v[218:219], v[218:219], v[224:225] op_sel_hi:[1,0]
    v_pk_mul_f32 v[220:221], v[220:221], v[224:225] op_sel_hi:[1,0]
    v_pk_mul_f32 v[222:223], v[222:223], v[224:225] op_sel_hi:[1,0]
    v_cvt_pk_bf16_f32 v228, v216, v217
    v_cvt_pk_bf16_f32 v229, v218, v219
    v_cvt_pk_bf16_f32 v230, v220, v221
    v_cvt_pk_bf16_f32 v231, v222, v223
    buffer_store_dwordx4 v[228:231], v26, s[24:27], s63 offen offset:2048 sc1
    v_pk_mul_f32 v[240:241], v[240:241], v[248:249] op_sel_hi:[1,0]
    v_pk_mul_f32 v[242:243], v[242:243], v[248:249] op_sel_hi:[1,0]
    v_pk_mul_f32 v[244:245], v[244:245], v[248:249] op_sel_hi:[1,0]
    v_pk_mul_f32 v[246:247], v[246:247], v[248:249] op_sel_hi:[1,0]
    v_cvt_pk_bf16_f32 v252, v240, v241
    v_cvt_pk_bf16_f32 v253, v242, v243
    v_cvt_pk_bf16_f32 v254, v244, v245
    v_cvt_pk_bf16_f32 v255, v246, v247
    buffer_store_dwordx4 v[252:255], v26, s[24:27], s63 offen offset:3072 sc1
    s_add_u32 s56, s38, 1
    s_and_b32 s56, s56, 3
    s_lshl_b32 s56, s56, 11
    v_add_u32 v2, s56, v26
    s_add_u32 s56, s38, 2
    s_and_b32 s56, s56, 3
    s_lshl_b32 s56, s56, 11
    v_add_u32 v3, s56, v26
    s_add_u32 s56, s38, 3
    s_and_b32 s56, s56, 3
    s_lshl_b32 s56, s56, 11
    v_add_u32 v4, s56, v26
    s_add_u32 s56, s38, 4
    s_and_b32 s56, s56, 3
    s_lshl_b32 s56, s56, 11
    v_add_u32 v5, s56, v26
    v_bfe_u32 v6, v1, 1, 4
    v_lshlrev_b32 v6, 3, v6
    v_and_b32 v7, 1, v1
    v_lshl_add_u32 v6, v7, 2, v6
    s_waitcnt vmcnt(16)
    v_mov_b32 v38, 0
    v_mov_b32 v39, 0
    v_dot2_f32_bf16 v38, v68, v164, v38
    v_dot2_f32_bf16 v39, v116, v164, v39
    v_dot2_f32_bf16 v38, v69, v165, v38
    v_dot2_f32_bf16 v39, v117, v165, v39
    v_dot2_f32_bf16 v38, v70, v166, v38
    v_dot2_f32_bf16 v39, v118, v166, v39
    v_dot2_f32_bf16 v38, v71, v167, v38
    v_dot2_f32_bf16 v39, v119, v167, v39
    v_dot2_f32_bf16 v38, v92, v188, v38
    v_dot2_f32_bf16 v39, v140, v188, v39
    v_dot2_f32_bf16 v38, v93, v189, v38
    v_dot2_f32_bf16 v39, v141, v189, v39
    v_dot2_f32_bf16 v38, v94, v190, v38
    v_dot2_f32_bf16 v39, v142, v190, v39
    v_dot2_f32_bf16 v38, v95, v191, v38
    v_dot2_f32_bf16 v39, v143, v191, v39
    s_nop 1
    v_add_f32_dpp v38, v38, v38 quad_perm:[1,0,3,2] row_mask:0xf bank_mask:0xf
    v_add_f32_dpp v39, v39, v39 quad_perm:[1,0,3,2] row_mask:0xf bank_mask:0xf
    s_nop 0
    v_add_f32_dpp v38, v38, v38 quad_perm:[2,3,0,1] row_mask:0xf bank_mask:0xf
    v_add_f32_dpp v39, v39, v39 quad_perm:[2,3,0,1] row_mask:0xf bank_mask:0xf
    s_nop 0
    v_add_f32_dpp v38, v38, v38 row_half_mirror row_mask:0xf bank_mask:0xf
    v_add_f32_dpp v39, v39, v39 row_half_mirror row_mask:0xf bank_mask:0xf
    s_nop 0
    v_add_f32_dpp v38, v38, v38 row_mirror row_mask:0xf bank_mask:0xf
    v_add_f32_dpp v39, v39, v39 row_mirror row_mask:0xf bank_mask:0xf
    v_readlane_b32 s4, v38, 0
    v_readlane_b32 s5, v38, 16
    v_readlane_b32 s6, v38, 32
    v_readlane_b32 s7, v38, 48
    v_readlane_b32 s8, v39, 0
    v_readlane_b32 s9, v39, 16
    v_readlane_b32 s10, v39, 32
    v_readlane_b32 s11, v39, 48
    v_mov_b32 v38, s4
    v_add_f32 v38, s5, v38
    v_add_f32 v38, s6, v38
    v_add_f32 v38, s7, v38
    v_mov_b32 v39, s8
    v_add_f32 v39, s9, v39
    v_add_f32 v39, s10, v39
    v_add_f32 v39, s11, v39
    v_cvt_pk_bf16_f32 v38, v38, v38
    v_cvt_pk_bf16_f32 v39, v39, v39
    v_and_b32 v38, 0xffff0000, v38
    v_and_b32 v39, 0xffff0000, v39
    v_mul_f32 v38, 0xbfb8aa3b, v38
    v_mul_f32 v39, 0xbfb8aa3b, v39
    v_exp_f32 v38, v38
    v_exp_f32 v39, v39
    v_add_f32 v38, 1.0, v38
    v_add_f32 v39, 1.0, v39
    v_rcp_f32 v38, v38
    v_rcp_f32 v39, v39
    v_cvt_pk_bf16_f32 v38, v38, v38
    v_cvt_pk_bf16_f32 v39, v39, v39
    v_and_b32 v38, 0xffff0000, v38
    v_and_b32 v39, 0xffff0000, v39
    s_mov_b32 s16, s70
    s_and_b32 s17, s71, 0xffff
    s_mov_b32 s18, 4194304
    s_mov_b32 s19, 0x00020000
    v_add_u32 v7, s48, v26
    v_add_u32 v8, 0x10000, v7
    s_xor_b32 s56, s38, 1
    s_sub_u32 s57, s38, s56
    s_sub_u32 s57, s57, 1
    s_and_b32 s57, s57, 3
    s_lshl_b32 s57, s57, 15
    s_lshl_b32 s56, s56, 13
    s_add_u32 s56, s56, s57
    v_add_u32 v9, s56, v26
    s_xor_b32 s56, s38, 2
    s_sub_u32 s57, s38, s56
    s_sub_u32 s57, s57, 1
    s_and_b32 s57, s57, 3
    s_lshl_b32 s57, s57, 15
    s_lshl_b32 s56, s56, 13
    s_add_u32 s56, s56, s57
    v_add_u32 v10, s56, v26
    s_xor_b32 s56, s38, 3
    s_sub_u32 s57, s38, s56
    s_sub_u32 s57, s57, 1
    s_and_b32 s57, s57, 3
    s_lshl_b32 s57, s57, 15
    s_lshl_b32 s56, s56, 13
    s_add_u32 s56, s56, s57
    v_add_u32 v11, s56, v26
    v_and_b32 v24, 15, v1
    v_lshrrev_b32 v25, 4, v1
    v_and_b32 v28, 1, v25
    v_lshlrev_b32 v28, 5, v28
    v_lshrrev_b32 v25, 1, v25
    v_lshl_add_u32 v28, v25, 4, v28
    v_and_b32 v24, 7, v1
    v_bfe_u32 v25, v1, 3, 1
    v_lshl_add_u32 v28, v25, 6, v28
    v_lshl_add_u32 v14, v24, 11, v28
    v_add_u32 v15, 0x4000, v14
    s_lshl_b32 s56, s50, 18
    s_lshl_b32 s57, s38, 16
    s_add_u32 s56, s56, s57
    s_lshl_b32 s57, s51, 7
    s_add_u32 s61, s56, s57
    s_add_u32 s62, s61, 32768
    s_mov_b32 s60, 0
    s_getpc_b64 s[66:67]
K_PC:
    s_add_u32 s66, s66, K_WAIT-K_PC
    s_addc_u32 s67, s67, 0
    v_subrev_u32 v16, 0x10000, v32
    v_subrev_u32 v17, 0x10000, v33
    v_subrev_u32 v18, 0x10000, v34
    v_subrev_u32 v19, 0x10000, v35
    ds_read_b64_tr_b16 v[64:65], v32 offset:36864
    ds_read_b64_tr_b16 v[66:67], v32 offset:38912
    ds_read_b64_tr_b16 v[68:69], v33 offset:36864
    ds_read_b64_tr_b16 v[70:71], v33 offset:38912
    ds_read_b64_tr_b16 v[72:73], v34 offset:36864
    ds_read_b64_tr_b16 v[74:75], v34 offset:38912
    ds_read_b64_tr_b16 v[76:77], v35 offset:36864
    ds_read_b64_tr_b16 v[78:79], v35 offset:38912
    s_waitcnt vmcnt(0)
    s_mov_b64 exec, 1
    buffer_store_dwordx2 v[38:39], v29, s[24:27], s55 offen sc1
    s_mov_b64 exec, -1
    s_waitcnt vmcnt(0)
    s_bitcmp1_b32 s60, 16
    s_cbranch_scc1 K_RDY0
    s_mov_b32 s59, 16
    s_swappc_b64 s[68:69], s[66:67]
K_RDY0:
    s_add_u32 s43, s53, 65536
    buffer_load_dwordx4 a[0:3], v2, s[24:27], s43 offen sc1
    buffer_load_dwordx4 a[4:7], v2, s[24:27], s43 offen offset:1024 sc1
    buffer_load_dwordx4 a[8:11], v3, s[24:27], s43 offen sc1
    buffer_load_dwordx4 a[12:15], v3, s[24:27], s43 offen offset:1024 sc1
    buffer_load_dwordx4 a[48:51], v4, s[24:27], s43 offen sc1
    buffer_load_dwordx4 a[52:55], v4, s[24:27], s43 offen offset:1024 sc1
    buffer_load_dwordx4 a[56:59], v5, s[24:27], s43 offen sc1
    buffer_load_dwordx4 a[60:63], v5, s[24:27], s43 offen offset:1024 sc1
    s_bitcmp1_b32 s60, 18
    s_cbranch_scc1 K_RDY1
    s_mov_b32 s59, 18
    s_swappc_b64 s[68:69], s[66:67]
K_RDY1:
    s_add_u32 s43, s53, 73728
    buffer_load_dwordx4 a[80:83], v2, s[24:27], s43 offen sc1
    buffer_load_dwordx4 a[84:87], v2, s[24:27], s43 offen offset:1024 sc1
    buffer_load_dwordx4 a[88:91], v3, s[24:27], s43 offen sc1
    buffer_load_dwordx4 a[92:95], v3, s[24:27], s43 offen offset:1024 sc1
    buffer_load_dwordx4 a[96:99], v4, s[24:27], s43 offen sc1
    buffer_load_dwordx4 a[100:103], v4, s[24:27], s43 offen offset:1024 sc1
    buffer_load_dwordx4 a[104:107], v5, s[24:27], s43 offen sc1
    buffer_load_dwordx4 a[108:111], v5, s[24:27], s43 offen offset:1024 sc1
    s_waitcnt vmcnt(15)
    s_waitcnt lgkmcnt(6)
    v_mfma_f32_16x16x32_bf16 v[128:131], v[64:67], a[0:3], 0
    s_waitcnt lgkmcnt(4)
    v_mfma_f32_16x16x32_bf16 v[132:135], v[68:71], a[0:3], 0
    s_waitcnt lgkmcnt(2)
    v_mfma_f32_16x16x32_bf16 v[136:139], v[72:75], a[0:3], 0
    s_bitcmp1_b32 s60, 20
    s_cbranch_scc1 K_RDY2
    s_mov_b32 s59, 20
    s_swappc_b64 s[68:69], s[66:67]
K_RDY2:
    s_waitcnt lgkmcnt(0)
    v_mfma_f32_16x16x32_bf16 v[140:143], v[76:79], a[0:3], 0
    s_add_u32 s43, s53, 81920
    buffer_load_dwordx4 a[112:115], v2, s[24:27], s43 offen sc1
    s_waitcnt vmcnt(15)
    v_mfma_f32_16x16x32_bf16 v[144:147], v[64:67], a[4:7], 0
    ds_read_b64_tr_b16 v[80:81], v32 offset:0
    v_mfma_f32_16x16x32_bf16 v[148:151], v[68:71], a[4:7], 0
    buffer_load_dwordx4 a[116:119], v2, s[24:27], s43 offen offset:1024 sc1
    v_mfma_f32_16x16x32_bf16 v[152:155], v[72:75], a[4:7], 0
    ds_read_b64_tr_b16 v[82:83], v32 offset:2048
    buffer_load_dwordx4 a[120:123], v3, s[24:27], s43 offen sc1
    v_mfma_f32_16x16x32_bf16 v[156:159], v[76:79], a[4:7], 0
    s_waitcnt vmcnt(16)
    v_mfma_f32_16x16x32_bf16 v[160:163], v[64:67], a[8:11], 0
    ds_read_b64_tr_b16 v[84:85], v33 offset:0
    buffer_load_dwordx4 a[124:127], v3, s[24:27], s43 offen offset:1024 sc1
    v_mfma_f32_16x16x32_bf16 v[164:167], v[68:71], a[8:11], 0
    buffer_load_dwordx4 a[128:131], v4, s[24:27], s43 offen sc1
    v_mfma_f32_16x16x32_bf16 v[168:171], v[72:75], a[8:11], 0
    ds_read_b64_tr_b16 v[86:87], v33 offset:2048
    v_mfma_f32_16x16x32_bf16 v[172:175], v[76:79], a[8:11], 0
    buffer_load_dwordx4 a[132:135], v4, s[24:27], s43 offen offset:1024 sc1
    s_waitcnt vmcnt(18)
    v_mfma_f32_16x16x32_bf16 v[176:179], v[64:67], a[12:15], 0
    ds_read_b64_tr_b16 v[88:89], v34 offset:0
    buffer_load_dwordx4 a[136:139], v5, s[24:27], s43 offen sc1
    v_mfma_f32_16x16x32_bf16 v[180:183], v[68:71], a[12:15], 0
    v_mfma_f32_16x16x32_bf16 v[184:187], v[72:75], a[12:15], 0
    ds_read_b64_tr_b16 v[90:91], v34 offset:2048
    buffer_load_dwordx4 a[140:143], v5, s[24:27], s43 offen offset:1024 sc1
    v_mfma_f32_16x16x32_bf16 v[188:191], v[76:79], a[12:15], 0
    s_waitcnt vmcnt(19)
    v_mfma_f32_16x16x32_bf16 v[192:195], v[64:67], a[48:51], 0
    ds_read_b64_tr_b16 v[92:93], v35 offset:0
    s_bitcmp1_b32 s60, 22
    s_cbranch_scc1 K_RDY3
    s_mov_b32 s59, 22
    s_swappc_b64 s[68:69], s[66:67]
K_RDY3:
    buffer_load_dword v43, v6, s[24:27], s54 offen sc1
    v_mfma_f32_16x16x32_bf16 v[196:199], v[68:71], a[48:51], 0
    s_add_u32 s43, s53, 90112
    buffer_load_dwordx4 a[144:147], v2, s[24:27], s43 offen sc1
    v_mfma_f32_16x16x32_bf16 v[200:203], v[72:75], a[48:51], 0
    ds_read_b64_tr_b16 v[94:95], v35 offset:2048
    v_mfma_f32_16x16x32_bf16 v[204:207], v[76:79], a[48:51], 0
    buffer_load_dwordx4 a[148:151], v2, s[24:27], s43 offen offset:1024 sc1
    s_waitcnt vmcnt(21)
    v_mfma_f32_16x16x32_bf16 v[208:211], v[64:67], a[52:55], 0
    v_mfma_f32_16x16x32_bf16 v[212:215], v[68:71], a[52:55], 0
    buffer_load_dwordx4 a[152:155], v3, s[24:27], s43 offen sc1
    v_mfma_f32_16x16x32_bf16 v[216:219], v[72:75], a[52:55], 0
    buffer_load_dwordx4 a[156:159], v3, s[24:27], s43 offen offset:1024 sc1
    v_mfma_f32_16x16x32_bf16 v[220:223], v[76:79], a[52:55], 0
    s_waitcnt vmcnt(22)
    v_mfma_f32_16x16x32_bf16 v[224:227], v[64:67], a[56:59], 0
    buffer_load_dwordx4 a[160:163], v4, s[24:27], s43 offen sc1
    v_mfma_f32_16x16x32_bf16 v[228:231], v[68:71], a[56:59], 0
    v_mfma_f32_16x16x32_bf16 v[232:235], v[72:75], a[56:59], 0
    buffer_load_dwordx4 a[164:167], v4, s[24:27], s43 offen offset:1024 sc1
    v_mfma_f32_16x16x32_bf16 v[236:239], v[76:79], a[56:59], 0
    buffer_load_dwordx4 a[168:171], v5, s[24:27], s43 offen sc1
    s_waitcnt vmcnt(24)
    v_mfma_f32_16x16x32_bf16 v[240:243], v[64:67], a[60:63], 0
    v_mfma_f32_16x16x32_bf16 v[244:247], v[68:71], a[60:63], 0
    buffer_load_dwordx4 a[172:175], v5, s[24:27], s43 offen offset:1024 sc1
    v_mfma_f32_16x16x32_bf16 v[248:251], v[72:75], a[60:63], 0
    v_mfma_f32_16x16x32_bf16 v[252:255], v[76:79], a[60:63], 0
    s_waitcnt vmcnt(24)
    s_waitcnt lgkmcnt(6)
    v_mfma_f32_16x16x32_bf16 v[128:131], v[80:83], a[80:83], v[128:131]
    s_waitcnt lgkmcnt(4)
    v_mfma_f32_16x16x32_bf16 v[132:135], v[84:87], a[80:83], v[132:135]
    s_waitcnt lgkmcnt(2)
    v_mfma_f32_16x16x32_bf16 v[136:139], v[88:91], a[80:83], v[136:139]
    s_bitcmp1_b32 s60, 24
    s_cbranch_scc1 K_RDY4
    s_mov_b32 s59, 24
    s_swappc_b64 s[68:69], s[66:67]
K_RDY4:
    s_waitcnt lgkmcnt(0)
    v_mfma_f32_16x16x32_bf16 v[140:143], v[92:95], a[80:83], v[140:143]
    s_waitcnt vmcnt(23)
    v_mfma_f32_16x16x32_bf16 v[144:147], v[80:83], a[84:87], v[144:147]
    ds_read_b64_tr_b16 v[64:65], v32 offset:4096
    s_add_u32 s43, s53, 98304
    buffer_load_dwordx4 a[0:3], v2, s[24:27], s43 offen sc1
    v_mfma_f32_16x16x32_bf16 v[148:151], v[84:87], a[84:87], v[148:151]
    v_mfma_f32_16x16x32_bf16 v[152:155], v[88:91], a[84:87], v[152:155]
    ds_read_b64_tr_b16 v[66:67], v32 offset:6144
    buffer_load_dwordx4 a[4:7], v2, s[24:27], s43 offen offset:1024 sc1
    v_mfma_f32_16x16x32_bf16 v[156:159], v[92:95], a[84:87], v[156:159]
    s_waitcnt vmcnt(24)
    v_mfma_f32_16x16x32_bf16 v[160:163], v[80:83], a[88:91], v[160:163]
    ds_read_b64_tr_b16 v[68:69], v33 offset:4096
    buffer_load_dwordx4 a[8:11], v3, s[24:27], s43 offen sc1
    v_mfma_f32_16x16x32_bf16 v[164:167], v[84:87], a[88:91], v[164:167]
    v_mfma_f32_16x16x32_bf16 v[168:171], v[88:91], a[88:91], v[168:171]
    ds_read_b64_tr_b16 v[70:71], v33 offset:6144
    buffer_load_dwordx4 a[12:15], v3, s[24:27], s43 offen offset:1024 sc1
    v_mfma_f32_16x16x32_bf16 v[172:175], v[92:95], a[88:91], v[172:175]
    s_waitcnt vmcnt(25)
    v_mfma_f32_16x16x32_bf16 v[176:179], v[80:83], a[92:95], v[176:179]
    ds_read_b64_tr_b16 v[72:73], v34 offset:4096
    v_mfma_f32_16x16x32_bf16 v[180:183], v[84:87], a[92:95], v[180:183]
    buffer_load_dwordx4 a[48:51], v4, s[24:27], s43 offen sc1
    v_mfma_f32_16x16x32_bf16 v[184:187], v[88:91], a[92:95], v[184:187]
    ds_read_b64_tr_b16 v[74:75], v34 offset:6144
    v_mfma_f32_16x16x32_bf16 v[188:191], v[92:95], a[92:95], v[188:191]
    buffer_load_dwordx4 a[52:55], v4, s[24:27], s43 offen offset:1024 sc1
    s_waitcnt vmcnt(26)
    v_mfma_f32_16x16x32_bf16 v[192:195], v[80:83], a[96:99], v[192:195]
    ds_read_b64_tr_b16 v[76:77], v35 offset:4096
    v_mfma_f32_16x16x32_bf16 v[196:199], v[84:87], a[96:99], v[196:199]
    buffer_load_dwordx4 a[56:59], v5, s[24:27], s43 offen sc1
    v_mfma_f32_16x16x32_bf16 v[200:203], v[88:91], a[96:99], v[200:203]
    ds_read_b64_tr_b16 v[78:79], v35 offset:6144
    v_mfma_f32_16x16x32_bf16 v[204:207], v[92:95], a[96:99], v[204:207]
    buffer_load_dwordx4 a[60:63], v5, s[24:27], s43 offen offset:1024 sc1
    s_waitcnt vmcnt(27)
    v_mfma_f32_16x16x32_bf16 v[208:211], v[80:83], a[100:103], v[208:211]
    v_mfma_f32_16x16x32_bf16 v[212:215], v[84:87], a[100:103], v[212:215]
    v_mfma_f32_16x16x32_bf16 v[216:219], v[88:91], a[100:103], v[216:219]
    v_mfma_f32_16x16x32_bf16 v[220:223], v[92:95], a[100:103], v[220:223]
    s_waitcnt vmcnt(26)
    v_mfma_f32_16x16x32_bf16 v[224:227], v[80:83], a[104:107], v[224:227]
    v_mfma_f32_16x16x32_bf16 v[228:231], v[84:87], a[104:107], v[228:231]
    v_mfma_f32_16x16x32_bf16 v[232:235], v[88:91], a[104:107], v[232:235]
    v_mfma_f32_16x16x32_bf16 v[236:239], v[92:95], a[104:107], v[236:239]
    s_waitcnt vmcnt(25)
    v_mfma_f32_16x16x32_bf16 v[240:243], v[80:83], a[108:111], v[240:243]
    v_mfma_f32_16x16x32_bf16 v[244:247], v[84:87], a[108:111], v[244:247]
    v_mfma_f32_16x16x32_bf16 v[248:251], v[88:91], a[108:111], v[248:251]
    v_mfma_f32_16x16x32_bf16 v[252:255], v[92:95], a[108:111], v[252:255]
    s_waitcnt vmcnt(17)
    s_waitcnt lgkmcnt(6)
    v_mfma_f32_16x16x32_bf16 v[128:131], v[64:67], a[112:115], v[128:131]
    s_waitcnt lgkmcnt(4)
    v_mfma_f32_16x16x32_bf16 v[132:135], v[68:71], a[112:115], v[132:135]
    s_waitcnt lgkmcnt(2)
    v_mfma_f32_16x16x32_bf16 v[136:139], v[72:75], a[112:115], v[136:139]
    s_bitcmp1_b32 s60, 26
    s_cbranch_scc1 K_RDY5
    s_mov_b32 s59, 26
    s_swappc_b64 s[68:69], s[66:67]
K_RDY5:
    s_waitcnt lgkmcnt(0)
    v_mfma_f32_16x16x32_bf16 v[140:143], v[76:79], a[112:115], v[140:143]
    v_mfma_f32_16x16x32_bf16 v[144:147], v[64:67], a[116:119], v[144:147]
    ds_read_b64_tr_b16 v[80:81], v32 offset:32768
    s_add_u32 s43, s53, 106496
    buffer_load_dwordx4 a[80:83], v2, s[24:27], s43 offen sc1
    v_mfma_f32_16x16x32_bf16 v[148:151], v[68:71], a[116:119], v[148:151]
    v_mfma_f32_16x16x32_bf16 v[152:155], v[72:75], a[116:119], v[152:155]
    ds_read_b64_tr_b16 v[82:83], v32 offset:34816
    buffer_load_dwordx4 a[84:87], v2, s[24:27], s43 offen offset:1024 sc1
    v_mfma_f32_16x16x32_bf16 v[156:159], v[76:79], a[116:119], v[156:159]
    v_mfma_f32_16x16x32_bf16 v[160:163], v[64:67], a[120:123], v[160:163]
    ds_read_b64_tr_b16 v[84:85], v33 offset:32768
    buffer_load_dwordx4 a[88:91], v3, s[24:27], s43 offen sc1
    v_mfma_f32_16x16x32_bf16 v[164:167], v[68:71], a[120:123], v[164:167]
    v_mfma_f32_16x16x32_bf16 v[168:171], v[72:75], a[120:123], v[168:171]
    ds_read_b64_tr_b16 v[86:87], v33 offset:34816
    buffer_load_dwordx4 a[92:95], v3, s[24:27], s43 offen offset:1024 sc1
    v_mfma_f32_16x16x32_bf16 v[172:175], v[76:79], a[120:123], v[172:175]
    v_mfma_f32_16x16x32_bf16 v[176:179], v[64:67], a[124:127], v[176:179]
    ds_read_b64_tr_b16 v[88:89], v34 offset:32768
    v_mfma_f32_16x16x32_bf16 v[180:183], v[68:71], a[124:127], v[180:183]
    buffer_load_dwordx4 a[96:99], v4, s[24:27], s43 offen sc1
    v_mfma_f32_16x16x32_bf16 v[184:187], v[72:75], a[124:127], v[184:187]
    ds_read_b64_tr_b16 v[90:91], v34 offset:34816
    v_mfma_f32_16x16x32_bf16 v[188:191], v[76:79], a[124:127], v[188:191]
    buffer_load_dwordx4 a[100:103], v4, s[24:27], s43 offen offset:1024 sc1
    v_mfma_f32_16x16x32_bf16 v[192:195], v[64:67], a[128:131], v[192:195]
    ds_read_b64_tr_b16 v[92:93], v35 offset:32768
    v_mfma_f32_16x16x32_bf16 v[196:199], v[68:71], a[128:131], v[196:199]
    buffer_load_dwordx4 a[104:107], v5, s[24:27], s43 offen sc1
    v_mfma_f32_16x16x32_bf16 v[200:203], v[72:75], a[128:131], v[200:203]
    ds_read_b64_tr_b16 v[94:95], v35 offset:34816
    v_mfma_f32_16x16x32_bf16 v[204:207], v[76:79], a[128:131], v[204:207]
    buffer_load_dwordx4 a[108:111], v5, s[24:27], s43 offen offset:1024 sc1
    v_mfma_f32_16x16x32_bf16 v[208:211], v[64:67], a[132:135], v[208:211]
    v_mfma_f32_16x16x32_bf16 v[212:215], v[68:71], a[132:135], v[212:215]
    v_mfma_f32_16x16x32_bf16 v[216:219], v[72:75], a[132:135], v[216:219]
    v_mfma_f32_16x16x32_bf16 v[220:223], v[76:79], a[132:135], v[220:223]
    v_mfma_f32_16x16x32_bf16 v[224:227], v[64:67], a[136:139], v[224:227]
    v_mfma_f32_16x16x32_bf16 v[228:231], v[68:71], a[136:139], v[228:231]
    v_mfma_f32_16x16x32_bf16 v[232:235], v[72:75], a[136:139], v[232:235]
    v_mfma_f32_16x16x32_bf16 v[236:239], v[76:79], a[136:139], v[236:239]
    v_mfma_f32_16x16x32_bf16 v[240:243], v[64:67], a[140:143], v[240:243]
    v_mfma_f32_16x16x32_bf16 v[244:247], v[68:71], a[140:143], v[244:247]
    v_mfma_f32_16x16x32_bf16 v[248:251], v[72:75], a[140:143], v[248:251]
    v_mfma_f32_16x16x32_bf16 v[252:255], v[76:79], a[140:143], v[252:255]
    s_waitcnt vmcnt(16)
    s_waitcnt lgkmcnt(6)
    v_mfma_f32_16x16x32_bf16 v[128:131], v[80:83], a[144:147], v[128:131]
    v_cmp_ne_u32 vcc, -1, v43
    s_waitcnt lgkmcnt(4)
    v_mfma_f32_16x16x32_bf16 v[132:135], v[84:87], a[144:147], v[132:135]
    s_lshr_b32 s57, vcc_lo, 1
    s_and_b32 s57, s57, vcc_lo
    s_or_b32 s60, s60, s57
    s_waitcnt lgkmcnt(2)
    v_mfma_f32_16x16x32_bf16 v[136:139], v[88:91], a[144:147], v[136:139]
    s_bitcmp1_b32 s60, 28
    s_cbranch_scc1 K_RDY6
    s_mov_b32 s59, 28
    s_swappc_b64 s[68:69], s[66:67]
K_RDY6:
    s_waitcnt lgkmcnt(0)
    v_mfma_f32_16x16x32_bf16 v[140:143], v[92:95], a[144:147], v[140:143]
    v_mfma_f32_16x16x32_bf16 v[144:147], v[80:83], a[148:151], v[144:147]
    ds_read_b64_tr_b16 v[64:65], v16 offset:32768
    s_add_u32 s43, s53, 114688
    buffer_load_dwordx4 a[112:115], v2, s[24:27], s43 offen sc1
    v_mfma_f32_16x16x32_bf16 v[148:151], v[84:87], a[148:151], v[148:151]
    v_mfma_f32_16x16x32_bf16 v[152:155], v[88:91], a[148:151], v[152:155]
    ds_read_b64_tr_b16 v[66:67], v16 offset:34816
    buffer_load_dwordx4 a[116:119], v2, s[24:27], s43 offen offset:1024 sc1
    v_mfma_f32_16x16x32_bf16 v[156:159], v[92:95], a[148:151], v[156:159]
    v_mfma_f32_16x16x32_bf16 v[160:163], v[80:83], a[152:155], v[160:163]
    ds_read_b64_tr_b16 v[68:69], v17 offset:32768
    buffer_load_dwordx4 a[120:123], v3, s[24:27], s43 offen sc1
    v_mfma_f32_16x16x32_bf16 v[164:167], v[84:87], a[152:155], v[164:167]
    v_mfma_f32_16x16x32_bf16 v[168:171], v[88:91], a[152:155], v[168:171]
    ds_read_b64_tr_b16 v[70:71], v17 offset:34816
    buffer_load_dwordx4 a[124:127], v3, s[24:27], s43 offen offset:1024 sc1
    v_mfma_f32_16x16x32_bf16 v[172:175], v[92:95], a[152:155], v[172:175]
    v_mfma_f32_16x16x32_bf16 v[176:179], v[80:83], a[156:159], v[176:179]
    ds_read_b64_tr_b16 v[72:73], v18 offset:32768
    v_mfma_f32_16x16x32_bf16 v[180:183], v[84:87], a[156:159], v[180:183]
    buffer_load_dwordx4 a[128:131], v4, s[24:27], s43 offen sc1
    v_mfma_f32_16x16x32_bf16 v[184:187], v[88:91], a[156:159], v[184:187]
    ds_read_b64_tr_b16 v[74:75], v18 offset:34816
    v_mfma_f32_16x16x32_bf16 v[188:191], v[92:95], a[156:159], v[188:191]
    buffer_load_dwordx4 a[132:135], v4, s[24:27], s43 offen offset:1024 sc1
    v_mfma_f32_16x16x32_bf16 v[192:195], v[80:83], a[160:163], v[192:195]
    ds_read_b64_tr_b16 v[76:77], v19 offset:32768
    v_mfma_f32_16x16x32_bf16 v[196:199], v[84:87], a[160:163], v[196:199]
    buffer_load_dwordx4 a[136:139], v5, s[24:27], s43 offen sc1
    v_mfma_f32_16x16x32_bf16 v[200:203], v[88:91], a[160:163], v[200:203]
    ds_read_b64_tr_b16 v[78:79], v19 offset:34816
    v_mfma_f32_16x16x32_bf16 v[204:207], v[92:95], a[160:163], v[204:207]
    buffer_load_dwordx4 a[140:143], v5, s[24:27], s43 offen offset:1024 sc1
    v_mfma_f32_16x16x32_bf16 v[208:211], v[80:83], a[164:167], v[208:211]
    v_mfma_f32_16x16x32_bf16 v[212:215], v[84:87], a[164:167], v[212:215]
    v_mfma_f32_16x16x32_bf16 v[216:219], v[88:91], a[164:167], v[216:219]
    v_mfma_f32_16x16x32_bf16 v[220:223], v[92:95], a[164:167], v[220:223]
    v_mfma_f32_16x16x32_bf16 v[224:227], v[80:83], a[168:171], v[224:227]
    v_mfma_f32_16x16x32_bf16 v[228:231], v[84:87], a[168:171], v[228:231]
    v_mfma_f32_16x16x32_bf16 v[232:235], v[88:91], a[168:171], v[232:235]
    v_mfma_f32_16x16x32_bf16 v[236:239], v[92:95], a[168:171], v[236:239]
    v_mfma_f32_16x16x32_bf16 v[240:243], v[80:83], a[172:175], v[240:243]
    v_mfma_f32_16x16x32_bf16 v[244:247], v[84:87], a[172:175], v[244:247]
    v_mfma_f32_16x16x32_bf16 v[248:251], v[88:91], a[172:175], v[248:251]
    v_mfma_f32_16x16x32_bf16 v[252:255], v[92:95], a[172:175], v[252:255]
    s_waitcnt vmcnt(16)
    s_waitcnt lgkmcnt(6)
    v_mfma_f32_16x16x32_bf16 v[128:131], v[64:67], a[0:3], v[128:131]
    s_waitcnt lgkmcnt(4)
    v_mfma_f32_16x16x32_bf16 v[132:135], v[68:71], a[0:3], v[132:135]
    s_waitcnt lgkmcnt(2)
    v_mfma_f32_16x16x32_bf16 v[136:139], v[72:75], a[0:3], v[136:139]
    s_bitcmp1_b32 s60, 30
    s_cbranch_scc1 K_RDY7
    s_mov_b32 s59, 30
    s_swappc_b64 s[68:69], s[66:67]
K_RDY7:
    s_waitcnt lgkmcnt(0)
    v_mfma_f32_16x16x32_bf16 v[140:143], v[76:79], a[0:3], v[140:143]
    v_mfma_f32_16x16x32_bf16 v[144:147], v[64:67], a[4:7], v[144:147]
    ds_read_b64_tr_b16 v[80:81], v16 offset:36864
    s_add_u32 s43, s53, 122880
    buffer_load_dwordx4 a[144:147], v2, s[24:27], s43 offen sc1
    v_mfma_f32_16x16x32_bf16 v[148:151], v[68:71], a[4:7], v[148:151]
    v_mfma_f32_16x16x32_bf16 v[152:155], v[72:75], a[4:7], v[152:155]
    ds_read_b64_tr_b16 v[82:83], v16 offset:38912
    buffer_load_dwordx4 a[148:151], v2, s[24:27], s43 offen offset:1024 sc1
    v_mfma_f32_16x16x32_bf16 v[156:159], v[76:79], a[4:7], v[156:159]
    v_mfma_f32_16x16x32_bf16 v[160:163], v[64:67], a[8:11], v[160:163]
    ds_read_b64_tr_b16 v[84:85], v17 offset:36864
    buffer_load_dwordx4 a[152:155], v3, s[24:27], s43 offen sc1
    v_mfma_f32_16x16x32_bf16 v[164:167], v[68:71], a[8:11], v[164:167]
    v_mfma_f32_16x16x32_bf16 v[168:171], v[72:75], a[8:11], v[168:171]
    ds_read_b64_tr_b16 v[86:87], v17 offset:38912
    buffer_load_dwordx4 a[156:159], v3, s[24:27], s43 offen offset:1024 sc1
    v_mfma_f32_16x16x32_bf16 v[172:175], v[76:79], a[8:11], v[172:175]
    v_mfma_f32_16x16x32_bf16 v[176:179], v[64:67], a[12:15], v[176:179]
    ds_read_b64_tr_b16 v[88:89], v18 offset:36864
    v_mfma_f32_16x16x32_bf16 v[180:183], v[68:71], a[12:15], v[180:183]
    buffer_load_dwordx4 a[160:163], v4, s[24:27], s43 offen sc1
    v_mfma_f32_16x16x32_bf16 v[184:187], v[72:75], a[12:15], v[184:187]
    ds_read_b64_tr_b16 v[90:91], v18 offset:38912
    v_mfma_f32_16x16x32_bf16 v[188:191], v[76:79], a[12:15], v[188:191]
    buffer_load_dwordx4 a[164:167], v4, s[24:27], s43 offen offset:1024 sc1
    v_mfma_f32_16x16x32_bf16 v[192:195], v[64:67], a[48:51], v[192:195]
    ds_read_b64_tr_b16 v[92:93], v19 offset:36864
    v_mfma_f32_16x16x32_bf16 v[196:199], v[68:71], a[48:51], v[196:199]
    buffer_load_dwordx4 a[168:171], v5, s[24:27], s43 offen sc1
    v_mfma_f32_16x16x32_bf16 v[200:203], v[72:75], a[48:51], v[200:203]
    ds_read_b64_tr_b16 v[94:95], v19 offset:38912
    v_mfma_f32_16x16x32_bf16 v[204:207], v[76:79], a[48:51], v[204:207]
    buffer_load_dwordx4 a[172:175], v5, s[24:27], s43 offen offset:1024 sc1
    v_mfma_f32_16x16x32_bf16 v[208:211], v[64:67], a[52:55], v[208:211]
    v_mfma_f32_16x16x32_bf16 v[212:215], v[68:71], a[52:55], v[212:215]
    v_mfma_f32_16x16x32_bf16 v[216:219], v[72:75], a[52:55], v[216:219]
    v_mfma_f32_16x16x32_bf16 v[220:223], v[76:79], a[52:55], v[220:223]
    v_mfma_f32_16x16x32_bf16 v[224:227], v[64:67], a[56:59], v[224:227]
    v_mfma_f32_16x16x32_bf16 v[228:231], v[68:71], a[56:59], v[228:231]
    v_mfma_f32_16x16x32_bf16 v[232:235], v[72:75], a[56:59], v[232:235]
    v_mfma_f32_16x16x32_bf16 v[236:239], v[76:79], a[56:59], v[236:239]
    v_mfma_f32_16x16x32_bf16 v[240:243], v[64:67], a[60:63], v[240:243]
    v_mfma_f32_16x16x32_bf16 v[244:247], v[68:71], a[60:63], v[244:247]
    v_mfma_f32_16x16x32_bf16 v[248:251], v[72:75], a[60:63], v[248:251]
    v_mfma_f32_16x16x32_bf16 v[252:255], v[76:79], a[60:63], v[252:255]
    s_waitcnt vmcnt(16)
    s_waitcnt lgkmcnt(6)
    v_mfma_f32_16x16x32_bf16 v[128:131], v[80:83], a[80:83], v[128:131]
    s_waitcnt lgkmcnt(4)
    v_mfma_f32_16x16x32_bf16 v[132:135], v[84:87], a[80:83], v[132:135]
    s_waitcnt lgkmcnt(2)
    v_mfma_f32_16x16x32_bf16 v[136:139], v[88:91], a[80:83], v[136:139]
    s_bitcmp1_b32 s60, 0
    s_cbranch_scc1 K_RDY8
    s_mov_b32 s59, 0
    s_swappc_b64 s[68:69], s[66:67]
K_RDY8:
    s_waitcnt lgkmcnt(0)
    v_mfma_f32_16x16x32_bf16 v[140:143], v[92:95], a[80:83], v[140:143]
    v_mfma_f32_16x16x32_bf16 v[144:147], v[80:83], a[84:87], v[144:147]
    ds_read_b64_tr_b16 v[64:65], v16 offset:0
    s_add_u32 s43, s53, 0
    buffer_load_dwordx4 a[0:3], v2, s[24:27], s43 offen sc1
    v_mfma_f32_16x16x32_bf16 v[148:151], v[84:87], a[84:87], v[148:151]
    v_mfma_f32_16x16x32_bf16 v[152:155], v[88:91], a[84:87], v[152:155]
    ds_read_b64_tr_b16 v[66:67], v16 offset:2048
    buffer_load_dwordx4 a[4:7], v2, s[24:27], s43 offen offset:1024 sc1
    v_mfma_f32_16x16x32_bf16 v[156:159], v[92:95], a[84:87], v[156:159]
    v_mfma_f32_16x16x32_bf16 v[160:163], v[80:83], a[88:91], v[160:163]
    ds_read_b64_tr_b16 v[68:69], v17 offset:0
    buffer_load_dwordx4 a[8:11], v3, s[24:27], s43 offen sc1
    v_mfma_f32_16x16x32_bf16 v[164:167], v[84:87], a[88:91], v[164:167]
    v_mfma_f32_16x16x32_bf16 v[168:171], v[88:91], a[88:91], v[168:171]
    ds_read_b64_tr_b16 v[70:71], v17 offset:2048
    buffer_load_dwordx4 a[12:15], v3, s[24:27], s43 offen offset:1024 sc1
    v_mfma_f32_16x16x32_bf16 v[172:175], v[92:95], a[88:91], v[172:175]
    v_mfma_f32_16x16x32_bf16 v[176:179], v[80:83], a[92:95], v[176:179]
    ds_read_b64_tr_b16 v[72:73], v18 offset:0
    v_mfma_f32_16x16x32_bf16 v[180:183], v[84:87], a[92:95], v[180:183]
    buffer_load_dwordx4 a[48:51], v4, s[24:27], s43 offen sc1
    v_mfma_f32_16x16x32_bf16 v[184:187], v[88:91], a[92:95], v[184:187]
    ds_read_b64_tr_b16 v[74:75], v18 offset:2048
    v_mfma_f32_16x16x32_bf16 v[188:191], v[92:95], a[92:95], v[188:191]
    buffer_load_dwordx4 a[52:55], v4, s[24:27], s43 offen offset:1024 sc1
    v_mfma_f32_16x16x32_bf16 v[192:195], v[80:83], a[96:99], v[192:195]
    ds_read_b64_tr_b16 v[76:77], v19 offset:0
    v_mfma_f32_16x16x32_bf16 v[196:199], v[84:87], a[96:99], v[196:199]
    buffer_load_dwordx4 a[56:59], v5, s[24:27], s43 offen sc1
    v_mfma_f32_16x16x32_bf16 v[200:203], v[88:91], a[96:99], v[200:203]
    ds_read_b64_tr_b16 v[78:79], v19 offset:2048
    v_mfma_f32_16x16x32_bf16 v[204:207], v[92:95], a[96:99], v[204:207]
    buffer_load_dwordx4 a[60:63], v5, s[24:27], s43 offen offset:1024 sc1
    v_mfma_f32_16x16x32_bf16 v[208:211], v[80:83], a[100:103], v[208:211]
    v_mfma_f32_16x16x32_bf16 v[212:215], v[84:87], a[100:103], v[212:215]
    v_mfma_f32_16x16x32_bf16 v[216:219], v[88:91], a[100:103], v[216:219]
    v_mfma_f32_16x16x32_bf16 v[220:223], v[92:95], a[100:103], v[220:223]
    v_mfma_f32_16x16x32_bf16 v[224:227], v[80:83], a[104:107], v[224:227]
    v_mfma_f32_16x16x32_bf16 v[228:231], v[84:87], a[104:107], v[228:231]
    v_mfma_f32_16x16x32_bf16 v[232:235], v[88:91], a[104:107], v[232:235]
    v_mfma_f32_16x16x32_bf16 v[236:239], v[92:95], a[104:107], v[236:239]
    v_mfma_f32_16x16x32_bf16 v[240:243], v[80:83], a[108:111], v[240:243]
    v_mfma_f32_16x16x32_bf16 v[244:247], v[84:87], a[108:111], v[244:247]
    v_mfma_f32_16x16x32_bf16 v[248:251], v[88:91], a[108:111], v[248:251]
    v_mfma_f32_16x16x32_bf16 v[252:255], v[92:95], a[108:111], v[252:255]
    s_waitcnt vmcnt(16)
    s_waitcnt lgkmcnt(6)
    v_mfma_f32_16x16x32_bf16 v[128:131], v[64:67], a[112:115], v[128:131]
    s_waitcnt lgkmcnt(4)
    v_mfma_f32_16x16x32_bf16 v[132:135], v[68:71], a[112:115], v[132:135]
    s_waitcnt lgkmcnt(2)
    v_mfma_f32_16x16x32_bf16 v[136:139], v[72:75], a[112:115], v[136:139]
    s_bitcmp1_b32 s60, 2
    s_cbranch_scc1 K_RDY9
    s_mov_b32 s59, 2
    s_swappc_b64 s[68:69], s[66:67]
K_RDY9:
    s_waitcnt lgkmcnt(0)
    v_mfma_f32_16x16x32_bf16 v[140:143], v[76:79], a[112:115], v[140:143]
    v_mfma_f32_16x16x32_bf16 v[144:147], v[64:67], a[116:119], v[144:147]
    ds_read_b64_tr_b16 v[80:81], v16 offset:4096
    s_add_u32 s43, s53, 8192
    buffer_load_dwordx4 a[80:83], v2, s[24:27], s43 offen sc1
    v_mfma_f32_16x16x32_bf16 v[148:151], v[68:71], a[116:119], v[148:151]
    v_mfma_f32_16x16x32_bf16 v[152:155], v[72:75], a[116:119], v[152:155]
    ds_read_b64_tr_b16 v[82:83], v16 offset:6144
    buffer_load_dwordx4 a[84:87], v2, s[24:27], s43 offen offset:1024 sc1
    v_mfma_f32_16x16x32_bf16 v[156:159], v[76:79], a[116:119], v[156:159]
    v_mfma_f32_16x16x32_bf16 v[160:163], v[64:67], a[120:123], v[160:163]
    ds_read_b64_tr_b16 v[84:85], v17 offset:4096
    buffer_load_dwordx4 a[88:91], v3, s[24:27], s43 offen sc1
    v_mfma_f32_16x16x32_bf16 v[164:167], v[68:71], a[120:123], v[164:167]
    v_mfma_f32_16x16x32_bf16 v[168:171], v[72:75], a[120:123], v[168:171]
    ds_read_b64_tr_b16 v[86:87], v17 offset:6144
    buffer_load_dwordx4 a[92:95], v3, s[24:27], s43 offen offset:1024 sc1
    v_mfma_f32_16x16x32_bf16 v[172:175], v[76:79], a[120:123], v[172:175]
    v_mfma_f32_16x16x32_bf16 v[176:179], v[64:67], a[124:127], v[176:179]
    ds_read_b64_tr_b16 v[88:89], v18 offset:4096
    v_mfma_f32_16x16x32_bf16 v[180:183], v[68:71], a[124:127], v[180:183]
    buffer_load_dwordx4 a[96:99], v4, s[24:27], s43 offen sc1
    v_mfma_f32_16x16x32_bf16 v[184:187], v[72:75], a[124:127], v[184:187]
    ds_read_b64_tr_b16 v[90:91], v18 offset:6144
    v_mfma_f32_16x16x32_bf16 v[188:191], v[76:79], a[124:127], v[188:191]
    buffer_load_dwordx4 a[100:103], v4, s[24:27], s43 offen offset:1024 sc1
    v_mfma_f32_16x16x32_bf16 v[192:195], v[64:67], a[128:131], v[192:195]
    ds_read_b64_tr_b16 v[92:93], v19 offset:4096
    v_mfma_f32_16x16x32_bf16 v[196:199], v[68:71], a[128:131], v[196:199]
    buffer_load_dwordx4 a[104:107], v5, s[24:27], s43 offen sc1
    v_mfma_f32_16x16x32_bf16 v[200:203], v[72:75], a[128:131], v[200:203]
    ds_read_b64_tr_b16 v[94:95], v19 offset:6144
    v_mfma_f32_16x16x32_bf16 v[204:207], v[76:79], a[128:131], v[204:207]
    buffer_load_dwordx4 a[108:111], v5, s[24:27], s43 offen offset:1024 sc1
    v_mfma_f32_16x16x32_bf16 v[208:211], v[64:67], a[132:135], v[208:211]
    v_mfma_f32_16x16x32_bf16 v[212:215], v[68:71], a[132:135], v[212:215]
    v_mfma_f32_16x16x32_bf16 v[216:219], v[72:75], a[132:135], v[216:219]
    v_mfma_f32_16x16x32_bf16 v[220:223], v[76:79], a[132:135], v[220:223]
    v_mfma_f32_16x16x32_bf16 v[224:227], v[64:67], a[136:139], v[224:227]
    v_mfma_f32_16x16x32_bf16 v[228:231], v[68:71], a[136:139], v[228:231]
    v_mfma_f32_16x16x32_bf16 v[232:235], v[72:75], a[136:139], v[232:235]
    v_mfma_f32_16x16x32_bf16 v[236:239], v[76:79], a[136:139], v[236:239]
    v_mfma_f32_16x16x32_bf16 v[240:243], v[64:67], a[140:143], v[240:243]
    v_mfma_f32_16x16x32_bf16 v[244:247], v[68:71], a[140:143], v[244:247]
    v_mfma_f32_16x16x32_bf16 v[248:251], v[72:75], a[140:143], v[248:251]
    v_mfma_f32_16x16x32_bf16 v[252:255], v[76:79], a[140:143], v[252:255]
    s_waitcnt vmcnt(16)
    s_waitcnt lgkmcnt(6)
    v_mfma_f32_16x16x32_bf16 v[128:131], v[80:83], a[144:147], v[128:131]
    s_waitcnt lgkmcnt(4)
    v_mfma_f32_16x16x32_bf16 v[132:135], v[84:87], a[144:147], v[132:135]
    s_waitcnt lgkmcnt(2)
    v_mfma_f32_16x16x32_bf16 v[136:139], v[88:91], a[144:147], v[136:139]
    s_bitcmp1_b32 s60, 4
    s_cbranch_scc1 K_RDY10
    s_mov_b32 s59, 4
    s_swappc_b64 s[68:69], s[66:67]
K_RDY10:
    s_waitcnt lgkmcnt(0)
    v_mfma_f32_16x16x32_bf16 v[140:143], v[92:95], a[144:147], v[140:143]
    v_mfma_f32_16x16x32_bf16 v[144:147], v[80:83], a[148:151], v[144:147]
    s_add_u32 s43, s53, 16384
    buffer_load_dwordx4 a[112:115], v2, s[24:27], s43 offen sc1
    v_mfma_f32_16x16x32_bf16 v[148:151], v[84:87], a[148:151], v[148:151]
    v_mfma_f32_16x16x32_bf16 v[152:155], v[88:91], a[148:151], v[152:155]
    buffer_load_dwordx4 a[116:119], v2, s[24:27], s43 offen offset:1024 sc1
    v_mfma_f32_16x16x32_bf16 v[156:159], v[92:95], a[148:151], v[156:159]
    v_mfma_f32_16x16x32_bf16 v[160:163], v[80:83], a[152:155], v[160:163]
    buffer_load_dwordx4 a[120:123], v3, s[24:27], s43 offen sc1
    v_mfma_f32_16x16x32_bf16 v[164:167], v[84:87], a[152:155], v[164:167]
    v_mfma_f32_16x16x32_bf16 v[168:171], v[88:91], a[152:155], v[168:171]
    buffer_load_dwordx4 a[124:127], v3, s[24:27], s43 offen offset:1024 sc1
    v_mfma_f32_16x16x32_bf16 v[172:175], v[92:95], a[152:155], v[172:175]
    v_mfma_f32_16x16x32_bf16 v[176:179], v[80:83], a[156:159], v[176:179]
    v_mfma_f32_16x16x32_bf16 v[180:183], v[84:87], a[156:159], v[180:183]
    buffer_load_dwordx4 a[128:131], v4, s[24:27], s43 offen sc1
    v_mfma_f32_16x16x32_bf16 v[184:187], v[88:91], a[156:159], v[184:187]
    v_mfma_f32_16x16x32_bf16 v[188:191], v[92:95], a[156:159], v[188:191]
    buffer_load_dwordx4 a[132:135], v4, s[24:27], s43 offen offset:1024 sc1
    v_mfma_f32_16x16x32_bf16 v[192:195], v[80:83], a[160:163], v[192:195]
    v_mfma_f32_16x16x32_bf16 v[196:199], v[84:87], a[160:163], v[196:199]
    buffer_load_dwordx4 a[136:139], v5, s[24:27], s43 offen sc1
    v_mfma_f32_16x16x32_bf16 v[200:203], v[88:91], a[160:163], v[200:203]
    v_mfma_f32_16x16x32_bf16 v[204:207], v[92:95], a[160:163], v[204:207]
    buffer_load_dwordx4 a[140:143], v5, s[24:27], s43 offen offset:1024 sc1
    v_mfma_f32_16x16x32_bf16 v[208:211], v[80:83], a[164:167], v[208:211]
    v_mfma_f32_16x16x32_bf16 v[212:215], v[84:87], a[164:167], v[212:215]
    v_mfma_f32_16x16x32_bf16 v[216:219], v[88:91], a[164:167], v[216:219]
    v_mfma_f32_16x16x32_bf16 v[220:223], v[92:95], a[164:167], v[220:223]
    v_mfma_f32_16x16x32_bf16 v[224:227], v[80:83], a[168:171], v[224:227]
    v_mfma_f32_16x16x32_bf16 v[228:231], v[84:87], a[168:171], v[228:231]
    v_mfma_f32_16x16x32_bf16 v[232:235], v[88:91], a[168:171], v[232:235]
    v_mfma_f32_16x16x32_bf16 v[236:239], v[92:95], a[168:171], v[236:239]
    v_mfma_f32_16x16x32_bf16 v[240:243], v[80:83], a[172:175], v[240:243]
    v_mfma_f32_16x16x32_bf16 v[244:247], v[84:87], a[172:175], v[244:247]
    v_mfma_f32_16x16x32_bf16 v[248:251], v[88:91], a[172:175], v[248:251]
    v_mfma_f32_16x16x32_bf16 v[252:255], v[92:95], a[172:175], v[252:255]
    s_waitcnt vmcnt(16)
    v_mfma_f32_16x16x32_bf16 v[128:131], a[176:179], a[0:3], v[128:131]
    v_mfma_f32_16x16x32_bf16 v[132:135], a[180:183], a[0:3], v[132:135]
    v_mfma_f32_16x16x32_bf16 v[136:139], a[184:187], a[0:3], v[136:139]
    s_bitcmp1_b32 s60, 6
    s_cbranch_scc1 K_RDY11
    s_mov_b32 s59, 6
    s_swappc_b64 s[68:69], s[66:67]
K_RDY11:
    v_mfma_f32_16x16x32_bf16 v[140:143], a[188:191], a[0:3], v[140:143]
    v_mfma_f32_16x16x32_bf16 v[144:147], a[176:179], a[4:7], v[144:147]
    s_add_u32 s43, s53, 24576
    buffer_load_dwordx4 a[144:147], v2, s[24:27], s43 offen sc1
    v_mfma_f32_16x16x32_bf16 v[148:151], a[180:183], a[4:7], v[148:151]
    v_mfma_f32_16x16x32_bf16 v[152:155], a[184:187], a[4:7], v[152:155]
    buffer_load_dwordx4 a[148:151], v2, s[24:27], s43 offen offset:1024 sc1
    v_mfma_f32_16x16x32_bf16 v[156:159], a[188:191], a[4:7], v[156:159]
    v_mfma_f32_16x16x32_bf16 v[160:163], a[176:179], a[8:11], v[160:163]
    buffer_load_dwordx4 a[152:155], v3, s[24:27], s43 offen sc1
    v_mfma_f32_16x16x32_bf16 v[164:167], a[180:183], a[8:11], v[164:167]
    v_mfma_f32_16x16x32_bf16 v[168:171], a[184:187], a[8:11], v[168:171]
    buffer_load_dwordx4 a[156:159], v3, s[24:27], s43 offen offset:1024 sc1
    v_mfma_f32_16x16x32_bf16 v[172:175], a[188:191], a[8:11], v[172:175]
    v_mfma_f32_16x16x32_bf16 v[176:179], a[176:179], a[12:15], v[176:179]
    v_mfma_f32_16x16x32_bf16 v[180:183], a[180:183], a[12:15], v[180:183]
    buffer_load_dwordx4 a[160:163], v4, s[24:27], s43 offen sc1
    v_mfma_f32_16x16x32_bf16 v[184:187], a[184:187], a[12:15], v[184:187]
    v_mfma_f32_16x16x32_bf16 v[188:191], a[188:191], a[12:15], v[188:191]
    buffer_load_dwordx4 a[164:167], v4, s[24:27], s43 offen offset:1024 sc1
    v_mfma_f32_16x16x32_bf16 v[192:195], a[176:179], a[48:51], v[192:195]
    v_mfma_f32_16x16x32_bf16 v[196:199], a[180:183], a[48:51], v[196:199]
    buffer_load_dwordx4 a[168:171], v5, s[24:27], s43 offen sc1
    v_mfma_f32_16x16x32_bf16 v[200:203], a[184:187], a[48:51], v[200:203]
    v_mfma_f32_16x16x32_bf16 v[204:207], a[188:191], a[48:51], v[204:207]
    buffer_load_dwordx4 a[172:175], v5, s[24:27], s43 offen offset:1024 sc1
    v_mfma_f32_16x16x32_bf16 v[208:211], a[176:179], a[52:55], v[208:211]
    v_mfma_f32_16x16x32_bf16 v[212:215], a[180:183], a[52:55], v[212:215]
    v_mfma_f32_16x16x32_bf16 v[216:219], a[184:187], a[52:55], v[216:219]
    v_mfma_f32_16x16x32_bf16 v[220:223], a[188:191], a[52:55], v[220:223]
    v_mfma_f32_16x16x32_bf16 v[224:227], a[176:179], a[56:59], v[224:227]
    v_mfma_f32_16x16x32_bf16 v[228:231], a[180:183], a[56:59], v[228:231]
    v_mfma_f32_16x16x32_bf16 v[232:235], a[184:187], a[56:59], v[232:235]
    v_mfma_f32_16x16x32_bf16 v[236:239], a[188:191], a[56:59], v[236:239]
    v_mfma_f32_16x16x32_bf16 v[240:243], a[176:179], a[60:63], v[240:243]
    v_mfma_f32_16x16x32_bf16 v[244:247], a[180:183], a[60:63], v[244:247]
    v_mfma_f32_16x16x32_bf16 v[248:251], a[184:187], a[60:63], v[248:251]
    v_mfma_f32_16x16x32_bf16 v[252:255], a[188:191], a[60:63], v[252:255]
    s_waitcnt vmcnt(16)
    v_mfma_f32_16x16x32_bf16 v[128:131], a[192:195], a[80:83], v[128:131]
    v_mfma_f32_16x16x32_bf16 v[132:135], a[196:199], a[80:83], v[132:135]
    v_mfma_f32_16x16x32_bf16 v[136:139], a[200:203], a[80:83], v[136:139]
    s_bitcmp1_b32 s60, 8
    s_cbranch_scc1 K_RDY12
    s_mov_b32 s59, 8
    s_swappc_b64 s[68:69], s[66:67]
K_RDY12:
    v_mfma_f32_16x16x32_bf16 v[140:143], a[204:207], a[80:83], v[140:143]
    v_mfma_f32_16x16x32_bf16 v[144:147], a[192:195], a[84:87], v[144:147]
    s_add_u32 s43, s53, 32768
    buffer_load_dwordx4 a[0:3], v2, s[24:27], s43 offen sc1
    v_mfma_f32_16x16x32_bf16 v[148:151], a[196:199], a[84:87], v[148:151]
    v_mfma_f32_16x16x32_bf16 v[152:155], a[200:203], a[84:87], v[152:155]
    buffer_load_dwordx4 a[4:7], v2, s[24:27], s43 offen offset:1024 sc1
    v_mfma_f32_16x16x32_bf16 v[156:159], a[204:207], a[84:87], v[156:159]
    v_mfma_f32_16x16x32_bf16 v[160:163], a[192:195], a[88:91], v[160:163]
    buffer_load_dwordx4 a[8:11], v3, s[24:27], s43 offen sc1
    v_mfma_f32_16x16x32_bf16 v[164:167], a[196:199], a[88:91], v[164:167]
    v_mfma_f32_16x16x32_bf16 v[168:171], a[200:203], a[88:91], v[168:171]
    buffer_load_dwordx4 a[12:15], v3, s[24:27], s43 offen offset:1024 sc1
    v_mfma_f32_16x16x32_bf16 v[172:175], a[204:207], a[88:91], v[172:175]
    v_mfma_f32_16x16x32_bf16 v[176:179], a[192:195], a[92:95], v[176:179]
    v_mfma_f32_16x16x32_bf16 v[180:183], a[196:199], a[92:95], v[180:183]
    buffer_load_dwordx4 a[48:51], v4, s[24:27], s43 offen sc1
    v_mfma_f32_16x16x32_bf16 v[184:187], a[200:203], a[92:95], v[184:187]
    v_mfma_f32_16x16x32_bf16 v[188:191], a[204:207], a[92:95], v[188:191]
    buffer_load_dwordx4 a[52:55], v4, s[24:27], s43 offen offset:1024 sc1
    v_mfma_f32_16x16x32_bf16 v[192:195], a[192:195], a[96:99], v[192:195]
    v_mfma_f32_16x16x32_bf16 v[196:199], a[196:199], a[96:99], v[196:199]
    buffer_load_dwordx4 a[56:59], v5, s[24:27], s43 offen sc1
    v_mfma_f32_16x16x32_bf16 v[200:203], a[200:203], a[96:99], v[200:203]
    v_mfma_f32_16x16x32_bf16 v[204:207], a[204:207], a[96:99], v[204:207]
    buffer_load_dwordx4 a[60:63], v5, s[24:27], s43 offen offset:1024 sc1
    v_mfma_f32_16x16x32_bf16 v[208:211], a[192:195], a[100:103], v[208:211]
    v_mfma_f32_16x16x32_bf16 v[212:215], a[196:199], a[100:103], v[212:215]
    v_mfma_f32_16x16x32_bf16 v[216:219], a[200:203], a[100:103], v[216:219]
    v_mfma_f32_16x16x32_bf16 v[220:223], a[204:207], a[100:103], v[220:223]
    v_mfma_f32_16x16x32_bf16 v[224:227], a[192:195], a[104:107], v[224:227]
    v_mfma_f32_16x16x32_bf16 v[228:231], a[196:199], a[104:107], v[228:231]
    v_mfma_f32_16x16x32_bf16 v[232:235], a[200:203], a[104:107], v[232:235]
    v_mfma_f32_16x16x32_bf16 v[236:239], a[204:207], a[104:107], v[236:239]
    v_mfma_f32_16x16x32_bf16 v[240:243], a[192:195], a[108:111], v[240:243]
    v_mfma_f32_16x16x32_bf16 v[244:247], a[196:199], a[108:111], v[244:247]
    v_mfma_f32_16x16x32_bf16 v[248:251], a[200:203], a[108:111], v[248:251]
    v_mfma_f32_16x16x32_bf16 v[252:255], a[204:207], a[108:111], v[252:255]
    s_waitcnt vmcnt(16)
    v_mfma_f32_16x16x32_bf16 v[128:131], a[208:211], a[112:115], v[128:131]
    v_mfma_f32_16x16x32_bf16 v[132:135], a[212:215], a[112:115], v[132:135]
    v_mfma_f32_16x16x32_bf16 v[136:139], a[216:219], a[112:115], v[136:139]
    s_bitcmp1_b32 s60, 10
    s_cbranch_scc1 K_RDY13
    s_mov_b32 s59, 10
    s_swappc_b64 s[68:69], s[66:67]
K_RDY13:
    s_bitcmp1_b32 s60, 12
    s_cbranch_scc1 K_RDY14
    s_mov_b32 s59, 12
    s_swappc_b64 s[68:69], s[66:67]
K_RDY14:
    s_bitcmp1_b32 s60, 14
    s_cbranch_scc1 K_RDY15
    s_mov_b32 s59, 14
    s_swappc_b64 s[68:69], s[66:67]
K_RDY15:
    buffer_load_dword v20, v6, s[24:27], s54 offen sc1
    v_mfma_f32_16x16x32_bf16 v[140:143], a[220:223], a[112:115], v[140:143]
    v_mfma_f32_16x16x32_bf16 v[144:147], a[208:211], a[116:119], v[144:147]
    s_add_u32 s4, s53, 40960
    s_add_u32 s5, s53, 49152
    s_add_u32 s6, s53, 57344
    buffer_load_dwordx4 a[80:83], v2, s[24:27], s4 offen sc1
    v_mfma_f32_16x16x32_bf16 v[148:151], a[212:215], a[116:119], v[148:151]
    v_mfma_f32_16x16x32_bf16 v[152:155], a[216:219], a[116:119], v[152:155]
    buffer_load_dwordx4 a[84:87], v2, s[24:27], s5 offen sc1
    v_mfma_f32_16x16x32_bf16 v[156:159], a[220:223], a[116:119], v[156:159]
    v_mfma_f32_16x16x32_bf16 v[160:163], a[208:211], a[120:123], v[160:163]
    buffer_load_dwordx4 a[88:91], v2, s[24:27], s6 offen sc1
    v_mfma_f32_16x16x32_bf16 v[164:167], a[212:215], a[120:123], v[164:167]
    v_mfma_f32_16x16x32_bf16 v[168:171], a[216:219], a[120:123], v[168:171]
    buffer_load_dwordx4 a[92:95], v2, s[24:27], s4 offen offset:1024 sc1
    v_mfma_f32_16x16x32_bf16 v[172:175], a[220:223], a[120:123], v[172:175]
    v_mfma_f32_16x16x32_bf16 v[176:179], a[208:211], a[124:127], v[176:179]
    v_mfma_f32_16x16x32_bf16 v[180:183], a[212:215], a[124:127], v[180:183]
    buffer_load_dwordx4 a[96:99], v2, s[24:27], s5 offen offset:1024 sc1
    v_mfma_f32_16x16x32_bf16 v[184:187], a[216:219], a[124:127], v[184:187]
    v_mfma_f32_16x16x32_bf16 v[188:191], a[220:223], a[124:127], v[188:191]
    buffer_load_dwordx4 a[100:103], v2, s[24:27], s6 offen offset:1024 sc1
    v_mfma_f32_16x16x32_bf16 v[192:195], a[208:211], a[128:131], v[192:195]
    v_mfma_f32_16x16x32_bf16 v[196:199], a[212:215], a[128:131], v[196:199]
    buffer_load_dwordx4 a[104:107], v3, s[24:27], s4 offen sc1
    v_mfma_f32_16x16x32_bf16 v[200:203], a[216:219], a[128:131], v[200:203]
    v_mfma_f32_16x16x32_bf16 v[204:207], a[220:223], a[128:131], v[204:207]
    buffer_load_dwordx4 a[108:111], v3, s[24:27], s5 offen sc1
    v_mfma_f32_16x16x32_bf16 v[208:211], a[208:211], a[132:135], v[208:211]
    v_mfma_f32_16x16x32_bf16 v[212:215], a[212:215], a[132:135], v[212:215]
    v_mfma_f32_16x16x32_bf16 v[216:219], a[216:219], a[132:135], v[216:219]
    v_mfma_f32_16x16x32_bf16 v[220:223], a[220:223], a[132:135], v[220:223]
    v_mfma_f32_16x16x32_bf16 v[224:227], a[208:211], a[136:139], v[224:227]
    v_mfma_f32_16x16x32_bf16 v[228:231], a[212:215], a[136:139], v[228:231]
    v_mfma_f32_16x16x32_bf16 v[232:235], a[216:219], a[136:139], v[232:235]
    v_mfma_f32_16x16x32_bf16 v[236:239], a[220:223], a[136:139], v[236:239]
    v_mfma_f32_16x16x32_bf16 v[240:243], a[208:211], a[140:143], v[240:243]
    v_mfma_f32_16x16x32_bf16 v[244:247], a[212:215], a[140:143], v[244:247]
    v_mfma_f32_16x16x32_bf16 v[248:251], a[216:219], a[140:143], v[248:251]
    v_mfma_f32_16x16x32_bf16 v[252:255], a[220:223], a[140:143], v[252:255]
    s_waitcnt vmcnt(17)
    v_mfma_f32_16x16x32_bf16 v[128:131], a[224:227], a[144:147], v[128:131]
    v_mfma_f32_16x16x32_bf16 v[132:135], a[228:231], a[144:147], v[132:135]
    v_mfma_f32_16x16x32_bf16 v[136:139], a[232:235], a[144:147], v[136:139]
    v_mfma_f32_16x16x32_bf16 v[140:143], a[236:239], a[144:147], v[140:143]
    v_mfma_f32_16x16x32_bf16 v[144:147], a[224:227], a[148:151], v[144:147]
    buffer_load_dwordx4 a[112:115], v3, s[24:27], s6 offen sc1
    v_mfma_f32_16x16x32_bf16 v[148:151], a[228:231], a[148:151], v[148:151]
    v_mfma_f32_16x16x32_bf16 v[152:155], a[232:235], a[148:151], v[152:155]
    buffer_load_dwordx4 a[116:119], v3, s[24:27], s4 offen offset:1024 sc1
    v_mfma_f32_16x16x32_bf16 v[156:159], a[236:239], a[148:151], v[156:159]
    v_mfma_f32_16x16x32_bf16 v[160:163], a[224:227], a[152:155], v[160:163]
    buffer_load_dwordx4 a[120:123], v3, s[24:27], s5 offen offset:1024 sc1
    v_mfma_f32_16x16x32_bf16 v[164:167], a[228:231], a[152:155], v[164:167]
    v_mfma_f32_16x16x32_bf16 v[168:171], a[232:235], a[152:155], v[168:171]
    buffer_load_dwordx4 a[124:127], v3, s[24:27], s6 offen offset:1024 sc1
    v_mfma_f32_16x16x32_bf16 v[172:175], a[236:239], a[152:155], v[172:175]
    v_mfma_f32_16x16x32_bf16 v[176:179], a[224:227], a[156:159], v[176:179]
    v_mfma_f32_16x16x32_bf16 v[180:183], a[228:231], a[156:159], v[180:183]
    buffer_load_dwordx4 a[128:131], v4, s[24:27], s4 offen sc1
    v_mfma_f32_16x16x32_bf16 v[184:187], a[232:235], a[156:159], v[184:187]
    v_mfma_f32_16x16x32_bf16 v[188:191], a[236:239], a[156:159], v[188:191]
    buffer_load_dwordx4 a[132:135], v4, s[24:27], s5 offen sc1
    v_mfma_f32_16x16x32_bf16 v[192:195], a[224:227], a[160:163], v[192:195]
    v_mfma_f32_16x16x32_bf16 v[196:199], a[228:231], a[160:163], v[196:199]
    buffer_load_dwordx4 a[136:139], v4, s[24:27], s6 offen sc1
    v_mfma_f32_16x16x32_bf16 v[200:203], a[232:235], a[160:163], v[200:203]
    v_mfma_f32_16x16x32_bf16 v[204:207], a[236:239], a[160:163], v[204:207]
    buffer_load_dwordx4 a[140:143], v4, s[24:27], s4 offen offset:1024 sc1
    v_mfma_f32_16x16x32_bf16 v[208:211], a[224:227], a[164:167], v[208:211]
    v_mfma_f32_16x16x32_bf16 v[212:215], a[228:231], a[164:167], v[212:215]
    v_mfma_f32_16x16x32_bf16 v[216:219], a[232:235], a[164:167], v[216:219]
    v_mfma_f32_16x16x32_bf16 v[220:223], a[236:239], a[164:167], v[220:223]
    v_mfma_f32_16x16x32_bf16 v[224:227], a[224:227], a[168:171], v[224:227]
    v_mfma_f32_16x16x32_bf16 v[228:231], a[228:231], a[168:171], v[228:231]
    v_mfma_f32_16x16x32_bf16 v[232:235], a[232:235], a[168:171], v[232:235]
    v_mfma_f32_16x16x32_bf16 v[236:239], a[236:239], a[168:171], v[236:239]
    v_mfma_f32_16x16x32_bf16 v[240:243], a[224:227], a[172:175], v[240:243]
    v_mfma_f32_16x16x32_bf16 v[244:247], a[228:231], a[172:175], v[244:247]
    v_mfma_f32_16x16x32_bf16 v[248:251], a[232:235], a[172:175], v[248:251]
    v_mfma_f32_16x16x32_bf16 v[252:255], a[236:239], a[172:175], v[252:255]
    s_waitcnt vmcnt(17)
    v_mfma_f32_16x16x32_bf16 v[128:131], a[240:243], a[0:3], v[128:131]
    v_mfma_f32_16x16x32_bf16 v[132:135], a[244:247], a[0:3], v[132:135]
    v_mfma_f32_16x16x32_bf16 v[136:139], a[248:251], a[0:3], v[136:139]
    v_mfma_f32_16x16x32_bf16 v[140:143], a[252:255], a[0:3], v[140:143]
    v_mfma_f32_16x16x32_bf16 v[144:147], a[240:243], a[4:7], v[144:147]
    buffer_load_dwordx4 a[144:147], v4, s[24:27], s5 offen offset:1024 sc1
    v_mfma_f32_16x16x32_bf16 v[148:151], a[244:247], a[4:7], v[148:151]
    v_mfma_f32_16x16x32_bf16 v[152:155], a[248:251], a[4:7], v[152:155]
    buffer_load_dwordx4 a[148:151], v4, s[24:27], s6 offen offset:1024 sc1
    v_mfma_f32_16x16x32_bf16 v[156:159], a[252:255], a[4:7], v[156:159]
    v_mfma_f32_16x16x32_bf16 v[160:163], a[240:243], a[8:11], v[160:163]
    buffer_load_dwordx4 a[152:155], v5, s[24:27], s4 offen sc1
    v_mfma_f32_16x16x32_bf16 v[164:167], a[244:247], a[8:11], v[164:167]
    v_mfma_f32_16x16x32_bf16 v[168:171], a[248:251], a[8:11], v[168:171]
    buffer_load_dwordx4 a[156:159], v5, s[24:27], s5 offen sc1
    v_mfma_f32_16x16x32_bf16 v[172:175], a[252:255], a[8:11], v[172:175]
    v_mfma_f32_16x16x32_bf16 v[176:179], a[240:243], a[12:15], v[176:179]
    v_mfma_f32_16x16x32_bf16 v[180:183], a[244:247], a[12:15], v[180:183]
    buffer_load_dwordx4 a[160:163], v5, s[24:27], s6 offen sc1
    v_mfma_f32_16x16x32_bf16 v[184:187], a[248:251], a[12:15], v[184:187]
    v_mfma_f32_16x16x32_bf16 v[188:191], a[252:255], a[12:15], v[188:191]
    buffer_load_dwordx4 a[164:167], v5, s[24:27], s4 offen offset:1024 sc1
    v_mfma_f32_16x16x32_bf16 v[192:195], a[240:243], a[48:51], v[192:195]
    v_mfma_f32_16x16x32_bf16 v[196:199], a[244:247], a[48:51], v[196:199]
    buffer_load_dwordx4 a[168:171], v5, s[24:27], s5 offen offset:1024 sc1
    v_mfma_f32_16x16x32_bf16 v[200:203], a[248:251], a[48:51], v[200:203]
    v_mfma_f32_16x16x32_bf16 v[204:207], a[252:255], a[48:51], v[204:207]
    buffer_load_dwordx4 a[172:175], v5, s[24:27], s6 offen offset:1024 sc1
    v_mfma_f32_16x16x32_bf16 v[208:211], a[240:243], a[52:55], v[208:211]
    v_mfma_f32_16x16x32_bf16 v[212:215], a[244:247], a[52:55], v[212:215]
    v_mfma_f32_16x16x32_bf16 v[216:219], a[248:251], a[52:55], v[216:219]
    v_mfma_f32_16x16x32_bf16 v[220:223], a[252:255], a[52:55], v[220:223]
    v_mfma_f32_16x16x32_bf16 v[224:227], a[240:243], a[56:59], v[224:227]
    v_mfma_f32_16x16x32_bf16 v[228:231], a[244:247], a[56:59], v[228:231]
    v_mfma_f32_16x16x32_bf16 v[232:235], a[248:251], a[56:59], v[232:235]
    v_mfma_f32_16x16x32_bf16 v[236:239], a[252:255], a[56:59], v[236:239]
    v_mfma_f32_16x16x32_bf16 v[240:243], a[240:243], a[60:63], v[240:243]
    v_mfma_f32_16x16x32_bf16 v[244:247], a[244:247], a[60:63], v[244:247]
    v_mfma_f32_16x16x32_bf16 v[248:251], a[248:251], a[60:63], v[248:251]
    v_mfma_f32_16x16x32_bf16 v[252:255], a[252:255], a[60:63], v[252:255]
    s_waitcnt vmcnt(21)
    v_mfma_f32_16x16x32_bf16 v[128:131], a[16:19], a[80:83], v[128:131]
    v_mfma_f32_16x16x32_bf16 v[128:131], a[32:35], a[84:87], v[128:131]
    v_mov_b32 v22, v20
    v_mfma_f32_16x16x32_bf16 v[128:131], a[64:67], a[88:91], v[128:131]
    s_nop 0
    v_permlane16_swap_b32 v20, v22
    v_mfma_f32_16x16x32_bf16 v[132:135], a[20:23], a[80:83], v[132:135]
    v_sub_f32 v21, 1.0, v20
    v_mfma_f32_16x16x32_bf16 v[132:135], a[36:39], a[84:87], v[132:135]
    v_cvt_pk_bf16_f32 v21, v21, v21
    v_mfma_f32_16x16x32_bf16 v[132:135], a[68:71], a[88:91], v[132:135]
    v_mfma_f32_16x16x32_bf16 v[136:139], a[24:27], a[80:83], v[136:139]
    v_and_b32 v21, 0xffff0000, v21
    v_mfma_f32_16x16x32_bf16 v[136:139], a[40:43], a[84:87], v[136:139]
    v_sub_f32 v23, 1.0, v22
    v_mfma_f32_16x16x32_bf16 v[136:139], a[72:75], a[88:91], v[136:139]
    v_cvt_pk_bf16_f32 v23, v23, v23
    v_mfma_f32_16x16x32_bf16 v[140:143], a[28:31], a[80:83], v[140:143]
    v_and_b32 v23, 0xffff0000, v23
    v_mfma_f32_16x16x32_bf16 v[140:143], a[44:47], a[84:87], v[140:143]
    s_cmp_lt_u32 s38, 2
    s_cbranch_scc1 K_NOSWAP
    v_swap_b32 v20, v21
    v_swap_b32 v22, v23
K_NOSWAP:
    v_mfma_f32_16x16x32_bf16 v[140:143], a[76:79], a[88:91], v[140:143]
    s_waitcnt vmcnt(18)
    v_mfma_f32_16x16x32_bf16 v[144:147], a[16:19], a[92:95], v[144:147]
    v_mfma_f32_16x16x32_bf16 v[144:147], a[32:35], a[96:99], v[144:147]
    v_mfma_f32_16x16x32_bf16 v[144:147], a[64:67], a[100:103], v[144:147]
    ds_write_b128 v7, v[128:131] offset:0
    v_mfma_f32_16x16x32_bf16 v[148:151], a[20:23], a[92:95], v[148:151]
    v_mfma_f32_16x16x32_bf16 v[148:151], a[36:39], a[96:99], v[148:151]
    ds_write_b128 v7, v[132:135] offset:1024
    v_mfma_f32_16x16x32_bf16 v[148:151], a[68:71], a[100:103], v[148:151]
    v_mfma_f32_16x16x32_bf16 v[152:155], a[24:27], a[92:95], v[152:155]
    v_mfma_f32_16x16x32_bf16 v[152:155], a[40:43], a[96:99], v[152:155]
    ds_write_b128 v7, v[136:139] offset:2048
    v_mfma_f32_16x16x32_bf16 v[152:155], a[72:75], a[100:103], v[152:155]
    v_mfma_f32_16x16x32_bf16 v[156:159], a[28:31], a[92:95], v[156:159]
    ds_write_b128 v7, v[140:143] offset:3072
    v_mfma_f32_16x16x32_bf16 v[156:159], a[44:47], a[96:99], v[156:159]
    v_mfma_f32_16x16x32_bf16 v[156:159], a[76:79], a[100:103], v[156:159]
    s_waitcnt vmcnt(15)
    v_mfma_f32_16x16x32_bf16 v[160:163], a[16:19], a[104:107], v[160:163]
    v_mfma_f32_16x16x32_bf16 v[160:163], a[32:35], a[108:111], v[160:163]
    v_mfma_f32_16x16x32_bf16 v[160:163], a[64:67], a[112:115], v[160:163]
    ds_write_b128 v7, v[144:147] offset:4096
    v_mfma_f32_16x16x32_bf16 v[164:167], a[20:23], a[104:107], v[164:167]
    v_mfma_f32_16x16x32_bf16 v[164:167], a[36:39], a[108:111], v[164:167]
    ds_write_b128 v7, v[148:151] offset:5120
    v_mfma_f32_16x16x32_bf16 v[164:167], a[68:71], a[112:115], v[164:167]
    v_mfma_f32_16x16x32_bf16 v[168:171], a[24:27], a[104:107], v[168:171]
    v_mfma_f32_16x16x32_bf16 v[168:171], a[40:43], a[108:111], v[168:171]
    ds_write_b128 v7, v[152:155] offset:6144
    v_mfma_f32_16x16x32_bf16 v[168:171], a[72:75], a[112:115], v[168:171]
    v_mfma_f32_16x16x32_bf16 v[172:175], a[28:31], a[104:107], v[172:175]
    ds_write_b128 v7, v[156:159] offset:7168
    v_mfma_f32_16x16x32_bf16 v[172:175], a[44:47], a[108:111], v[172:175]
    v_mfma_f32_16x16x32_bf16 v[172:175], a[76:79], a[112:115], v[172:175]
    s_waitcnt vmcnt(12)
    v_mfma_f32_16x16x32_bf16 v[176:179], a[16:19], a[116:119], v[176:179]
    v_mfma_f32_16x16x32_bf16 v[176:179], a[32:35], a[120:123], v[176:179]
    v_mfma_f32_16x16x32_bf16 v[176:179], a[64:67], a[124:127], v[176:179]
    ds_write_b128 v7, v[160:163] offset:32768
    v_mfma_f32_16x16x32_bf16 v[180:183], a[20:23], a[116:119], v[180:183]
    v_mfma_f32_16x16x32_bf16 v[180:183], a[36:39], a[120:123], v[180:183]
    ds_write_b128 v7, v[164:167] offset:33792
    v_mfma_f32_16x16x32_bf16 v[180:183], a[68:71], a[124:127], v[180:183]
    v_mfma_f32_16x16x32_bf16 v[184:187], a[24:27], a[116:119], v[184:187]
    v_mfma_f32_16x16x32_bf16 v[184:187], a[40:43], a[120:123], v[184:187]
    ds_write_b128 v7, v[168:171] offset:34816
    v_mfma_f32_16x16x32_bf16 v[184:187], a[72:75], a[124:127], v[184:187]
    v_mfma_f32_16x16x32_bf16 v[188:191], a[28:31], a[116:119], v[188:191]
    ds_write_b128 v7, v[172:175] offset:35840
    v_mfma_f32_16x16x32_bf16 v[188:191], a[44:47], a[120:123], v[188:191]
    v_mfma_f32_16x16x32_bf16 v[188:191], a[76:79], a[124:127], v[188:191]
    s_waitcnt vmcnt(9)
    v_mfma_f32_16x16x32_bf16 v[192:195], a[16:19], a[128:131], v[192:195]
    v_mfma_f32_16x16x32_bf16 v[192:195], a[32:35], a[132:135], v[192:195]
    v_mfma_f32_16x16x32_bf16 v[192:195], a[64:67], a[136:139], v[192:195]
    ds_write_b128 v7, v[176:179] offset:36864
    v_mfma_f32_16x16x32_bf16 v[196:199], a[20:23], a[128:131], v[196:199]
    v_mfma_f32_16x16x32_bf16 v[196:199], a[36:39], a[132:135], v[196:199]
    ds_write_b128 v7, v[180:183] offset:37888
    v_mfma_f32_16x16x32_bf16 v[196:199], a[68:71], a[136:139], v[196:199]
    v_mfma_f32_16x16x32_bf16 v[200:203], a[24:27], a[128:131], v[200:203]
    v_mfma_f32_16x16x32_bf16 v[200:203], a[40:43], a[132:135], v[200:203]
    ds_write_b128 v7, v[184:187] offset:38912
    v_mfma_f32_16x16x32_bf16 v[200:203], a[72:75], a[136:139], v[200:203]
    v_mfma_f32_16x16x32_bf16 v[204:207], a[28:31], a[128:131], v[204:207]
    ds_write_b128 v7, v[188:191] offset:39936
    v_mfma_f32_16x16x32_bf16 v[204:207], a[44:47], a[132:135], v[204:207]
    v_mfma_f32_16x16x32_bf16 v[204:207], a[76:79], a[136:139], v[204:207]
    s_waitcnt vmcnt(6)
    v_mfma_f32_16x16x32_bf16 v[208:211], a[16:19], a[140:143], v[208:211]
    v_mfma_f32_16x16x32_bf16 v[208:211], a[32:35], a[144:147], v[208:211]
    v_mfma_f32_16x16x32_bf16 v[208:211], a[64:67], a[148:151], v[208:211]
    ds_write_b128 v8, v[192:195] offset:0
    v_mfma_f32_16x16x32_bf16 v[212:215], a[20:23], a[140:143], v[212:215]
    v_mfma_f32_16x16x32_bf16 v[212:215], a[36:39], a[144:147], v[212:215]
    ds_write_b128 v8, v[196:199] offset:1024
    v_mfma_f32_16x16x32_bf16 v[212:215], a[68:71], a[148:151], v[212:215]
    v_mfma_f32_16x16x32_bf16 v[216:219], a[24:27], a[140:143], v[216:219]
    v_mfma_f32_16x16x32_bf16 v[216:219], a[40:43], a[144:147], v[216:219]
    ds_write_b128 v8, v[200:203] offset:2048
    v_mfma_f32_16x16x32_bf16 v[216:219], a[72:75], a[148:151], v[216:219]
    v_mfma_f32_16x16x32_bf16 v[220:223], a[28:31], a[140:143], v[220:223]
    ds_write_b128 v8, v[204:207] offset:3072
    v_mfma_f32_16x16x32_bf16 v[220:223], a[44:47], a[144:147], v[220:223]
    v_mfma_f32_16x16x32_bf16 v[220:223], a[76:79], a[148:151], v[220:223]
    s_waitcnt vmcnt(3)
    v_mfma_f32_16x16x32_bf16 v[224:227], a[16:19], a[152:155], v[224:227]
    v_mfma_f32_16x16x32_bf16 v[224:227], a[32:35], a[156:159], v[224:227]
    v_mfma_f32_16x16x32_bf16 v[224:227], a[64:67], a[160:163], v[224:227]
    ds_write_b128 v8, v[208:211] offset:4096
    v_mfma_f32_16x16x32_bf16 v[228:231], a[20:23], a[152:155], v[228:231]
    v_mfma_f32_16x16x32_bf16 v[228:231], a[36:39], a[156:159], v[228:231]
    ds_write_b128 v8, v[212:215] offset:5120
    v_mfma_f32_16x16x32_bf16 v[228:231], a[68:71], a[160:163], v[228:231]
    v_mfma_f32_16x16x32_bf16 v[232:235], a[24:27], a[152:155], v[232:235]
    v_mfma_f32_16x16x32_bf16 v[232:235], a[40:43], a[156:159], v[232:235]
    ds_write_b128 v8, v[216:219] offset:6144
    v_mfma_f32_16x16x32_bf16 v[232:235], a[72:75], a[160:163], v[232:235]
    v_mfma_f32_16x16x32_bf16 v[236:239], a[28:31], a[152:155], v[236:239]
    ds_write_b128 v8, v[220:223] offset:7168
    v_mfma_f32_16x16x32_bf16 v[236:239], a[44:47], a[156:159], v[236:239]
    v_mfma_f32_16x16x32_bf16 v[236:239], a[76:79], a[160:163], v[236:239]
    s_waitcnt vmcnt(0)
    s_waitcnt lgkmcnt(0)
    s_barrier
    v_mfma_f32_16x16x32_bf16 v[240:243], a[16:19], a[164:167], v[240:243]
    ds_read_b128 v[128:131], v9 offset:0
    ds_read_b128 v[132:135], v9 offset:1024
    v_mfma_f32_16x16x32_bf16 v[240:243], a[32:35], a[168:171], v[240:243]
    ds_read_b128 v[136:139], v9 offset:2048
    ds_read_b128 v[140:143], v9 offset:3072
    v_mfma_f32_16x16x32_bf16 v[240:243], a[64:67], a[172:175], v[240:243]
    ds_read_b128 v[144:147], v9 offset:4096
    ds_read_b128 v[148:151], v9 offset:5120
    v_mfma_f32_16x16x32_bf16 v[244:247], a[20:23], a[164:167], v[244:247]
    ds_read_b128 v[152:155], v9 offset:6144
    ds_read_b128 v[156:159], v9 offset:7168
    v_mfma_f32_16x16x32_bf16 v[244:247], a[36:39], a[168:171], v[244:247]
    ds_read_b128 v[160:163], v10 offset:0
    ds_read_b128 v[164:167], v10 offset:1024
    v_mfma_f32_16x16x32_bf16 v[244:247], a[68:71], a[172:175], v[244:247]
    ds_read_b128 v[168:171], v10 offset:2048
    ds_read_b128 v[172:175], v10 offset:3072
    v_mfma_f32_16x16x32_bf16 v[248:251], a[24:27], a[164:167], v[248:251]
    ds_read_b128 v[176:179], v10 offset:4096
    ds_read_b128 v[180:183], v10 offset:5120
    v_mfma_f32_16x16x32_bf16 v[248:251], a[40:43], a[168:171], v[248:251]
    ds_read_b128 v[184:187], v10 offset:6144
    ds_read_b128 v[188:191], v10 offset:7168
    v_mfma_f32_16x16x32_bf16 v[248:251], a[72:75], a[172:175], v[248:251]
    ds_read_b128 v[192:195], v11 offset:0
    ds_read_b128 v[196:199], v11 offset:1024
    v_mfma_f32_16x16x32_bf16 v[252:255], a[28:31], a[164:167], v[252:255]
    ds_read_b128 v[200:203], v11 offset:2048
    ds_read_b128 v[204:207], v11 offset:3072
    v_mfma_f32_16x16x32_bf16 v[252:255], a[44:47], a[168:171], v[252:255]
    ds_read_b128 v[208:211], v11 offset:4096
    ds_read_b128 v[212:215], v11 offset:5120
    v_mfma_f32_16x16x32_bf16 v[252:255], a[76:79], a[172:175], v[252:255]
    ds_read_b128 v[216:219], v11 offset:6144
    ds_read_b128 v[220:223], v11 offset:7168
    s_waitcnt lgkmcnt(15)
    v_pk_add_f32 v[224:225], v[224:225], v[128:129]
    v_pk_add_f32 v[226:227], v[226:227], v[130:131]
    v_pk_add_f32 v[228:229], v[228:229], v[132:133]
    v_pk_add_f32 v[230:231], v[230:231], v[134:135]
    v_pk_add_f32 v[232:233], v[232:233], v[136:137]
    v_pk_add_f32 v[234:235], v[234:235], v[138:139]
    v_pk_add_f32 v[236:237], v[236:237], v[140:141]
    v_pk_add_f32 v[238:239], v[238:239], v[142:143]
    v_pk_add_f32 v[240:241], v[240:241], v[144:145]
    v_pk_add_f32 v[242:243], v[242:243], v[146:147]
    v_pk_add_f32 v[244:245], v[244:245], v[148:149]
    v_pk_add_f32 v[246:247], v[246:247], v[150:151]
    v_pk_add_f32 v[248:249], v[248:249], v[152:153]
    v_pk_add_f32 v[250:251], v[250:251], v[154:155]
    v_pk_add_f32 v[252:253], v[252:253], v[156:157]
    v_pk_add_f32 v[254:255], v[254:255], v[158:159]
    v_pk_mul_f32 v[224:225], v[224:225], v[20:21] op_sel_hi:[1,0]
    v_pk_mul_f32 v[226:227], v[226:227], v[20:21] op_sel_hi:[1,0]
    v_pk_mul_f32 v[228:229], v[228:229], v[20:21] op_sel_hi:[1,0]
    v_pk_mul_f32 v[230:231], v[230:231], v[20:21] op_sel_hi:[1,0]
    v_pk_mul_f32 v[232:233], v[232:233], v[20:21] op_sel_hi:[1,0]
    v_pk_mul_f32 v[234:235], v[234:235], v[20:21] op_sel_hi:[1,0]
    v_pk_mul_f32 v[236:237], v[236:237], v[20:21] op_sel_hi:[1,0]
    v_pk_mul_f32 v[238:239], v[238:239], v[20:21] op_sel_hi:[1,0]
    v_pk_mul_f32 v[240:241], v[240:241], v[22:23] op_sel_hi:[1,0]
    v_pk_mul_f32 v[242:243], v[242:243], v[22:23] op_sel_hi:[1,0]
    v_pk_mul_f32 v[244:245], v[244:245], v[22:23] op_sel_hi:[1,0]
    v_pk_mul_f32 v[246:247], v[246:247], v[22:23] op_sel_hi:[1,0]
    v_pk_mul_f32 v[248:249], v[248:249], v[22:23] op_sel_hi:[1,0]
    v_pk_mul_f32 v[250:251], v[250:251], v[22:23] op_sel_hi:[1,0]
    v_pk_mul_f32 v[252:253], v[252:253], v[22:23] op_sel_hi:[1,0]
    v_pk_mul_f32 v[254:255], v[254:255], v[22:23] op_sel_hi:[1,0]
    s_waitcnt lgkmcnt(0)
    v_pk_add_f32 v[160:161], v[160:161], v[192:193]
    v_pk_add_f32 v[162:163], v[162:163], v[194:195]
    v_pk_add_f32 v[164:165], v[164:165], v[196:197]
    v_pk_add_f32 v[166:167], v[166:167], v[198:199]
    v_pk_fma_f32 v[224:225], v[160:161], v[20:21], v[224:225] op_sel:[0,1,0] op_sel_hi:[1,1,1]
    v_pk_fma_f32 v[226:227], v[162:163], v[20:21], v[226:227] op_sel:[0,1,0] op_sel_hi:[1,1,1]
    v_pk_fma_f32 v[228:229], v[164:165], v[20:21], v[228:229] op_sel:[0,1,0] op_sel_hi:[1,1,1]
    v_pk_fma_f32 v[230:231], v[166:167], v[20:21], v[230:231] op_sel:[0,1,0] op_sel_hi:[1,1,1]
    v_cvt_pk_bf16_f32 v64, v224, v225
    v_cvt_pk_bf16_f32 v65, v226, v227
    v_cvt_pk_bf16_f32 v66, v228, v229
    v_cvt_pk_bf16_f32 v67, v230, v231
    s_nop 0
    v_permlane16_swap_b32 v64, v66
    v_permlane16_swap_b32 v65, v67
    v_pk_add_f32 v[168:169], v[168:169], v[200:201]
    v_pk_add_f32 v[170:171], v[170:171], v[202:203]
    v_pk_add_f32 v[172:173], v[172:173], v[204:205]
    v_pk_add_f32 v[174:175], v[174:175], v[206:207]
    v_pk_fma_f32 v[232:233], v[168:169], v[20:21], v[232:233] op_sel:[0,1,0] op_sel_hi:[1,1,1]
    v_pk_fma_f32 v[234:235], v[170:171], v[20:21], v[234:235] op_sel:[0,1,0] op_sel_hi:[1,1,1]
    v_pk_fma_f32 v[236:237], v[172:173], v[20:21], v[236:237] op_sel:[0,1,0] op_sel_hi:[1,1,1]
    v_pk_fma_f32 v[238:239], v[174:175], v[20:21], v[238:239] op_sel:[0,1,0] op_sel_hi:[1,1,1]
    v_cvt_pk_bf16_f32 v68, v232, v233
    v_cvt_pk_bf16_f32 v69, v234, v235
    v_cvt_pk_bf16_f32 v70, v236, v237
    v_cvt_pk_bf16_f32 v71, v238, v239
    s_nop 0
    v_permlane16_swap_b32 v68, v70
    v_permlane16_swap_b32 v69, v71
    v_mov_b32 v80, v64
    v_mov_b32 v81, v65
    v_mov_b32 v82, v66
    v_mov_b32 v83, v67
    v_mov_b32_dpp v64, v68 row_ror:8 row_mask:0xf bank_mask:0xc
    v_mov_b32_dpp v65, v69 row_ror:8 row_mask:0xf bank_mask:0xc
    v_mov_b32_dpp v66, v70 row_ror:8 row_mask:0xf bank_mask:0xc
    v_mov_b32_dpp v67, v71 row_ror:8 row_mask:0xf bank_mask:0xc
    v_mov_b32_dpp v68, v80 row_ror:8 row_mask:0xf bank_mask:0x3
    v_mov_b32_dpp v69, v81 row_ror:8 row_mask:0xf bank_mask:0x3
    v_mov_b32_dpp v70, v82 row_ror:8 row_mask:0xf bank_mask:0x3
    v_mov_b32_dpp v71, v83 row_ror:8 row_mask:0xf bank_mask:0x3
    buffer_store_dwordx4 v[64:67], v14, s[16:19], s61 offen sc1
    buffer_store_dwordx4 v[68:71], v15, s[16:19], s61 offen sc1
    v_pk_add_f32 v[176:177], v[176:177], v[208:209]
    v_pk_add_f32 v[178:179], v[178:179], v[210:211]
    v_pk_add_f32 v[180:181], v[180:181], v[212:213]
    v_pk_add_f32 v[182:183], v[182:183], v[214:215]
    v_pk_fma_f32 v[240:241], v[176:177], v[22:23], v[240:241] op_sel:[0,1,0] op_sel_hi:[1,1,1]
    v_pk_fma_f32 v[242:243], v[178:179], v[22:23], v[242:243] op_sel:[0,1,0] op_sel_hi:[1,1,1]
    v_pk_fma_f32 v[244:245], v[180:181], v[22:23], v[244:245] op_sel:[0,1,0] op_sel_hi:[1,1,1]
    v_pk_fma_f32 v[246:247], v[182:183], v[22:23], v[246:247] op_sel:[0,1,0] op_sel_hi:[1,1,1]
    v_cvt_pk_bf16_f32 v72, v240, v241
    v_cvt_pk_bf16_f32 v73, v242, v243
    v_cvt_pk_bf16_f32 v74, v244, v245
    v_cvt_pk_bf16_f32 v75, v246, v247
    s_nop 0
    v_permlane16_swap_b32 v72, v74
    v_permlane16_swap_b32 v73, v75
    v_pk_add_f32 v[184:185], v[184:185], v[216:217]
    v_pk_add_f32 v[186:187], v[186:187], v[218:219]
    v_pk_add_f32 v[188:189], v[188:189], v[220:221]
    v_pk_add_f32 v[190:191], v[190:191], v[222:223]
    v_pk_fma_f32 v[248:249], v[184:185], v[22:23], v[248:249] op_sel:[0,1,0] op_sel_hi:[1,1,1]
    v_pk_fma_f32 v[250:251], v[186:187], v[22:23], v[250:251] op_sel:[0,1,0] op_sel_hi:[1,1,1]
    v_pk_fma_f32 v[252:253], v[188:189], v[22:23], v[252:253] op_sel:[0,1,0] op_sel_hi:[1,1,1]
    v_pk_fma_f32 v[254:255], v[190:191], v[22:23], v[254:255] op_sel:[0,1,0] op_sel_hi:[1,1,1]
    v_cvt_pk_bf16_f32 v76, v248, v249
    v_cvt_pk_bf16_f32 v77, v250, v251
    v_cvt_pk_bf16_f32 v78, v252, v253
    v_cvt_pk_bf16_f32 v79, v254, v255
    s_nop 0
    v_permlane16_swap_b32 v76, v78
    v_permlane16_swap_b32 v77, v79
    v_mov_b32 v80, v72
    v_mov_b32 v81, v73
    v_mov_b32 v82, v74
    v_mov_b32 v83, v75
    v_mov_b32_dpp v72, v76 row_ror:8 row_mask:0xf bank_mask:0xc
    v_mov_b32_dpp v73, v77 row_ror:8 row_mask:0xf bank_mask:0xc
    v_mov_b32_dpp v74, v78 row_ror:8 row_mask:0xf bank_mask:0xc
    v_mov_b32_dpp v75, v79 row_ror:8 row_mask:0xf bank_mask:0xc
    v_mov_b32_dpp v76, v80 row_ror:8 row_mask:0xf bank_mask:0x3
    v_mov_b32_dpp v77, v81 row_ror:8 row_mask:0xf bank_mask:0x3
    v_mov_b32_dpp v78, v82 row_ror:8 row_mask:0xf bank_mask:0x3
    v_mov_b32_dpp v79, v83 row_ror:8 row_mask:0xf bank_mask:0x3
    buffer_store_dwordx4 v[72:75], v14, s[16:19], s62 offen sc1
    buffer_store_dwordx4 v[76:79], v15, s[16:19], s62 offen sc1
K_END:
    s_endpgm
K_WAIT:
    buffer_load_dword v44, v6, s[24:27], s54 offen sc1
    s_waitcnt vmcnt(0)
    v_cmp_ne_u32 vcc, -1, v44
    s_nop 1
    s_lshr_b32 s57, vcc_lo, 1
    s_and_b32 s57, s57, vcc_lo
    s_or_b32 s60, s60, s57
    s_bitcmp1_b32 s60, s59
    s_cbranch_scc0 K_WAIT
K_LAST:
    s_setpc_b64 s[68:69]
    s_endpgm
.section .rodata,"a"
.p2align 6
.amdhsa_kernel gated_mix__linear_attn_block__linear_attn_block__prompt_kernel
  .amdhsa_next_free_vgpr 512
  .amdhsa_next_free_sgpr 96
  .amdhsa_accum_offset 256
  .amdhsa_group_segment_fixed_size 0
  .amdhsa_kernarg_size 80
  .amdhsa_user_sgpr_count 2
  .amdhsa_user_sgpr_kernarg_segment_ptr 1
  .amdhsa_system_sgpr_workgroup_id_x 1
  .amdhsa_float_denorm_mode_32 3
.end_amdhsa_kernel
```
